```python
import torch

def _softmax(x, axis=-1):
    return torch.softmax(x, dim=axis)
def _gelu(x):
    return torch.nn.functional.gelu(x, approximate="tanh")
def _silu(x):
    return torch.nn.functional.silu(x)
def _sigmoid(x):
    return torch.sigmoid(x)
def _layernorm(x, axis=-1, eps=1e-5):
    m = x.mean(dim=axis, keepdim=True)
    v = x.var(dim=axis, keepdim=True, unbiased=False)
    return (x - m) / torch.sqrt(v + eps)
def _scatter_add(tgt, idx, src, axis=0):
    return tgt.clone().index_add_(axis, idx, src)
def _segment_sum(src, seg, n):
    out = torch.zeros((n,) + src.shape[1:], dtype=src.dtype)
    return out.index_add_(0, seg, src)
def _pad(x, pw):
    flat = tuple(v for pair in reversed(pw) for v in pair)
    return torch.nn.functional.pad(x, flat)

kernel_name = 'concat_heads__gqa_block_cached__mha_block_cached__near_ridge'

def setup_inputs():

    _w = (lambda a: (lambda t: t.to(torch.bfloat16) if t.is_floating_point() else t)(torch.as_tensor(a)))
    def _A_setup():
        B, Sq, D = 16, 80, 576
        Hq, Hkv, Sk, Dh = 32, 16, 512, 128
        assert Hq % Hkv == 0, (Hq, Hkv)
        return {
            "x": _w((lambda *s: torch.randn(*s, dtype=torch.bfloat16) * 0.8)(B, Sq, D)),
            "k_cache": _w((lambda *s: torch.randn(*s, dtype=torch.bfloat16) * 0.8)(B, Hkv, Sk, Dh)),
            "v_cache": _w((lambda *s: torch.randn(*s, dtype=torch.bfloat16) * 0.05)(B, Hkv, Sk, Dh)),
            "wq": _w((lambda *s: torch.randn(*s, dtype=torch.bfloat16) * 0.8)(D, Hq * Dh) * (D ** -0.5)),
            "wo": _w((lambda *s: torch.randn(*s, dtype=torch.bfloat16) * 0.05)(Hq * Dh, D) * ((Hq * Dh) ** -0.5)),
        }
    _A_in = _A_setup()

    def _B_setup():
        B, Sq, D = 16, 80, 576
        H, Sk, Dh = 32, 512, 128
        return {
            "x": _w((lambda *s: torch.randn(*s, dtype=torch.bfloat16) * 0.8)(B, Sq, D)),
            "k_cache": _w((lambda *s: torch.randn(*s, dtype=torch.bfloat16) * 0.8)(B, H, Sk, Dh)),
            "v_cache": _w((lambda *s: torch.randn(*s, dtype=torch.bfloat16) * 0.05)(B, H, Sk, Dh)),
            "wq": _w((lambda *s: torch.randn(*s, dtype=torch.bfloat16) * 0.8)(D, H * Dh) * (D ** -0.5)),
            "wo": _w((lambda *s: torch.randn(*s, dtype=torch.bfloat16) * 0.05)(H * Dh, D) * ((H * Dh) ** -0.5)),
        }
    _B_in = _B_setup()

    return {
        "A_x": _A_in["x"],
        "A_k_cache": _A_in["k_cache"],
        "A_v_cache": _A_in["v_cache"],
        "A_wq": _A_in["wq"],
        "A_wo": _A_in["wo"],
        "B_x": _B_in["x"],
        "B_k_cache": _B_in["k_cache"],
        "B_v_cache": _B_in["v_cache"],
        "B_wq": _B_in["wq"],
        "B_wo": _B_in["wo"],
    }

def reference(A_x, A_k_cache, A_v_cache, A_wq, A_wo, B_x, B_k_cache, B_v_cache, B_wq, B_wo):
    def _A_ref(x, k_cache, v_cache, wq, wo):
        B, Sq, D = x.shape
        Hq, Dh = 32, 128
        Hkv = k_cache.shape[1]
        rep = Hq // Hkv
        q = (lambda x, *d: x.permute(*d))((x @ wq).reshape(B, Sq, Hq, Dh), 0, 2, 1, 3)
        k = (lambda x, n, axis: torch.repeat_interleave(x, n, dim=axis))(k_cache, rep, axis=1)
        v = (lambda x, n, axis: torch.repeat_interleave(x, n, dim=axis))(v_cache, rep, axis=1)
        scores = torch.einsum("bhqd,bhkd->bhqk", q, k) * (Dh ** -0.5)
        p = _softmax(scores, axis=-1)
        o = torch.einsum("bhqk,bhkd->bhqd", p, v)
        return (lambda x, *d: x.permute(*d))(o, 0, 2, 1, 3).reshape(B, Sq, Hq * Dh) @ wo

    def _B_ref(x, k_cache, v_cache, wq, wo):
        B, Sq, D = x.shape
        H, Dh = 32, 128
        q = (lambda x, *d: x.permute(*d))((x @ wq).reshape(B, Sq, H, Dh), 0, 2, 1, 3)
        scores = torch.einsum("bhqd,bhkd->bhqk", q, k_cache) * (Dh ** -0.5)
        p = _softmax(scores, axis=-1)
        o = torch.einsum("bhqk,bhkd->bhqd", p, v_cache)
        return (lambda x, *d: x.permute(*d))(o, 0, 2, 1, 3).reshape(B, Sq, H * Dh) @ wo

    a = _A_ref(A_x, A_k_cache, A_v_cache, A_wq, A_wo)
    b = _B_ref(B_x, B_k_cache, B_v_cache, B_wq, B_wo)
    return torch.concatenate([a, b], axis=-1)
```

```asm
; @launch kernel=attn_kernel grid=(256,1,1) block=(256,1,1) lds=163840
; @launch kernel=reduce_kernel grid=(360,1,1) block=(256,1,1) lds=0
.amdgcn_target "amdgcn-amd-amdhsa--gfx950"
.text
.globl attn_kernel
.p2align 8
.type attn_kernel,@function
attn_kernel:
  s_cmp_ge_u32 s2, 256
  s_cbranch_scc1 K1_END
  s_load_dwordx16 s[4:19], s[0:1], 0
  s_load_dwordx8 s[20:27], s[0:1], 64
  s_load_dwordx2 s[28:29], s[0:1], 96
  v_lshrrev_b32 v1, 6, v0
  v_and_b32 v0, 63, v0
  v_readfirstlane_b32 s56, v1
  s_and_b32 s64, s2, 7
  s_lshr_b32 s65, s2, 3
  s_and_b32 s57, s65, 1
  s_lshr_b32 s98, s65, 1
  s_and_b32 s98, s98, 7
  s_and_b32 s60, s64, 1
  s_lshl_b32 s60, s60, 3
  s_add_u32 s60, s60, s98
  s_lshr_b32 s66, s65, 4
  s_lshr_b32 s58, s64, 1
  s_lshl_b32 s58, s58, 1
  s_add_u32 s58, s58, s66
  s_mul_i32 s66, s66, 10
  s_lshl_b32 s3, s98, 1
  s_add_u32 s3, s3, s66
  s_sub_u32 s66, s3, 18
  s_cmp_ge_u32 s3, 18
  s_cselect_b32 s3, s66, s3
  v_lshrrev_b32 v9, 4, v0
  v_and_b32 v10, 15, v0
  s_and_b32 s59, s56, 1
  s_lshl_b32 s61, s58, 2
  s_add_u32 s61, s61, s56
  s_lshl_b32 s76, s59, 12
  s_lshl_b32 s78, s2, 2
  s_add_u32 s78, s78, s56
  s_lshl_b32 s62, s56, 15
  s_cmp_ge_u32 s56, 2
  s_cselect_b32 s64, 32768, 0
  s_add_u32 s62, s62, s64
  s_cmp_eq_u32 s57, 0
  s_cselect_b32 s62, s64, s62
  s_lshl_b32 s64, s56, 13
  s_mul_i32 s65, s56, 2560
  s_add_u32 s99, s64, 0
  s_add_u32 s30, s65, 98304
  s_add_u32 s100, s64, 32768
  s_add_u32 s31, s65, 108544
  s_add_u32 s101, s64, 65536
  s_add_u32 s63, s65, 118784
  v_lshrrev_b32 v11, 2, v10
  v_and_b32 v12, 3, v10
  v_lshlrev_b32 v254, 4, v0
  s_lshl_b32 s64, s56, 16
  v_xor_b32 v13, 0, v0
  v_lshlrev_b32 v13, 4, v13
  v_add_u32 v13, s64, v13
  v_mov_b32 v246, v13
  v_xor_b32 v13, 4, v0
  v_lshlrev_b32 v13, 4, v13
  v_add_u32 v13, s64, v13
  v_add_u32 v247, 7168, v13
  v_xor_b32 v13, 8, v0
  v_lshlrev_b32 v13, 4, v13
  v_add_u32 v13, s64, v13
  v_add_u32 v248, 14336, v13
  v_xor_b32 v13, 12, v0
  v_lshlrev_b32 v13, 4, v13
  v_add_u32 v13, s64, v13
  v_add_u32 v249, 21504, v13
  v_lshrrev_b32 v14, 3, v0
  s_mul_i32 s64, s56, 20
  v_add_u32 v14, s64, v14
  v_mul_u32_u24 v14, 1152, v14
  s_mul_i32 s64, s56, 10
  v_add_u32 v13, s64, v9
  v_and_b32 v13, 7, v13
  v_and_b32 v15, 7, v0
  v_xor_b32 v13, v13, v15
  v_lshl_add_u32 v250, v13, 4, v14
  v_add_u32 v13, s64, v9
  v_add_u32 v13, 4, v13
  v_and_b32 v13, 7, v13
  v_and_b32 v15, 7, v0
  v_xor_b32 v13, v13, v15
  v_lshl_add_u32 v251, v13, 4, v14
  v_add_u32 v251, 8192, v251
  v_add_u32 v13, s64, v9
  v_add_u32 v13, 8, v13
  v_and_b32 v13, 7, v13
  v_and_b32 v15, 7, v0
  v_xor_b32 v13, v13, v15
  v_lshl_add_u32 v252, v13, 4, v14
  v_add_u32 v252, 16384, v252
  s_waitcnt lgkmcnt(0)
  s_cmp_eq_u32 s57, 0
  s_cselect_b32 s44, s4, s14
  s_cselect_b32 s45, s5, s15
  s_cselect_b32 s32, s6, s16
  s_cselect_b32 s33, s7, s17
  s_cselect_b32 s36, s8, s18
  s_cselect_b32 s37, s9, s19
  s_cselect_b32 s40, s10, s20
  s_cselect_b32 s41, s11, s21
  s_cselect_b32 s48, s12, s22
  s_cselect_b32 s49, s13, s23
  s_lshl_b32 s64, s58, 10
  s_sub_u32 s42, 4718592, s64
  s_add_u32 s40, s40, s64
  s_addc_u32 s41, s41, 0
  s_and_b32 s41, s41, 0xffff
  s_mov_b32 s43, 0x20000
  s_mul_i32 s64, s60, 92160
  s_mov_b32 s46, 92160
  s_add_u32 s44, s44, s64
  s_addc_u32 s45, s45, 0
  s_and_b32 s45, s45, 0xffff
  s_mov_b32 s47, 0x20000
  s_cmp_eq_u32 s57, 0
  s_cbranch_scc1 K1_NO_S0
  s_add_u32 s66, s3, 0
  s_sub_u32 s67, s66, 18
  s_cmp_ge_u32 s66, 18
  s_cselect_b32 s66, s67, s66
  s_lshl_b32 s69, s66, 18
  s_lshl_b32 s70, s66, 6
  s_mov_b32 m0, s99
  s_nop 0
  buffer_load_dwordx4 v246, s[40:43], s69 offen offset:0 lds
  buffer_load_dwordx4 v247, s[40:43], s69 offen offset:1024 lds
  buffer_load_dwordx4 v248, s[40:43], s69 offen offset:2048 lds
  buffer_load_dwordx4 v249, s[40:43], s69 offen offset:3072 lds
  s_add_u32 m0, s99, 4096
  s_add_u32 s67, s69, 32768
  buffer_load_dwordx4 v246, s[40:43], s67 offen offset:0 lds
  buffer_load_dwordx4 v247, s[40:43], s67 offen offset:1024 lds
  buffer_load_dwordx4 v248, s[40:43], s67 offen offset:2048 lds
  buffer_load_dwordx4 v249, s[40:43], s67 offen offset:3072 lds
  s_mov_b32 m0, s30
  s_nop 0
  buffer_load_dwordx4 v250, s[44:47], s70 offen offset:0 lds
  buffer_load_dwordx4 v251, s[44:47], s70 offen offset:1024 lds
  s_mov_b32 exec_hi, 0
  buffer_load_dwordx4 v252, s[44:47], s70 offen offset:2048 lds
  s_mov_b32 exec_hi, -1
  s_branch K1_S0_DONE
K1_NO_S0:
  s_lshl_b32 s64, s58, 10
  s_add_u32 s8, s20, s64
  s_addc_u32 s9, s21, 0
  s_and_b32 s9, s9, 0xffff
  s_sub_u32 s10, 4718592, s64
  s_mov_b32 s11, 0x20000
  s_and_b32 s64, s60, 7
  s_mul_i32 s64, s64, 72
  s_mul_i32 s65, s56, 18
  s_add_u32 s64, s64, s65
  v_add_u32 v13, 0, v0
  v_lshrrev_b32 v14, 3, v13
  v_add_u32 v14, s64, v14
  v_lshlrev_b32 v14, 13, v14
  v_and_b32 v15, 7, v13
  v_lshl_add_u32 v14, v15, 7, v14
  buffer_load_dword v8, v14, s[8:11], 0 offen
  v_add_u32 v13, 64, v0
  v_lshrrev_b32 v14, 3, v13
  v_add_u32 v14, s64, v14
  v_lshlrev_b32 v14, 13, v14
  v_and_b32 v15, 7, v13
  v_lshl_add_u32 v14, v15, 7, v14
  buffer_load_dword v8, v14, s[8:11], 0 offen
  v_add_u32 v13, 128, v0
  v_lshrrev_b32 v14, 3, v13
  v_add_u32 v14, s64, v14
  v_lshlrev_b32 v14, 13, v14
  v_and_b32 v15, 7, v13
  v_lshl_add_u32 v14, v15, 7, v14
  v_cmp_gt_u32 vcc, 16, v0
  v_mov_b32 v15, 0x40000000
  s_nop 0
  v_cndmask_b32 v14, v15, v14, vcc
  buffer_load_dword v8, v14, s[8:11], 0 offen
  s_mul_i32 s64, s60, 92160
  s_add_u32 s8, s14, s64
  s_addc_u32 s9, s15, 0
  s_and_b32 s9, s9, 0xffff
  s_mov_b32 s10, 92160
  s_mov_b32 s11, 0x20000
  s_lshr_b32 s64, s2, 7
  s_mul_i32 s64, s64, 40
  s_mul_i32 s65, s56, 10
  s_add_u32 s64, s64, s65
  v_add_u32 v13, 0, v0
  v_mul_u32_u24 v14, 7282, v13
  v_lshrrev_b32 v14, 16, v14
  v_mul_u32_u24 v15, 9, v14
  v_sub_u32 v15, v13, v15
  v_add_u32 v14, s64, v14
  v_mul_u32_u24 v14, 1152, v14
  v_lshl_add_u32 v14, v15, 7, v14
  buffer_load_dword v8, v14, s[8:11], 0 offen
  v_add_u32 v13, 64, v0
  v_mul_u32_u24 v14, 7282, v13
  v_lshrrev_b32 v14, 16, v14
  v_mul_u32_u24 v15, 9, v14
  v_sub_u32 v15, v13, v15
  v_add_u32 v14, s64, v14
  v_mul_u32_u24 v14, 1152, v14
  v_lshl_add_u32 v14, v15, 7, v14
  v_cmp_gt_u32 vcc, 26, v0
  v_mov_b32 v15, 0x40000000
  s_nop 0
  v_cndmask_b32 v14, v15, v14, vcc
  buffer_load_dword v8, v14, s[8:11], 0 offen
K1_S0_DONE:
  s_lshl_b32 s64, s60, 4
  s_lshr_b32 s65, s61, 1
  s_add_u32 s64, s64, s65
  s_lshl_b32 s65, s60, 5
  s_add_u32 s65, s65, s61
  s_cmp_eq_u32 s57, 0
  s_cselect_b32 s64, s64, s65
  s_lshl_b32 s66, s64, 17
  s_add_u32 s32, s32, s66
  s_addc_u32 s33, s33, 0
  s_and_b32 s33, s33, 0xffff
  s_mov_b32 s34, 131072
  s_mov_b32 s35, 0x20000
  s_add_u32 s36, s36, s66
  s_addc_u32 s37, s37, 0
  s_and_b32 s37, s37, 0xffff
  s_mov_b32 s38, 131072
  s_mov_b32 s39, 0x20000
  s_lshr_b32 s64, s56, 1
  s_cmp_eq_u32 s57, 0
  s_cselect_b32 s64, s64, s56
  s_mul_i32 s64, s64, 5
  s_lshr_b32 s65, s2, 1
  s_add_u32 s96, s64, s65
  s_and_b32 s96, s96, 15
  v_mov_b32 v16, 0
  v_mov_b32 v17, 0
  v_mov_b32 v18, 0
  v_mov_b32 v19, 0
  v_mov_b32 v20, 0
  v_mov_b32 v21, 0
  v_mov_b32 v22, 0
  v_mov_b32 v23, 0
  v_mov_b32 v24, 0
  v_mov_b32 v25, 0
  v_mov_b32 v26, 0
  v_mov_b32 v27, 0
  v_mov_b32 v28, 0
  v_mov_b32 v29, 0
  v_mov_b32 v30, 0
  v_mov_b32 v31, 0
  v_mov_b32 v32, 0
  v_mov_b32 v33, 0
  v_mov_b32 v34, 0
  v_mov_b32 v35, 0
  v_mov_b32 v36, 0
  v_mov_b32 v37, 0
  v_mov_b32 v38, 0
  v_mov_b32 v39, 0
  v_mov_b32 v40, 0
  v_mov_b32 v41, 0
  v_mov_b32 v42, 0
  v_mov_b32 v43, 0
  v_mov_b32 v44, 0
  v_mov_b32 v45, 0
  v_mov_b32 v46, 0
  v_mov_b32 v47, 0
  v_mov_b32 v48, 0
  v_mov_b32 v49, 0
  v_mov_b32 v50, 0
  v_mov_b32 v51, 0
  v_mov_b32 v52, 0
  v_mov_b32 v53, 0
  v_mov_b32 v54, 0
  v_mov_b32 v55, 0
  v_mov_b32 v56, 0
  v_mov_b32 v57, 0
  v_mov_b32 v58, 0
  v_mov_b32 v59, 0
  v_mov_b32 v60, 0
  v_mov_b32 v61, 0
  v_mov_b32 v62, 0
  v_mov_b32 v63, 0
  v_mov_b32 v64, 0
  v_mov_b32 v65, 0
  v_mov_b32 v66, 0
  v_mov_b32 v67, 0
  v_mov_b32 v68, 0
  v_mov_b32 v69, 0
  v_mov_b32 v70, 0
  v_mov_b32 v71, 0
  v_mov_b32 v72, 0
  v_mov_b32 v73, 0
  v_mov_b32 v74, 0
  v_mov_b32 v75, 0
  v_mov_b32 v76, 0
  v_mov_b32 v77, 0
  v_mov_b32 v78, 0
  v_mov_b32 v79, 0
  v_mov_b32 v80, 0
  v_mov_b32 v81, 0
  v_mov_b32 v82, 0
  v_mov_b32 v83, 0
  v_mov_b32 v84, 0
  v_mov_b32 v85, 0
  v_mov_b32 v86, 0
  v_mov_b32 v87, 0
  v_mov_b32 v88, 0
  v_mov_b32 v89, 0
  v_mov_b32 v90, 0
  v_mov_b32 v91, 0
  v_mov_b32 v92, 0
  v_mov_b32 v93, 0
  v_mov_b32 v94, 0
  v_mov_b32 v95, 0
  v_mov_b32 v96, 0
  v_mov_b32 v97, 0
  v_mov_b32 v98, 0
  v_mov_b32 v99, 0
  v_mov_b32 v100, 0
  v_mov_b32 v101, 0
  v_mov_b32 v102, 0
  v_mov_b32 v103, 0
  v_mov_b32 v104, 0
  v_mov_b32 v105, 0
  v_mov_b32 v106, 0
  v_mov_b32 v107, 0
  v_mov_b32 v108, 0
  v_mov_b32 v109, 0
  v_mov_b32 v110, 0
  v_mov_b32 v111, 0
  v_mov_b32 v112, 0
  v_mov_b32 v113, 0
  v_mov_b32 v114, 0
  v_mov_b32 v115, 0
  v_mov_b32 v116, 0
  v_mov_b32 v117, 0
  v_mov_b32 v118, 0
  v_mov_b32 v119, 0
  v_mov_b32 v120, 0
  v_mov_b32 v121, 0
  v_mov_b32 v122, 0
  v_mov_b32 v123, 0
  v_mov_b32 v124, 0
  v_mov_b32 v125, 0
  v_mov_b32 v126, 0
  v_mov_b32 v127, 0
  v_mov_b32 v128, 0
  v_mov_b32 v129, 0
  v_mov_b32 v130, 0
  v_mov_b32 v131, 0
  v_mov_b32 v132, 0
  v_mov_b32 v133, 0
  v_mov_b32 v134, 0
  v_mov_b32 v135, 0
  v_mov_b32 v136, 0
  v_mov_b32 v137, 0
  v_mov_b32 v138, 0
  v_mov_b32 v139, 0
  v_mov_b32 v140, 0
  v_mov_b32 v141, 0
  v_mov_b32 v142, 0
  v_mov_b32 v143, 0
  v_mov_b32 v144, 0
  v_mov_b32 v145, 0
  v_mov_b32 v146, 0
  v_mov_b32 v147, 0
  v_mov_b32 v148, 0
  v_mov_b32 v149, 0
  v_mov_b32 v150, 0
  v_mov_b32 v151, 0
  v_mov_b32 v152, 0
  v_mov_b32 v153, 0
  v_mov_b32 v154, 0
  v_mov_b32 v155, 0
  v_mov_b32 v156, 0
  v_mov_b32 v157, 0
  v_mov_b32 v158, 0
  v_mov_b32 v159, 0
  v_mov_b32 v160, 0
  v_mov_b32 v161, 0
  v_mov_b32 v162, 0
  v_mov_b32 v163, 0
  v_mov_b32 v164, 0
  v_mov_b32 v165, 0
  v_mov_b32 v166, 0
  v_mov_b32 v167, 0
  v_mov_b32 v168, 0
  v_mov_b32 v169, 0
  v_mov_b32 v170, 0
  v_mov_b32 v171, 0
  v_mov_b32 v172, 0
  v_mov_b32 v173, 0
  v_mov_b32 v174, 0
  v_mov_b32 v175, 0
  s_mul_i32 s64, s58, 589824
  s_add_u32 s48, s48, s64
  s_addc_u32 s49, s49, 0
  s_and_b32 s49, s49, 0xffff
  s_mov_b32 s50, 589824
  s_mov_b32 s51, 0x20000
  s_mul_i32 s64, s57, 11796480
  s_mul_i32 s65, s58, 1474560
  s_add_u32 s64, s64, s65
  s_mul_i32 s65, s60, 92160
  s_add_u32 s64, s64, s65
  s_mov_b32 s52, s28
  s_mov_b32 s53, s29
  s_add_u32 s52, s52, s64
  s_addc_u32 s53, s53, 0
  s_and_b32 s53, s53, 0xffff
  s_mov_b32 s54, 92160
  s_mov_b32 s55, 0x20000
  v_lshl_add_u32 v14, v9, 3, v11
  v_lshlrev_b32 v14, 10, v14
  v_lshl_add_u32 v14, v12, 4, v14
  s_lshl_b32 s64, s56, 8
  s_add_u32 s66, s64, 0
  v_xor_b32 v13, 0, v11
  v_lshl_add_u32 v13, v13, 6, v14
  v_add_u32 v228, s66, v13
  v_xor_b32 v13, 1, v11
  v_lshl_add_u32 v13, v13, 6, v14
  v_add_u32 v229, s66, v13
  v_xor_b32 v13, 2, v11
  v_lshl_add_u32 v13, v13, 6, v14
  v_add_u32 v230, s66, v13
  v_xor_b32 v13, 3, v11
  v_lshl_add_u32 v13, v13, 6, v14
  v_add_u32 v231, s66, v13
  s_add_u32 s66, s64, 32768
  v_xor_b32 v13, 0, v11
  v_lshl_add_u32 v13, v13, 6, v14
  v_add_u32 v232, s66, v13
  v_xor_b32 v13, 1, v11
  v_lshl_add_u32 v13, v13, 6, v14
  v_add_u32 v233, s66, v13
  v_xor_b32 v13, 2, v11
  v_lshl_add_u32 v13, v13, 6, v14
  v_add_u32 v234, s66, v13
  v_xor_b32 v13, 3, v11
  v_lshl_add_u32 v13, v13, 6, v14
  v_add_u32 v235, s66, v13
  s_add_u32 s66, s64, 65536
  v_xor_b32 v13, 0, v11
  v_lshl_add_u32 v13, v13, 6, v14
  v_add_u32 v236, s66, v13
  v_xor_b32 v13, 1, v11
  v_lshl_add_u32 v13, v13, 6, v14
  v_add_u32 v237, s66, v13
  v_xor_b32 v13, 2, v11
  v_lshl_add_u32 v13, v13, 6, v14
  v_add_u32 v238, s66, v13
  v_xor_b32 v13, 3, v11
  v_lshl_add_u32 v13, v13, 6, v14
  v_add_u32 v239, s66, v13
  v_lshrrev_b32 v14, 1, v10
  v_add_u32 v13, 0, v9
  v_xor_b32 v13, v13, v14
  v_lshlrev_b32 v13, 4, v13
  v_lshl_add_u32 v13, v10, 7, v13
  v_add_u32 v240, 98304, v13
  v_add_u32 v13, 4, v9
  v_xor_b32 v13, v13, v14
  v_lshlrev_b32 v13, 4, v13
  v_lshl_add_u32 v13, v10, 7, v13
  v_add_u32 v241, 98304, v13
  v_add_u32 v13, 0, v9
  v_xor_b32 v13, v13, v14
  v_lshlrev_b32 v13, 4, v13
  v_lshl_add_u32 v13, v10, 7, v13
  v_add_u32 v242, 108544, v13
  v_add_u32 v13, 4, v9
  v_xor_b32 v13, v13, v14
  v_lshlrev_b32 v13, 4, v13
  v_lshl_add_u32 v13, v10, 7, v13
  v_add_u32 v243, 108544, v13
  v_add_u32 v13, 0, v9
  v_xor_b32 v13, v13, v14
  v_lshlrev_b32 v13, 4, v13
  v_lshl_add_u32 v13, v10, 7, v13
  v_add_u32 v244, 118784, v13
  v_add_u32 v13, 4, v9
  v_xor_b32 v13, v13, v14
  v_lshlrev_b32 v13, 4, v13
  v_lshl_add_u32 v13, v10, 7, v13
  v_add_u32 v245, 118784, v13
  v_accvgpr_write_b32 a0, 0
  v_accvgpr_write_b32 a1, 0
  v_accvgpr_write_b32 a2, 0
  v_accvgpr_write_b32 a3, 0
  v_accvgpr_write_b32 a4, 0
  v_accvgpr_write_b32 a5, 0
  v_accvgpr_write_b32 a6, 0
  v_accvgpr_write_b32 a7, 0
  v_accvgpr_write_b32 a8, 0
  v_accvgpr_write_b32 a9, 0
  v_accvgpr_write_b32 a10, 0
  v_accvgpr_write_b32 a11, 0
  v_accvgpr_write_b32 a12, 0
  v_accvgpr_write_b32 a13, 0
  v_accvgpr_write_b32 a14, 0
  v_accvgpr_write_b32 a15, 0
  v_accvgpr_write_b32 a16, 0
  v_accvgpr_write_b32 a17, 0
  v_accvgpr_write_b32 a18, 0
  v_accvgpr_write_b32 a19, 0
  v_accvgpr_write_b32 a20, 0
  v_accvgpr_write_b32 a21, 0
  v_accvgpr_write_b32 a22, 0
  v_accvgpr_write_b32 a23, 0
  v_accvgpr_write_b32 a24, 0
  v_accvgpr_write_b32 a25, 0
  v_accvgpr_write_b32 a26, 0
  v_accvgpr_write_b32 a27, 0
  v_accvgpr_write_b32 a28, 0
  v_accvgpr_write_b32 a29, 0
  v_accvgpr_write_b32 a30, 0
  v_accvgpr_write_b32 a31, 0
  v_accvgpr_write_b32 a32, 0
  v_accvgpr_write_b32 a33, 0
  v_accvgpr_write_b32 a34, 0
  v_accvgpr_write_b32 a35, 0
  v_accvgpr_write_b32 a36, 0
  v_accvgpr_write_b32 a37, 0
  v_accvgpr_write_b32 a38, 0
  v_accvgpr_write_b32 a39, 0
  v_accvgpr_write_b32 a40, 0
  v_accvgpr_write_b32 a41, 0
  v_accvgpr_write_b32 a42, 0
  v_accvgpr_write_b32 a43, 0
  v_accvgpr_write_b32 a44, 0
  v_accvgpr_write_b32 a45, 0
  v_accvgpr_write_b32 a46, 0
  v_accvgpr_write_b32 a47, 0
  v_accvgpr_write_b32 a48, 0
  v_accvgpr_write_b32 a49, 0
  v_accvgpr_write_b32 a50, 0
  v_accvgpr_write_b32 a51, 0
  v_accvgpr_write_b32 a52, 0
  v_accvgpr_write_b32 a53, 0
  v_accvgpr_write_b32 a54, 0
  v_accvgpr_write_b32 a55, 0
  v_accvgpr_write_b32 a56, 0
  v_accvgpr_write_b32 a57, 0
  v_accvgpr_write_b32 a58, 0
  v_accvgpr_write_b32 a59, 0
  v_accvgpr_write_b32 a60, 0
  v_accvgpr_write_b32 a61, 0
  v_accvgpr_write_b32 a62, 0
  v_accvgpr_write_b32 a63, 0
  v_accvgpr_write_b32 a64, 0
  v_accvgpr_write_b32 a65, 0
  v_accvgpr_write_b32 a66, 0
  v_accvgpr_write_b32 a67, 0
  v_accvgpr_write_b32 a68, 0
  v_accvgpr_write_b32 a69, 0
  v_accvgpr_write_b32 a70, 0
  v_accvgpr_write_b32 a71, 0
  v_accvgpr_write_b32 a72, 0
  v_accvgpr_write_b32 a73, 0
  v_accvgpr_write_b32 a74, 0
  v_accvgpr_write_b32 a75, 0
  v_accvgpr_write_b32 a76, 0
  v_accvgpr_write_b32 a77, 0
  v_accvgpr_write_b32 a78, 0
  v_accvgpr_write_b32 a79, 0
  v_accvgpr_write_b32 a80, 0
  v_accvgpr_write_b32 a81, 0
  v_accvgpr_write_b32 a82, 0
  v_accvgpr_write_b32 a83, 0
  v_accvgpr_write_b32 a84, 0
  v_accvgpr_write_b32 a85, 0
  v_accvgpr_write_b32 a86, 0
  v_accvgpr_write_b32 a87, 0
  v_accvgpr_write_b32 a88, 0
  v_accvgpr_write_b32 a89, 0
  v_accvgpr_write_b32 a90, 0
  v_accvgpr_write_b32 a91, 0
  v_accvgpr_write_b32 a92, 0
  v_accvgpr_write_b32 a93, 0
  v_accvgpr_write_b32 a94, 0
  v_accvgpr_write_b32 a95, 0
  v_accvgpr_write_b32 a96, 0
  v_accvgpr_write_b32 a97, 0
  v_accvgpr_write_b32 a98, 0
  v_accvgpr_write_b32 a99, 0
  v_accvgpr_write_b32 a100, 0
  v_accvgpr_write_b32 a101, 0
  v_accvgpr_write_b32 a102, 0
  v_accvgpr_write_b32 a103, 0
  v_accvgpr_write_b32 a104, 0
  v_accvgpr_write_b32 a105, 0
  v_accvgpr_write_b32 a106, 0
  v_accvgpr_write_b32 a107, 0
  v_accvgpr_write_b32 a108, 0
  v_accvgpr_write_b32 a109, 0
  v_accvgpr_write_b32 a110, 0
  v_accvgpr_write_b32 a111, 0
  v_accvgpr_write_b32 a112, 0
  v_accvgpr_write_b32 a113, 0
  v_accvgpr_write_b32 a114, 0
  v_accvgpr_write_b32 a115, 0
  v_accvgpr_write_b32 a116, 0
  v_accvgpr_write_b32 a117, 0
  v_accvgpr_write_b32 a118, 0
  v_accvgpr_write_b32 a119, 0
  v_accvgpr_write_b32 a120, 0
  v_accvgpr_write_b32 a121, 0
  v_accvgpr_write_b32 a122, 0
  v_accvgpr_write_b32 a123, 0
  v_accvgpr_write_b32 a124, 0
  v_accvgpr_write_b32 a125, 0
  v_accvgpr_write_b32 a126, 0
  v_accvgpr_write_b32 a127, 0
  v_accvgpr_write_b32 a128, 0
  v_accvgpr_write_b32 a129, 0
  v_accvgpr_write_b32 a130, 0
  v_accvgpr_write_b32 a131, 0
  v_accvgpr_write_b32 a132, 0
  v_accvgpr_write_b32 a133, 0
  v_accvgpr_write_b32 a134, 0
  v_accvgpr_write_b32 a135, 0
  v_accvgpr_write_b32 a136, 0
  v_accvgpr_write_b32 a137, 0
  v_accvgpr_write_b32 a138, 0
  v_accvgpr_write_b32 a139, 0
  v_accvgpr_write_b32 a140, 0
  v_accvgpr_write_b32 a141, 0
  v_accvgpr_write_b32 a142, 0
  v_accvgpr_write_b32 a143, 0
  v_accvgpr_write_b32 a144, 0
  v_accvgpr_write_b32 a145, 0
  v_accvgpr_write_b32 a146, 0
  v_accvgpr_write_b32 a147, 0
  v_accvgpr_write_b32 a148, 0
  v_accvgpr_write_b32 a149, 0
  v_accvgpr_write_b32 a150, 0
  v_accvgpr_write_b32 a151, 0
  v_accvgpr_write_b32 a152, 0
  v_accvgpr_write_b32 a153, 0
  v_accvgpr_write_b32 a154, 0
  v_accvgpr_write_b32 a155, 0
  v_accvgpr_write_b32 a156, 0
  v_accvgpr_write_b32 a157, 0
  v_accvgpr_write_b32 a158, 0
  v_accvgpr_write_b32 a159, 0
  v_accvgpr_write_b32 a160, 0
  v_accvgpr_write_b32 a161, 0
  v_accvgpr_write_b32 a162, 0
  v_accvgpr_write_b32 a163, 0
  v_accvgpr_write_b32 a164, 0
  v_accvgpr_write_b32 a165, 0
  v_accvgpr_write_b32 a166, 0
  v_accvgpr_write_b32 a167, 0
  v_accvgpr_write_b32 a168, 0
  v_accvgpr_write_b32 a169, 0
  v_accvgpr_write_b32 a170, 0
  v_accvgpr_write_b32 a171, 0
  v_accvgpr_write_b32 a172, 0
  v_accvgpr_write_b32 a173, 0
  v_accvgpr_write_b32 a174, 0
  v_accvgpr_write_b32 a175, 0
  v_accvgpr_write_b32 a176, 0
  v_accvgpr_write_b32 a177, 0
  v_accvgpr_write_b32 a178, 0
  v_accvgpr_write_b32 a179, 0
  v_mov_b32 v13, 0x3f803f80
  v_accvgpr_write_b32 a180, v13
  v_accvgpr_write_b32 a181, v13
  v_accvgpr_write_b32 a182, v13
  v_accvgpr_write_b32 a183, v13
  s_mov_b32 s5, 0
  s_cmp_lg_u32 s57, 0
  s_cbranch_scc1 K1_G1_GO
  s_lshr_b32 s64, s2, 4
  s_lshl_b32 s64, s64, 3
  s_and_b32 s65, s2, 7
  s_add_u32 s64, s64, s65
  s_cmp_lt_u32 s64, 64
  s_cselect_b32 s16, s12, s22
  s_cselect_b32 s17, s13, s23
  s_and_b32 s17, s17, 0xffff
  s_mov_b32 s18, 4718592
  s_mov_b32 s19, 0x20000
  s_and_b32 s64, s64, 63
  s_lshl_b32 s64, s64, 6
  s_lshl_b32 s65, s56, 4
  s_add_u32 s64, s64, s65
  v_add_u32 v13, 0, v0
  v_mul_u32_u24 v14, 7282, v13
  v_lshrrev_b32 v14, 16, v14
  v_mul_u32_u24 v15, 9, v14
  v_sub_u32 v15, v13, v15
  v_add_u32 v14, s64, v14
  v_mul_u32_u24 v14, 1152, v14
  v_lshl_add_u32 v14, v15, 7, v14
  buffer_load_dword v8, v14, s[16:19], 0 offen
  v_add_u32 v13, 64, v0
  v_mul_u32_u24 v14, 7282, v13
  v_lshrrev_b32 v14, 16, v14
  v_mul_u32_u24 v15, 9, v14
  v_sub_u32 v15, v13, v15
  v_add_u32 v14, s64, v14
  v_mul_u32_u24 v14, 1152, v14
  v_lshl_add_u32 v14, v15, 7, v14
  buffer_load_dword v8, v14, s[16:19], 0 offen
  v_add_u32 v13, 128, v0
  v_mul_u32_u24 v14, 7282, v13
  v_lshrrev_b32 v14, 16, v14
  v_mul_u32_u24 v15, 9, v14
  v_sub_u32 v15, v13, v15
  v_add_u32 v14, s64, v14
  v_mul_u32_u24 v14, 1152, v14
  v_lshl_add_u32 v14, v15, 7, v14
  v_cmp_gt_u32 vcc, 16, v0
  v_mov_b32 v15, 0x40000000
  s_nop 0
  v_cndmask_b32 v14, v15, v14, vcc
  buffer_load_dword v8, v14, s[16:19], 0 offen
  s_add_u32 s66, s3, 0
  s_sub_u32 s67, s66, 18
  s_cmp_ge_u32 s66, 18
  s_cselect_b32 s66, s67, s66
  s_lshl_b32 s69, s66, 18
  s_lshl_b32 s70, s66, 6
  s_mov_b32 m0, s99
  s_nop 0
  buffer_load_dwordx4 v246, s[40:43], s69 offen offset:0 lds
  buffer_load_dwordx4 v247, s[40:43], s69 offen offset:1024 lds
  buffer_load_dwordx4 v248, s[40:43], s69 offen offset:2048 lds
  buffer_load_dwordx4 v249, s[40:43], s69 offen offset:3072 lds
  s_add_u32 m0, s99, 4096
  s_add_u32 s67, s69, 32768
  buffer_load_dwordx4 v246, s[40:43], s67 offen offset:0 lds
  buffer_load_dwordx4 v247, s[40:43], s67 offen offset:1024 lds
  buffer_load_dwordx4 v248, s[40:43], s67 offen offset:2048 lds
  buffer_load_dwordx4 v249, s[40:43], s67 offen offset:3072 lds
  s_mov_b32 m0, s30
  s_nop 0
  buffer_load_dwordx4 v250, s[44:47], s70 offen offset:0 lds
  buffer_load_dwordx4 v251, s[44:47], s70 offen offset:1024 lds
  s_mov_b32 exec_hi, 0
  buffer_load_dwordx4 v252, s[44:47], s70 offen offset:2048 lds
  s_mov_b32 exec_hi, -1
K1_G1_GO:
  s_add_u32 s66, s3, 1
  s_sub_u32 s67, s66, 18
  s_cmp_ge_u32 s66, 18
  s_cselect_b32 s66, s67, s66
  s_lshl_b32 s69, s66, 18
  s_lshl_b32 s70, s66, 6
  s_mov_b32 m0, s100
  s_nop 0
  buffer_load_dwordx4 v246, s[40:43], s69 offen offset:0 lds
  buffer_load_dwordx4 v247, s[40:43], s69 offen offset:1024 lds
  buffer_load_dwordx4 v248, s[40:43], s69 offen offset:2048 lds
  buffer_load_dwordx4 v249, s[40:43], s69 offen offset:3072 lds
  s_add_u32 m0, s100, 4096
  s_add_u32 s67, s69, 32768
  buffer_load_dwordx4 v246, s[40:43], s67 offen offset:0 lds
  buffer_load_dwordx4 v247, s[40:43], s67 offen offset:1024 lds
  buffer_load_dwordx4 v248, s[40:43], s67 offen offset:2048 lds
  buffer_load_dwordx4 v249, s[40:43], s67 offen offset:3072 lds
  s_waitcnt vmcnt(8)
  s_barrier
  ds_read_b64_tr_b16 v[176:177], v228 offset:0
  ds_read_b64_tr_b16 v[178:179], v228 offset:4096
  ds_read_b64_tr_b16 v[180:181], v228 offset:8
  ds_read_b64_tr_b16 v[182:183], v228 offset:4104
  ds_read_b64_tr_b16 v[184:185], v229 offset:0
  ds_read_b64_tr_b16 v[186:187], v229 offset:4096
  ds_read_b64_tr_b16 v[188:189], v229 offset:8
  ds_read_b64_tr_b16 v[190:191], v229 offset:4104
  ds_read_b64_tr_b16 v[192:193], v230 offset:0
  ds_read_b64_tr_b16 v[194:195], v230 offset:4096
  ds_read_b64_tr_b16 v[196:197], v230 offset:8
  ds_read_b64_tr_b16 v[198:199], v230 offset:4104
  ds_read_b128 v[208:211], v240 offset:0
  ds_read_b128 v[212:215], v240 offset:2048
  ds_read_b128 v[216:219], v240 offset:4096
  ds_read_b128 v[220:223], v240 offset:6144
  ds_read_b128 v[224:227], v240 offset:8192
  s_add_u32 s66, s3, 2
  s_sub_u32 s67, s66, 18
  s_cmp_ge_u32 s66, 18
  s_cselect_b32 s66, s67, s66
  s_lshl_b32 s69, s66, 18
  s_lshl_b32 s70, s66, 6
  s_mov_b32 s75, s69
  s_mov_b32 m0, s31
  s_nop 0
  buffer_load_dwordx4 v250, s[44:47], s70 offen offset:0 lds
  buffer_load_dwordx4 v251, s[44:47], s70 offen offset:1024 lds
  s_mov_b32 m0, s101
  s_nop 0
  buffer_load_dwordx4 v246, s[40:43], s69 offen offset:0 lds
  buffer_load_dwordx4 v247, s[40:43], s69 offen offset:1024 lds
  buffer_load_dwordx4 v248, s[40:43], s69 offen offset:2048 lds
  buffer_load_dwordx4 v249, s[40:43], s69 offen offset:3072 lds
  s_add_u32 m0, s101, 4096
  s_add_u32 s67, s69, 32768
  buffer_load_dwordx4 v246, s[40:43], s67 offen offset:0 lds
  buffer_load_dwordx4 v247, s[40:43], s67 offen offset:1024 lds
  buffer_load_dwordx4 v248, s[40:43], s67 offen offset:2048 lds
  buffer_load_dwordx4 v249, s[40:43], s67 offen offset:3072 lds
  s_waitcnt lgkmcnt(0)
  s_mov_b32 s68, 0
K1_QLOOP:
  s_waitcnt lgkmcnt(6)
  v_mfma_f32_16x16x32_bf16 v[16:19], v[176:179], v[208:211], v[16:19]
  s_add_u32 s75, s75, 262144
  v_mfma_f32_16x16x32_bf16 v[20:23], v[180:183], v[208:211], v[20:23]
  s_waitcnt lgkmcnt(3)
  v_mfma_f32_16x16x32_bf16 v[48:51], v[176:179], v[212:215], v[48:51]
  s_cmp_eq_u32 s75, 4718592
  s_cselect_b32 s75, 0, s75
  v_mfma_f32_16x16x32_bf16 v[52:55], v[180:183], v[212:215], v[52:55]
  s_waitcnt lgkmcnt(2)
  v_mfma_f32_16x16x32_bf16 v[80:83], v[176:179], v[216:219], v[80:83]
  s_mov_b32 s69, s75
  v_mfma_f32_16x16x32_bf16 v[84:87], v[180:183], v[216:219], v[84:87]
  s_waitcnt lgkmcnt(1)
  v_mfma_f32_16x16x32_bf16 v[112:115], v[176:179], v[220:223], v[112:115]
  v_mfma_f32_16x16x32_bf16 v[116:119], v[180:183], v[220:223], v[116:119]
  s_waitcnt lgkmcnt(0)
  v_mfma_f32_16x16x32_bf16 v[144:147], v[176:179], v[224:227], v[144:147]
  ds_read_b64_tr_b16 v[200:201], v231 offset:0
  ds_read_b64_tr_b16 v[202:203], v231 offset:4096
  v_mfma_f32_16x16x32_bf16 v[148:151], v[180:183], v[224:227], v[148:151]
  ds_read_b64_tr_b16 v[204:205], v231 offset:8
  ds_read_b64_tr_b16 v[206:207], v231 offset:4104
  v_mfma_f32_16x16x32_bf16 v[24:27], v[184:187], v[208:211], v[24:27]
  v_mfma_f32_16x16x32_bf16 v[28:31], v[188:191], v[208:211], v[28:31]
  v_mfma_f32_16x16x32_bf16 v[56:59], v[184:187], v[212:215], v[56:59]
  v_mfma_f32_16x16x32_bf16 v[60:63], v[188:191], v[212:215], v[60:63]
  v_mfma_f32_16x16x32_bf16 v[88:91], v[184:187], v[216:219], v[88:91]
  s_waitcnt vmcnt(10) lgkmcnt(0)
  s_barrier
  v_mfma_f32_16x16x32_bf16 v[92:95], v[188:191], v[216:219], v[92:95]
  ds_read_b64_tr_b16 v[176:177], v232 offset:0
  ds_read_b64_tr_b16 v[178:179], v232 offset:4096
  v_mfma_f32_16x16x32_bf16 v[120:123], v[184:187], v[220:223], v[120:123]
  ds_read_b64_tr_b16 v[180:181], v232 offset:8
  ds_read_b64_tr_b16 v[182:183], v232 offset:4104
  v_mfma_f32_16x16x32_bf16 v[124:127], v[188:191], v[220:223], v[124:127]
  s_add_u32 m0, s31, 0
  s_nop 0
  v_mfma_f32_16x16x32_bf16 v[152:155], v[184:187], v[224:227], v[152:155]
  s_mov_b32 exec_hi, 0
  buffer_load_dwordx4 v252, s[44:47], s70 offen offset:2048 lds
  s_mov_b32 exec_hi, -1
  v_mfma_f32_16x16x32_bf16 v[156:159], v[188:191], v[224:227], v[156:159]
  v_mfma_f32_16x16x32_bf16 v[32:35], v[192:195], v[208:211], v[32:35]
  ds_read_b64_tr_b16 v[184:185], v233 offset:0
  ds_read_b64_tr_b16 v[186:187], v233 offset:4096
  v_mfma_f32_16x16x32_bf16 v[36:39], v[196:199], v[208:211], v[36:39]
  ds_read_b64_tr_b16 v[188:189], v233 offset:8
  ds_read_b64_tr_b16 v[190:191], v233 offset:4104
  v_mfma_f32_16x16x32_bf16 v[64:67], v[192:195], v[212:215], v[64:67]
  s_mov_b32 m0, s99
  s_nop 0
  v_mfma_f32_16x16x32_bf16 v[68:71], v[196:199], v[212:215], v[68:71]
  buffer_load_dwordx4 v246, s[40:43], s69 offen offset:0 lds
  v_mfma_f32_16x16x32_bf16 v[96:99], v[192:195], v[216:219], v[96:99]
  v_mfma_f32_16x16x32_bf16 v[100:103], v[196:199], v[216:219], v[100:103]
  buffer_load_dwordx4 v247, s[40:43], s69 offen offset:1024 lds
  v_mfma_f32_16x16x32_bf16 v[128:131], v[192:195], v[220:223], v[128:131]
  buffer_load_dwordx4 v248, s[40:43], s69 offen offset:2048 lds
  v_mfma_f32_16x16x32_bf16 v[132:135], v[196:199], v[220:223], v[132:135]
  v_mfma_f32_16x16x32_bf16 v[160:163], v[192:195], v[224:227], v[160:163]
  buffer_load_dwordx4 v249, s[40:43], s69 offen offset:3072 lds
  v_mfma_f32_16x16x32_bf16 v[164:167], v[196:199], v[224:227], v[164:167]
  v_mfma_f32_16x16x32_bf16 v[40:43], v[200:203], v[208:211], v[40:43]
  ds_read_b64_tr_b16 v[192:193], v234 offset:0
  ds_read_b64_tr_b16 v[194:195], v234 offset:4096
  v_mfma_f32_16x16x32_bf16 v[44:47], v[204:207], v[208:211], v[44:47]
  ds_read_b128 v[208:211], v241 offset:0
  s_add_u32 m0, s99, 4096
  v_mfma_f32_16x16x32_bf16 v[72:75], v[200:203], v[212:215], v[72:75]
  ds_read_b64_tr_b16 v[196:197], v234 offset:8
  ds_read_b64_tr_b16 v[198:199], v234 offset:4104
  v_mfma_f32_16x16x32_bf16 v[76:79], v[204:207], v[212:215], v[76:79]
  ds_read_b128 v[212:215], v241 offset:2048
  s_add_u32 s67, s69, 32768
  v_mfma_f32_16x16x32_bf16 v[104:107], v[200:203], v[216:219], v[104:107]
  buffer_load_dwordx4 v246, s[40:43], s67 offen offset:0 lds
  v_mfma_f32_16x16x32_bf16 v[108:111], v[204:207], v[216:219], v[108:111]
  ds_read_b128 v[216:219], v241 offset:4096
  buffer_load_dwordx4 v247, s[40:43], s67 offen offset:1024 lds
  v_mfma_f32_16x16x32_bf16 v[136:139], v[200:203], v[220:223], v[136:139]
  buffer_load_dwordx4 v248, s[40:43], s67 offen offset:2048 lds
  v_mfma_f32_16x16x32_bf16 v[140:143], v[204:207], v[220:223], v[140:143]
  ds_read_b128 v[220:223], v241 offset:6144
  v_mfma_f32_16x16x32_bf16 v[168:171], v[200:203], v[224:227], v[168:171]
  buffer_load_dwordx4 v249, s[40:43], s67 offen offset:3072 lds
  v_mfma_f32_16x16x32_bf16 v[172:175], v[204:207], v[224:227], v[172:175]
  ds_read_b128 v[224:227], v241 offset:8192
  s_waitcnt lgkmcnt(6)
  v_mfma_f32_16x16x32_bf16 v[16:19], v[176:179], v[208:211], v[16:19]
  s_add_u32 s75, s75, 262144
  v_mfma_f32_16x16x32_bf16 v[20:23], v[180:183], v[208:211], v[20:23]
  s_waitcnt lgkmcnt(3)
  v_mfma_f32_16x16x32_bf16 v[48:51], v[176:179], v[212:215], v[48:51]
  s_cmp_eq_u32 s75, 4718592
  s_cselect_b32 s75, 0, s75
  v_mfma_f32_16x16x32_bf16 v[52:55], v[180:183], v[212:215], v[52:55]
  s_waitcnt lgkmcnt(2)
  v_mfma_f32_16x16x32_bf16 v[80:83], v[176:179], v[216:219], v[80:83]
  s_lshr_b32 s70, s75, 12
  s_mov_b32 s69, s75
  v_mfma_f32_16x16x32_bf16 v[84:87], v[180:183], v[216:219], v[84:87]
  s_waitcnt lgkmcnt(1)
  v_mfma_f32_16x16x32_bf16 v[112:115], v[176:179], v[220:223], v[112:115]
  v_mfma_f32_16x16x32_bf16 v[116:119], v[180:183], v[220:223], v[116:119]
  s_waitcnt lgkmcnt(0)
  v_mfma_f32_16x16x32_bf16 v[144:147], v[176:179], v[224:227], v[144:147]
  ds_read_b64_tr_b16 v[200:201], v235 offset:0
  ds_read_b64_tr_b16 v[202:203], v235 offset:4096
  v_mfma_f32_16x16x32_bf16 v[148:151], v[180:183], v[224:227], v[148:151]
  ds_read_b64_tr_b16 v[204:205], v235 offset:8
  ds_read_b64_tr_b16 v[206:207], v235 offset:4104
  v_mfma_f32_16x16x32_bf16 v[24:27], v[184:187], v[208:211], v[24:27]
  v_mfma_f32_16x16x32_bf16 v[28:31], v[188:191], v[208:211], v[28:31]
  v_mfma_f32_16x16x32_bf16 v[56:59], v[184:187], v[212:215], v[56:59]
  v_mfma_f32_16x16x32_bf16 v[60:63], v[188:191], v[212:215], v[60:63]
  v_mfma_f32_16x16x32_bf16 v[88:91], v[184:187], v[216:219], v[88:91]
  s_waitcnt vmcnt(8) lgkmcnt(0)
  s_barrier
  v_mfma_f32_16x16x32_bf16 v[92:95], v[188:191], v[216:219], v[92:95]
  ds_read_b64_tr_b16 v[176:177], v236 offset:0
  ds_read_b64_tr_b16 v[178:179], v236 offset:4096
  v_mfma_f32_16x16x32_bf16 v[120:123], v[184:187], v[220:223], v[120:123]
  ds_read_b64_tr_b16 v[180:181], v236 offset:8
  ds_read_b64_tr_b16 v[182:183], v236 offset:4104
  v_mfma_f32_16x16x32_bf16 v[124:127], v[188:191], v[220:223], v[124:127]
  s_mov_b32 m0, s63
  v_mfma_f32_16x16x32_bf16 v[152:155], v[184:187], v[224:227], v[152:155]
  s_nop 0
  v_mfma_f32_16x16x32_bf16 v[156:159], v[188:191], v[224:227], v[156:159]
  buffer_load_dwordx4 v250, s[44:47], s70 offen offset:0 lds
  v_mfma_f32_16x16x32_bf16 v[32:35], v[192:195], v[208:211], v[32:35]
  ds_read_b64_tr_b16 v[184:185], v237 offset:0
  ds_read_b64_tr_b16 v[186:187], v237 offset:4096
  v_mfma_f32_16x16x32_bf16 v[36:39], v[196:199], v[208:211], v[36:39]
  ds_read_b64_tr_b16 v[188:189], v237 offset:8
  ds_read_b64_tr_b16 v[190:191], v237 offset:4104
  v_mfma_f32_16x16x32_bf16 v[64:67], v[192:195], v[212:215], v[64:67]
  buffer_load_dwordx4 v251, s[44:47], s70 offen offset:1024 lds
  s_mov_b32 m0, s100
  v_mfma_f32_16x16x32_bf16 v[68:71], v[196:199], v[212:215], v[68:71]
  v_mfma_f32_16x16x32_bf16 v[96:99], v[192:195], v[216:219], v[96:99]
  s_nop 0
  v_mfma_f32_16x16x32_bf16 v[100:103], v[196:199], v[216:219], v[100:103]
  buffer_load_dwordx4 v246, s[40:43], s69 offen offset:0 lds
  v_mfma_f32_16x16x32_bf16 v[128:131], v[192:195], v[220:223], v[128:131]
  v_mfma_f32_16x16x32_bf16 v[132:135], v[196:199], v[220:223], v[132:135]
  buffer_load_dwordx4 v247, s[40:43], s69 offen offset:1024 lds
  v_mfma_f32_16x16x32_bf16 v[160:163], v[192:195], v[224:227], v[160:163]
  buffer_load_dwordx4 v248, s[40:43], s69 offen offset:2048 lds
  v_mfma_f32_16x16x32_bf16 v[164:167], v[196:199], v[224:227], v[164:167]
  buffer_load_dwordx4 v249, s[40:43], s69 offen offset:3072 lds
  v_mfma_f32_16x16x32_bf16 v[40:43], v[200:203], v[208:211], v[40:43]
  ds_read_b64_tr_b16 v[192:193], v238 offset:0
  ds_read_b64_tr_b16 v[194:195], v238 offset:4096
  v_mfma_f32_16x16x32_bf16 v[44:47], v[204:207], v[208:211], v[44:47]
  ds_read_b128 v[208:211], v242 offset:0
  s_add_u32 m0, s100, 4096
  v_mfma_f32_16x16x32_bf16 v[72:75], v[200:203], v[212:215], v[72:75]
  ds_read_b64_tr_b16 v[196:197], v238 offset:8
  ds_read_b64_tr_b16 v[198:199], v238 offset:4104
  v_mfma_f32_16x16x32_bf16 v[76:79], v[204:207], v[212:215], v[76:79]
  ds_read_b128 v[212:215], v242 offset:2048
  s_add_u32 s67, s69, 32768
  v_mfma_f32_16x16x32_bf16 v[104:107], v[200:203], v[216:219], v[104:107]
  buffer_load_dwordx4 v246, s[40:43], s67 offen offset:0 lds
  v_mfma_f32_16x16x32_bf16 v[108:111], v[204:207], v[216:219], v[108:111]
  ds_read_b128 v[216:219], v242 offset:4096
  buffer_load_dwordx4 v247, s[40:43], s67 offen offset:1024 lds
  v_mfma_f32_16x16x32_bf16 v[136:139], v[200:203], v[220:223], v[136:139]
  v_mfma_f32_16x16x32_bf16 v[140:143], v[204:207], v[220:223], v[140:143]
  ds_read_b128 v[220:223], v242 offset:6144
  buffer_load_dwordx4 v248, s[40:43], s67 offen offset:2048 lds
  v_mfma_f32_16x16x32_bf16 v[168:171], v[200:203], v[224:227], v[168:171]
  buffer_load_dwordx4 v249, s[40:43], s67 offen offset:3072 lds
  v_mfma_f32_16x16x32_bf16 v[172:175], v[204:207], v[224:227], v[172:175]
  ds_read_b128 v[224:227], v242 offset:8192
  s_waitcnt lgkmcnt(6)
  v_mfma_f32_16x16x32_bf16 v[16:19], v[176:179], v[208:211], v[16:19]
  s_add_u32 s75, s75, 262144
  v_mfma_f32_16x16x32_bf16 v[20:23], v[180:183], v[208:211], v[20:23]
  s_waitcnt lgkmcnt(3)
  v_mfma_f32_16x16x32_bf16 v[48:51], v[176:179], v[212:215], v[48:51]
  s_cmp_eq_u32 s75, 4718592
  s_cselect_b32 s75, 0, s75
  v_mfma_f32_16x16x32_bf16 v[52:55], v[180:183], v[212:215], v[52:55]
  s_waitcnt lgkmcnt(2)
  v_mfma_f32_16x16x32_bf16 v[80:83], v[176:179], v[216:219], v[80:83]
  s_mov_b32 s69, s75
  v_mfma_f32_16x16x32_bf16 v[84:87], v[180:183], v[216:219], v[84:87]
  s_waitcnt lgkmcnt(1)
  v_mfma_f32_16x16x32_bf16 v[112:115], v[176:179], v[220:223], v[112:115]
  v_mfma_f32_16x16x32_bf16 v[116:119], v[180:183], v[220:223], v[116:119]
  s_waitcnt lgkmcnt(0)
  v_mfma_f32_16x16x32_bf16 v[144:147], v[176:179], v[224:227], v[144:147]
  ds_read_b64_tr_b16 v[200:201], v239 offset:0
  ds_read_b64_tr_b16 v[202:203], v239 offset:4096
  v_mfma_f32_16x16x32_bf16 v[148:151], v[180:183], v[224:227], v[148:151]
  ds_read_b64_tr_b16 v[204:205], v239 offset:8
  ds_read_b64_tr_b16 v[206:207], v239 offset:4104
  v_mfma_f32_16x16x32_bf16 v[24:27], v[184:187], v[208:211], v[24:27]
  v_mfma_f32_16x16x32_bf16 v[28:31], v[188:191], v[208:211], v[28:31]
  v_mfma_f32_16x16x32_bf16 v[56:59], v[184:187], v[212:215], v[56:59]
  v_mfma_f32_16x16x32_bf16 v[60:63], v[188:191], v[212:215], v[60:63]
  v_mfma_f32_16x16x32_bf16 v[88:91], v[184:187], v[216:219], v[88:91]
  s_waitcnt vmcnt(10) lgkmcnt(0)
  s_barrier
  v_mfma_f32_16x16x32_bf16 v[92:95], v[188:191], v[216:219], v[92:95]
  ds_read_b64_tr_b16 v[176:177], v228 offset:0
  ds_read_b64_tr_b16 v[178:179], v228 offset:4096
  v_mfma_f32_16x16x32_bf16 v[120:123], v[184:187], v[220:223], v[120:123]
  ds_read_b64_tr_b16 v[180:181], v228 offset:8
  ds_read_b64_tr_b16 v[182:183], v228 offset:4104
  v_mfma_f32_16x16x32_bf16 v[124:127], v[188:191], v[220:223], v[124:127]
  s_add_u32 m0, s63, 0
  s_nop 0
  v_mfma_f32_16x16x32_bf16 v[152:155], v[184:187], v[224:227], v[152:155]
  s_mov_b32 exec_hi, 0
  buffer_load_dwordx4 v252, s[44:47], s70 offen offset:2048 lds
  s_mov_b32 exec_hi, -1
  v_mfma_f32_16x16x32_bf16 v[156:159], v[188:191], v[224:227], v[156:159]
  v_mfma_f32_16x16x32_bf16 v[32:35], v[192:195], v[208:211], v[32:35]
  ds_read_b64_tr_b16 v[184:185], v229 offset:0
  ds_read_b64_tr_b16 v[186:187], v229 offset:4096
  v_mfma_f32_16x16x32_bf16 v[36:39], v[196:199], v[208:211], v[36:39]
  ds_read_b64_tr_b16 v[188:189], v229 offset:8
  ds_read_b64_tr_b16 v[190:191], v229 offset:4104
  v_mfma_f32_16x16x32_bf16 v[64:67], v[192:195], v[212:215], v[64:67]
  s_mov_b32 m0, s101
  s_nop 0
  v_mfma_f32_16x16x32_bf16 v[68:71], v[196:199], v[212:215], v[68:71]
  buffer_load_dwordx4 v246, s[40:43], s69 offen offset:0 lds
  v_mfma_f32_16x16x32_bf16 v[96:99], v[192:195], v[216:219], v[96:99]
  v_mfma_f32_16x16x32_bf16 v[100:103], v[196:199], v[216:219], v[100:103]
  buffer_load_dwordx4 v247, s[40:43], s69 offen offset:1024 lds
  v_mfma_f32_16x16x32_bf16 v[128:131], v[192:195], v[220:223], v[128:131]
  buffer_load_dwordx4 v248, s[40:43], s69 offen offset:2048 lds
  v_mfma_f32_16x16x32_bf16 v[132:135], v[196:199], v[220:223], v[132:135]
  v_mfma_f32_16x16x32_bf16 v[160:163], v[192:195], v[224:227], v[160:163]
  buffer_load_dwordx4 v249, s[40:43], s69 offen offset:3072 lds
  v_mfma_f32_16x16x32_bf16 v[164:167], v[196:199], v[224:227], v[164:167]
  v_mfma_f32_16x16x32_bf16 v[40:43], v[200:203], v[208:211], v[40:43]
  ds_read_b64_tr_b16 v[192:193], v230 offset:0
  ds_read_b64_tr_b16 v[194:195], v230 offset:4096
  v_mfma_f32_16x16x32_bf16 v[44:47], v[204:207], v[208:211], v[44:47]
  ds_read_b128 v[208:211], v243 offset:0
  s_add_u32 m0, s101, 4096
  v_mfma_f32_16x16x32_bf16 v[72:75], v[200:203], v[212:215], v[72:75]
  ds_read_b64_tr_b16 v[196:197], v230 offset:8
  ds_read_b64_tr_b16 v[198:199], v230 offset:4104
  v_mfma_f32_16x16x32_bf16 v[76:79], v[204:207], v[212:215], v[76:79]
  ds_read_b128 v[212:215], v243 offset:2048
  s_add_u32 s67, s69, 32768
  v_mfma_f32_16x16x32_bf16 v[104:107], v[200:203], v[216:219], v[104:107]
  buffer_load_dwordx4 v246, s[40:43], s67 offen offset:0 lds
  v_mfma_f32_16x16x32_bf16 v[108:111], v[204:207], v[216:219], v[108:111]
  ds_read_b128 v[216:219], v243 offset:4096
  buffer_load_dwordx4 v247, s[40:43], s67 offen offset:1024 lds
  v_mfma_f32_16x16x32_bf16 v[136:139], v[200:203], v[220:223], v[136:139]
  buffer_load_dwordx4 v248, s[40:43], s67 offen offset:2048 lds
  v_mfma_f32_16x16x32_bf16 v[140:143], v[204:207], v[220:223], v[140:143]
  ds_read_b128 v[220:223], v243 offset:6144
  v_mfma_f32_16x16x32_bf16 v[168:171], v[200:203], v[224:227], v[168:171]
  buffer_load_dwordx4 v249, s[40:43], s67 offen offset:3072 lds
  v_mfma_f32_16x16x32_bf16 v[172:175], v[204:207], v[224:227], v[172:175]
  ds_read_b128 v[224:227], v243 offset:8192
  s_waitcnt lgkmcnt(6)
  v_mfma_f32_16x16x32_bf16 v[16:19], v[176:179], v[208:211], v[16:19]
  s_add_u32 s75, s75, 262144
  v_mfma_f32_16x16x32_bf16 v[20:23], v[180:183], v[208:211], v[20:23]
  s_waitcnt lgkmcnt(3)
  v_mfma_f32_16x16x32_bf16 v[48:51], v[176:179], v[212:215], v[48:51]
  s_cmp_eq_u32 s75, 4718592
  s_cselect_b32 s75, 0, s75
  v_mfma_f32_16x16x32_bf16 v[52:55], v[180:183], v[212:215], v[52:55]
  s_waitcnt lgkmcnt(2)
  v_mfma_f32_16x16x32_bf16 v[80:83], v[176:179], v[216:219], v[80:83]
  s_lshr_b32 s70, s75, 12
  s_mov_b32 s69, s75
  v_mfma_f32_16x16x32_bf16 v[84:87], v[180:183], v[216:219], v[84:87]
  s_waitcnt lgkmcnt(1)
  v_mfma_f32_16x16x32_bf16 v[112:115], v[176:179], v[220:223], v[112:115]
  v_mfma_f32_16x16x32_bf16 v[116:119], v[180:183], v[220:223], v[116:119]
  s_waitcnt lgkmcnt(0)
  v_mfma_f32_16x16x32_bf16 v[144:147], v[176:179], v[224:227], v[144:147]
  ds_read_b64_tr_b16 v[200:201], v231 offset:0
  ds_read_b64_tr_b16 v[202:203], v231 offset:4096
  v_mfma_f32_16x16x32_bf16 v[148:151], v[180:183], v[224:227], v[148:151]
  ds_read_b64_tr_b16 v[204:205], v231 offset:8
  ds_read_b64_tr_b16 v[206:207], v231 offset:4104
  v_mfma_f32_16x16x32_bf16 v[24:27], v[184:187], v[208:211], v[24:27]
  v_mfma_f32_16x16x32_bf16 v[28:31], v[188:191], v[208:211], v[28:31]
  v_mfma_f32_16x16x32_bf16 v[56:59], v[184:187], v[212:215], v[56:59]
  v_mfma_f32_16x16x32_bf16 v[60:63], v[188:191], v[212:215], v[60:63]
  v_mfma_f32_16x16x32_bf16 v[88:91], v[184:187], v[216:219], v[88:91]
  s_waitcnt vmcnt(8) lgkmcnt(0)
  s_barrier
  v_mfma_f32_16x16x32_bf16 v[92:95], v[188:191], v[216:219], v[92:95]
  ds_read_b64_tr_b16 v[176:177], v232 offset:0
  ds_read_b64_tr_b16 v[178:179], v232 offset:4096
  v_mfma_f32_16x16x32_bf16 v[120:123], v[184:187], v[220:223], v[120:123]
  ds_read_b64_tr_b16 v[180:181], v232 offset:8
  ds_read_b64_tr_b16 v[182:183], v232 offset:4104
  v_mfma_f32_16x16x32_bf16 v[124:127], v[188:191], v[220:223], v[124:127]
  s_mov_b32 m0, s30
  v_mfma_f32_16x16x32_bf16 v[152:155], v[184:187], v[224:227], v[152:155]
  s_nop 0
  v_mfma_f32_16x16x32_bf16 v[156:159], v[188:191], v[224:227], v[156:159]
  buffer_load_dwordx4 v250, s[44:47], s70 offen offset:0 lds
  v_mfma_f32_16x16x32_bf16 v[32:35], v[192:195], v[208:211], v[32:35]
  ds_read_b64_tr_b16 v[184:185], v233 offset:0
  ds_read_b64_tr_b16 v[186:187], v233 offset:4096
  v_mfma_f32_16x16x32_bf16 v[36:39], v[196:199], v[208:211], v[36:39]
  ds_read_b64_tr_b16 v[188:189], v233 offset:8
  ds_read_b64_tr_b16 v[190:191], v233 offset:4104
  v_mfma_f32_16x16x32_bf16 v[64:67], v[192:195], v[212:215], v[64:67]
  buffer_load_dwordx4 v251, s[44:47], s70 offen offset:1024 lds
  s_mov_b32 m0, s99
  v_mfma_f32_16x16x32_bf16 v[68:71], v[196:199], v[212:215], v[68:71]
  v_mfma_f32_16x16x32_bf16 v[96:99], v[192:195], v[216:219], v[96:99]
  s_nop 0
  v_mfma_f32_16x16x32_bf16 v[100:103], v[196:199], v[216:219], v[100:103]
  buffer_load_dwordx4 v246, s[40:43], s69 offen offset:0 lds
  v_mfma_f32_16x16x32_bf16 v[128:131], v[192:195], v[220:223], v[128:131]
  v_mfma_f32_16x16x32_bf16 v[132:135], v[196:199], v[220:223], v[132:135]
  buffer_load_dwordx4 v247, s[40:43], s69 offen offset:1024 lds
  v_mfma_f32_16x16x32_bf16 v[160:163], v[192:195], v[224:227], v[160:163]
  buffer_load_dwordx4 v248, s[40:43], s69 offen offset:2048 lds
  v_mfma_f32_16x16x32_bf16 v[164:167], v[196:199], v[224:227], v[164:167]
  buffer_load_dwordx4 v249, s[40:43], s69 offen offset:3072 lds
  v_mfma_f32_16x16x32_bf16 v[40:43], v[200:203], v[208:211], v[40:43]
  ds_read_b64_tr_b16 v[192:193], v234 offset:0
  ds_read_b64_tr_b16 v[194:195], v234 offset:4096
  v_mfma_f32_16x16x32_bf16 v[44:47], v[204:207], v[208:211], v[44:47]
  ds_read_b128 v[208:211], v244 offset:0
  s_add_u32 m0, s99, 4096
  v_mfma_f32_16x16x32_bf16 v[72:75], v[200:203], v[212:215], v[72:75]
  ds_read_b64_tr_b16 v[196:197], v234 offset:8
  ds_read_b64_tr_b16 v[198:199], v234 offset:4104
  v_mfma_f32_16x16x32_bf16 v[76:79], v[204:207], v[212:215], v[76:79]
  ds_read_b128 v[212:215], v244 offset:2048
  s_add_u32 s67, s69, 32768
  v_mfma_f32_16x16x32_bf16 v[104:107], v[200:203], v[216:219], v[104:107]
  buffer_load_dwordx4 v246, s[40:43], s67 offen offset:0 lds
  v_mfma_f32_16x16x32_bf16 v[108:111], v[204:207], v[216:219], v[108:111]
  ds_read_b128 v[216:219], v244 offset:4096
  buffer_load_dwordx4 v247, s[40:43], s67 offen offset:1024 lds
  v_mfma_f32_16x16x32_bf16 v[136:139], v[200:203], v[220:223], v[136:139]
  v_mfma_f32_16x16x32_bf16 v[140:143], v[204:207], v[220:223], v[140:143]
  ds_read_b128 v[220:223], v244 offset:6144
  buffer_load_dwordx4 v248, s[40:43], s67 offen offset:2048 lds
  v_mfma_f32_16x16x32_bf16 v[168:171], v[200:203], v[224:227], v[168:171]
  buffer_load_dwordx4 v249, s[40:43], s67 offen offset:3072 lds
  v_mfma_f32_16x16x32_bf16 v[172:175], v[204:207], v[224:227], v[172:175]
  ds_read_b128 v[224:227], v244 offset:8192
  s_waitcnt lgkmcnt(6)
  v_mfma_f32_16x16x32_bf16 v[16:19], v[176:179], v[208:211], v[16:19]
  s_add_u32 s75, s75, 262144
  v_mfma_f32_16x16x32_bf16 v[20:23], v[180:183], v[208:211], v[20:23]
  s_waitcnt lgkmcnt(3)
  v_mfma_f32_16x16x32_bf16 v[48:51], v[176:179], v[212:215], v[48:51]
  s_cmp_eq_u32 s75, 4718592
  s_cselect_b32 s75, 0, s75
  v_mfma_f32_16x16x32_bf16 v[52:55], v[180:183], v[212:215], v[52:55]
  s_waitcnt lgkmcnt(2)
  v_mfma_f32_16x16x32_bf16 v[80:83], v[176:179], v[216:219], v[80:83]
  s_mov_b32 s69, s75
  v_mfma_f32_16x16x32_bf16 v[84:87], v[180:183], v[216:219], v[84:87]
  s_waitcnt lgkmcnt(1)
  v_mfma_f32_16x16x32_bf16 v[112:115], v[176:179], v[220:223], v[112:115]
  v_mfma_f32_16x16x32_bf16 v[116:119], v[180:183], v[220:223], v[116:119]
  s_waitcnt lgkmcnt(0)
  v_mfma_f32_16x16x32_bf16 v[144:147], v[176:179], v[224:227], v[144:147]
  ds_read_b64_tr_b16 v[200:201], v235 offset:0
  ds_read_b64_tr_b16 v[202:203], v235 offset:4096
  v_mfma_f32_16x16x32_bf16 v[148:151], v[180:183], v[224:227], v[148:151]
  ds_read_b64_tr_b16 v[204:205], v235 offset:8
  ds_read_b64_tr_b16 v[206:207], v235 offset:4104
  v_mfma_f32_16x16x32_bf16 v[24:27], v[184:187], v[208:211], v[24:27]
  v_mfma_f32_16x16x32_bf16 v[28:31], v[188:191], v[208:211], v[28:31]
  v_mfma_f32_16x16x32_bf16 v[56:59], v[184:187], v[212:215], v[56:59]
  v_mfma_f32_16x16x32_bf16 v[60:63], v[188:191], v[212:215], v[60:63]
  v_mfma_f32_16x16x32_bf16 v[88:91], v[184:187], v[216:219], v[88:91]
  s_waitcnt vmcnt(10) lgkmcnt(0)
  s_barrier
  v_mfma_f32_16x16x32_bf16 v[92:95], v[188:191], v[216:219], v[92:95]
  ds_read_b64_tr_b16 v[176:177], v236 offset:0
  ds_read_b64_tr_b16 v[178:179], v236 offset:4096
  v_mfma_f32_16x16x32_bf16 v[120:123], v[184:187], v[220:223], v[120:123]
  ds_read_b64_tr_b16 v[180:181], v236 offset:8
  ds_read_b64_tr_b16 v[182:183], v236 offset:4104
  v_mfma_f32_16x16x32_bf16 v[124:127], v[188:191], v[220:223], v[124:127]
  s_add_u32 m0, s30, 0
  s_nop 0
  v_mfma_f32_16x16x32_bf16 v[152:155], v[184:187], v[224:227], v[152:155]
  s_mov_b32 exec_hi, 0
  buffer_load_dwordx4 v252, s[44:47], s70 offen offset:2048 lds
  s_mov_b32 exec_hi, -1
  v_mfma_f32_16x16x32_bf16 v[156:159], v[188:191], v[224:227], v[156:159]
  v_mfma_f32_16x16x32_bf16 v[32:35], v[192:195], v[208:211], v[32:35]
  ds_read_b64_tr_b16 v[184:185], v237 offset:0
  ds_read_b64_tr_b16 v[186:187], v237 offset:4096
  v_mfma_f32_16x16x32_bf16 v[36:39], v[196:199], v[208:211], v[36:39]
  ds_read_b64_tr_b16 v[188:189], v237 offset:8
  ds_read_b64_tr_b16 v[190:191], v237 offset:4104
  v_mfma_f32_16x16x32_bf16 v[64:67], v[192:195], v[212:215], v[64:67]
  s_mov_b32 m0, s100
  s_nop 0
  v_mfma_f32_16x16x32_bf16 v[68:71], v[196:199], v[212:215], v[68:71]
  buffer_load_dwordx4 v246, s[40:43], s69 offen offset:0 lds
  v_mfma_f32_16x16x32_bf16 v[96:99], v[192:195], v[216:219], v[96:99]
  v_mfma_f32_16x16x32_bf16 v[100:103], v[196:199], v[216:219], v[100:103]
  buffer_load_dwordx4 v247, s[40:43], s69 offen offset:1024 lds
  v_mfma_f32_16x16x32_bf16 v[128:131], v[192:195], v[220:223], v[128:131]
  buffer_load_dwordx4 v248, s[40:43], s69 offen offset:2048 lds
  v_mfma_f32_16x16x32_bf16 v[132:135], v[196:199], v[220:223], v[132:135]
  v_mfma_f32_16x16x32_bf16 v[160:163], v[192:195], v[224:227], v[160:163]
  buffer_load_dwordx4 v249, s[40:43], s69 offen offset:3072 lds
  v_mfma_f32_16x16x32_bf16 v[164:167], v[196:199], v[224:227], v[164:167]
  v_mfma_f32_16x16x32_bf16 v[40:43], v[200:203], v[208:211], v[40:43]
  ds_read_b64_tr_b16 v[192:193], v238 offset:0
  ds_read_b64_tr_b16 v[194:195], v238 offset:4096
  v_mfma_f32_16x16x32_bf16 v[44:47], v[204:207], v[208:211], v[44:47]
  ds_read_b128 v[208:211], v245 offset:0
  s_add_u32 m0, s100, 4096
  v_mfma_f32_16x16x32_bf16 v[72:75], v[200:203], v[212:215], v[72:75]
  ds_read_b64_tr_b16 v[196:197], v238 offset:8
  ds_read_b64_tr_b16 v[198:199], v238 offset:4104
  v_mfma_f32_16x16x32_bf16 v[76:79], v[204:207], v[212:215], v[76:79]
  ds_read_b128 v[212:215], v245 offset:2048
  s_add_u32 s67, s69, 32768
  v_mfma_f32_16x16x32_bf16 v[104:107], v[200:203], v[216:219], v[104:107]
  buffer_load_dwordx4 v246, s[40:43], s67 offen offset:0 lds
  v_mfma_f32_16x16x32_bf16 v[108:111], v[204:207], v[216:219], v[108:111]
  ds_read_b128 v[216:219], v245 offset:4096
  buffer_load_dwordx4 v247, s[40:43], s67 offen offset:1024 lds
  v_mfma_f32_16x16x32_bf16 v[136:139], v[200:203], v[220:223], v[136:139]
  buffer_load_dwordx4 v248, s[40:43], s67 offen offset:2048 lds
  v_mfma_f32_16x16x32_bf16 v[140:143], v[204:207], v[220:223], v[140:143]
  ds_read_b128 v[220:223], v245 offset:6144
  v_mfma_f32_16x16x32_bf16 v[168:171], v[200:203], v[224:227], v[168:171]
  buffer_load_dwordx4 v249, s[40:43], s67 offen offset:3072 lds
  v_mfma_f32_16x16x32_bf16 v[172:175], v[204:207], v[224:227], v[172:175]
  ds_read_b128 v[224:227], v245 offset:8192
  s_waitcnt lgkmcnt(6)
  v_mfma_f32_16x16x32_bf16 v[16:19], v[176:179], v[208:211], v[16:19]
  s_add_u32 s75, s75, 262144
  v_mfma_f32_16x16x32_bf16 v[20:23], v[180:183], v[208:211], v[20:23]
  s_waitcnt lgkmcnt(3)
  v_mfma_f32_16x16x32_bf16 v[48:51], v[176:179], v[212:215], v[48:51]
  s_cmp_eq_u32 s75, 4718592
  s_cselect_b32 s75, 0, s75
  v_mfma_f32_16x16x32_bf16 v[52:55], v[180:183], v[212:215], v[52:55]
  s_waitcnt lgkmcnt(2)
  v_mfma_f32_16x16x32_bf16 v[80:83], v[176:179], v[216:219], v[80:83]
  s_lshr_b32 s70, s75, 12
  s_mov_b32 s69, s75
  v_mfma_f32_16x16x32_bf16 v[84:87], v[180:183], v[216:219], v[84:87]
  s_waitcnt lgkmcnt(1)
  v_mfma_f32_16x16x32_bf16 v[112:115], v[176:179], v[220:223], v[112:115]
  v_mfma_f32_16x16x32_bf16 v[116:119], v[180:183], v[220:223], v[116:119]
  s_waitcnt lgkmcnt(0)
  v_mfma_f32_16x16x32_bf16 v[144:147], v[176:179], v[224:227], v[144:147]
  ds_read_b64_tr_b16 v[200:201], v239 offset:0
  ds_read_b64_tr_b16 v[202:203], v239 offset:4096
  v_mfma_f32_16x16x32_bf16 v[148:151], v[180:183], v[224:227], v[148:151]
  ds_read_b64_tr_b16 v[204:205], v239 offset:8
  ds_read_b64_tr_b16 v[206:207], v239 offset:4104
  v_mfma_f32_16x16x32_bf16 v[24:27], v[184:187], v[208:211], v[24:27]
  v_mfma_f32_16x16x32_bf16 v[28:31], v[188:191], v[208:211], v[28:31]
  v_mfma_f32_16x16x32_bf16 v[56:59], v[184:187], v[212:215], v[56:59]
  v_mfma_f32_16x16x32_bf16 v[60:63], v[188:191], v[212:215], v[60:63]
  v_mfma_f32_16x16x32_bf16 v[88:91], v[184:187], v[216:219], v[88:91]
  s_waitcnt vmcnt(8) lgkmcnt(0)
  s_barrier
  v_mfma_f32_16x16x32_bf16 v[92:95], v[188:191], v[216:219], v[92:95]
  ds_read_b64_tr_b16 v[176:177], v228 offset:0
  ds_read_b64_tr_b16 v[178:179], v228 offset:4096
  v_mfma_f32_16x16x32_bf16 v[120:123], v[184:187], v[220:223], v[120:123]
  ds_read_b64_tr_b16 v[180:181], v228 offset:8
  ds_read_b64_tr_b16 v[182:183], v228 offset:4104
  v_mfma_f32_16x16x32_bf16 v[124:127], v[188:191], v[220:223], v[124:127]
  s_mov_b32 m0, s31
  v_mfma_f32_16x16x32_bf16 v[152:155], v[184:187], v[224:227], v[152:155]
  s_nop 0
  v_mfma_f32_16x16x32_bf16 v[156:159], v[188:191], v[224:227], v[156:159]
  buffer_load_dwordx4 v250, s[44:47], s70 offen offset:0 lds
  v_mfma_f32_16x16x32_bf16 v[32:35], v[192:195], v[208:211], v[32:35]
  ds_read_b64_tr_b16 v[184:185], v229 offset:0
  ds_read_b64_tr_b16 v[186:187], v229 offset:4096
  v_mfma_f32_16x16x32_bf16 v[36:39], v[196:199], v[208:211], v[36:39]
  ds_read_b64_tr_b16 v[188:189], v229 offset:8
  ds_read_b64_tr_b16 v[190:191], v229 offset:4104
  v_mfma_f32_16x16x32_bf16 v[64:67], v[192:195], v[212:215], v[64:67]
  buffer_load_dwordx4 v251, s[44:47], s70 offen offset:1024 lds
  s_mov_b32 m0, s101
  v_mfma_f32_16x16x32_bf16 v[68:71], v[196:199], v[212:215], v[68:71]
  v_mfma_f32_16x16x32_bf16 v[96:99], v[192:195], v[216:219], v[96:99]
  s_nop 0
  v_mfma_f32_16x16x32_bf16 v[100:103], v[196:199], v[216:219], v[100:103]
  buffer_load_dwordx4 v246, s[40:43], s69 offen offset:0 lds
  v_mfma_f32_16x16x32_bf16 v[128:131], v[192:195], v[220:223], v[128:131]
  v_mfma_f32_16x16x32_bf16 v[132:135], v[196:199], v[220:223], v[132:135]
  buffer_load_dwordx4 v247, s[40:43], s69 offen offset:1024 lds
  v_mfma_f32_16x16x32_bf16 v[160:163], v[192:195], v[224:227], v[160:163]
  buffer_load_dwordx4 v248, s[40:43], s69 offen offset:2048 lds
  v_mfma_f32_16x16x32_bf16 v[164:167], v[196:199], v[224:227], v[164:167]
  buffer_load_dwordx4 v249, s[40:43], s69 offen offset:3072 lds
  v_mfma_f32_16x16x32_bf16 v[40:43], v[200:203], v[208:211], v[40:43]
  ds_read_b64_tr_b16 v[192:193], v230 offset:0
  ds_read_b64_tr_b16 v[194:195], v230 offset:4096
  v_mfma_f32_16x16x32_bf16 v[44:47], v[204:207], v[208:211], v[44:47]
  ds_read_b128 v[208:211], v240 offset:0
  s_add_u32 m0, s101, 4096
  v_mfma_f32_16x16x32_bf16 v[72:75], v[200:203], v[212:215], v[72:75]
  ds_read_b64_tr_b16 v[196:197], v230 offset:8
  ds_read_b64_tr_b16 v[198:199], v230 offset:4104
  v_mfma_f32_16x16x32_bf16 v[76:79], v[204:207], v[212:215], v[76:79]
  ds_read_b128 v[212:215], v240 offset:2048
  s_add_u32 s67, s69, 32768
  v_mfma_f32_16x16x32_bf16 v[104:107], v[200:203], v[216:219], v[104:107]
  buffer_load_dwordx4 v246, s[40:43], s67 offen offset:0 lds
  v_mfma_f32_16x16x32_bf16 v[108:111], v[204:207], v[216:219], v[108:111]
  ds_read_b128 v[216:219], v240 offset:4096
  buffer_load_dwordx4 v247, s[40:43], s67 offen offset:1024 lds
  v_mfma_f32_16x16x32_bf16 v[136:139], v[200:203], v[220:223], v[136:139]
  v_mfma_f32_16x16x32_bf16 v[140:143], v[204:207], v[220:223], v[140:143]
  ds_read_b128 v[220:223], v240 offset:6144
  buffer_load_dwordx4 v248, s[40:43], s67 offen offset:2048 lds
  v_mfma_f32_16x16x32_bf16 v[168:171], v[200:203], v[224:227], v[168:171]
  buffer_load_dwordx4 v249, s[40:43], s67 offen offset:3072 lds
  v_mfma_f32_16x16x32_bf16 v[172:175], v[204:207], v[224:227], v[172:175]
  ds_read_b128 v[224:227], v240 offset:8192
  s_add_u32 s68, s68, 6
  s_cmp_lt_u32 s68, 12
  s_cbranch_scc1 K1_QLOOP
  s_waitcnt lgkmcnt(6)
  v_mfma_f32_16x16x32_bf16 v[16:19], v[176:179], v[208:211], v[16:19]
  s_add_u32 s75, s75, 262144
  v_mfma_f32_16x16x32_bf16 v[20:23], v[180:183], v[208:211], v[20:23]
  s_waitcnt lgkmcnt(3)
  v_mfma_f32_16x16x32_bf16 v[48:51], v[176:179], v[212:215], v[48:51]
  s_cmp_eq_u32 s75, 4718592
  s_cselect_b32 s75, 0, s75
  v_mfma_f32_16x16x32_bf16 v[52:55], v[180:183], v[212:215], v[52:55]
  s_waitcnt lgkmcnt(2)
  v_mfma_f32_16x16x32_bf16 v[80:83], v[176:179], v[216:219], v[80:83]
  s_mov_b32 s69, s75
  v_mfma_f32_16x16x32_bf16 v[84:87], v[180:183], v[216:219], v[84:87]
  s_waitcnt lgkmcnt(1)
  v_mfma_f32_16x16x32_bf16 v[112:115], v[176:179], v[220:223], v[112:115]
  v_mfma_f32_16x16x32_bf16 v[116:119], v[180:183], v[220:223], v[116:119]
  s_waitcnt lgkmcnt(0)
  v_mfma_f32_16x16x32_bf16 v[144:147], v[176:179], v[224:227], v[144:147]
  ds_read_b64_tr_b16 v[200:201], v231 offset:0
  ds_read_b64_tr_b16 v[202:203], v231 offset:4096
  v_mfma_f32_16x16x32_bf16 v[148:151], v[180:183], v[224:227], v[148:151]
  ds_read_b64_tr_b16 v[204:205], v231 offset:8
  ds_read_b64_tr_b16 v[206:207], v231 offset:4104
  v_mfma_f32_16x16x32_bf16 v[24:27], v[184:187], v[208:211], v[24:27]
  v_mfma_f32_16x16x32_bf16 v[28:31], v[188:191], v[208:211], v[28:31]
  v_mfma_f32_16x16x32_bf16 v[56:59], v[184:187], v[212:215], v[56:59]
  v_mfma_f32_16x16x32_bf16 v[60:63], v[188:191], v[212:215], v[60:63]
  v_mfma_f32_16x16x32_bf16 v[88:91], v[184:187], v[216:219], v[88:91]
  s_waitcnt vmcnt(10) lgkmcnt(0)
  s_barrier
  v_mfma_f32_16x16x32_bf16 v[92:95], v[188:191], v[216:219], v[92:95]
  ds_read_b64_tr_b16 v[176:177], v232 offset:0
  ds_read_b64_tr_b16 v[178:179], v232 offset:4096
  v_mfma_f32_16x16x32_bf16 v[120:123], v[184:187], v[220:223], v[120:123]
  ds_read_b64_tr_b16 v[180:181], v232 offset:8
  ds_read_b64_tr_b16 v[182:183], v232 offset:4104
  v_mfma_f32_16x16x32_bf16 v[124:127], v[188:191], v[220:223], v[124:127]
  s_add_u32 m0, s31, 0
  s_nop 0
  v_mfma_f32_16x16x32_bf16 v[152:155], v[184:187], v[224:227], v[152:155]
  s_mov_b32 exec_hi, 0
  buffer_load_dwordx4 v252, s[44:47], s70 offen offset:2048 lds
  s_mov_b32 exec_hi, -1
  v_mfma_f32_16x16x32_bf16 v[156:159], v[188:191], v[224:227], v[156:159]
  v_mfma_f32_16x16x32_bf16 v[32:35], v[192:195], v[208:211], v[32:35]
  ds_read_b64_tr_b16 v[184:185], v233 offset:0
  ds_read_b64_tr_b16 v[186:187], v233 offset:4096
  v_mfma_f32_16x16x32_bf16 v[36:39], v[196:199], v[208:211], v[36:39]
  ds_read_b64_tr_b16 v[188:189], v233 offset:8
  ds_read_b64_tr_b16 v[190:191], v233 offset:4104
  v_mfma_f32_16x16x32_bf16 v[64:67], v[192:195], v[212:215], v[64:67]
  s_mov_b32 m0, s99
  s_nop 0
  v_mfma_f32_16x16x32_bf16 v[68:71], v[196:199], v[212:215], v[68:71]
  buffer_load_dwordx4 v246, s[40:43], s69 offen offset:0 lds
  v_mfma_f32_16x16x32_bf16 v[96:99], v[192:195], v[216:219], v[96:99]
  v_mfma_f32_16x16x32_bf16 v[100:103], v[196:199], v[216:219], v[100:103]
  buffer_load_dwordx4 v247, s[40:43], s69 offen offset:1024 lds
  v_mfma_f32_16x16x32_bf16 v[128:131], v[192:195], v[220:223], v[128:131]
  buffer_load_dwordx4 v248, s[40:43], s69 offen offset:2048 lds
  v_mfma_f32_16x16x32_bf16 v[132:135], v[196:199], v[220:223], v[132:135]
  v_mfma_f32_16x16x32_bf16 v[160:163], v[192:195], v[224:227], v[160:163]
  buffer_load_dwordx4 v249, s[40:43], s69 offen offset:3072 lds
  v_mfma_f32_16x16x32_bf16 v[164:167], v[196:199], v[224:227], v[164:167]
  v_mfma_f32_16x16x32_bf16 v[40:43], v[200:203], v[208:211], v[40:43]
  ds_read_b64_tr_b16 v[192:193], v234 offset:0
  ds_read_b64_tr_b16 v[194:195], v234 offset:4096
  v_mfma_f32_16x16x32_bf16 v[44:47], v[204:207], v[208:211], v[44:47]
  ds_read_b128 v[208:211], v241 offset:0
  s_add_u32 m0, s99, 4096
  v_mfma_f32_16x16x32_bf16 v[72:75], v[200:203], v[212:215], v[72:75]
  ds_read_b64_tr_b16 v[196:197], v234 offset:8
  ds_read_b64_tr_b16 v[198:199], v234 offset:4104
  v_mfma_f32_16x16x32_bf16 v[76:79], v[204:207], v[212:215], v[76:79]
  ds_read_b128 v[212:215], v241 offset:2048
  s_add_u32 s67, s69, 32768
  v_mfma_f32_16x16x32_bf16 v[104:107], v[200:203], v[216:219], v[104:107]
  buffer_load_dwordx4 v246, s[40:43], s67 offen offset:0 lds
  v_mfma_f32_16x16x32_bf16 v[108:111], v[204:207], v[216:219], v[108:111]
  ds_read_b128 v[216:219], v241 offset:4096
  buffer_load_dwordx4 v247, s[40:43], s67 offen offset:1024 lds
  v_mfma_f32_16x16x32_bf16 v[136:139], v[200:203], v[220:223], v[136:139]
  buffer_load_dwordx4 v248, s[40:43], s67 offen offset:2048 lds
  v_mfma_f32_16x16x32_bf16 v[140:143], v[204:207], v[220:223], v[140:143]
  ds_read_b128 v[220:223], v241 offset:6144
  v_mfma_f32_16x16x32_bf16 v[168:171], v[200:203], v[224:227], v[168:171]
  buffer_load_dwordx4 v249, s[40:43], s67 offen offset:3072 lds
  v_mfma_f32_16x16x32_bf16 v[172:175], v[204:207], v[224:227], v[172:175]
  ds_read_b128 v[224:227], v241 offset:8192
  s_waitcnt lgkmcnt(6)
  v_mfma_f32_16x16x32_bf16 v[16:19], v[176:179], v[208:211], v[16:19]
  s_add_u32 s75, s75, 262144
  v_mfma_f32_16x16x32_bf16 v[20:23], v[180:183], v[208:211], v[20:23]
  s_waitcnt lgkmcnt(3)
  v_mfma_f32_16x16x32_bf16 v[48:51], v[176:179], v[212:215], v[48:51]
  s_cmp_eq_u32 s75, 4718592
  s_cselect_b32 s75, 0, s75
  v_mfma_f32_16x16x32_bf16 v[52:55], v[180:183], v[212:215], v[52:55]
  s_waitcnt lgkmcnt(2)
  v_mfma_f32_16x16x32_bf16 v[80:83], v[176:179], v[216:219], v[80:83]
  s_lshr_b32 s70, s75, 12
  s_mov_b32 s69, s75
  v_mfma_f32_16x16x32_bf16 v[84:87], v[180:183], v[216:219], v[84:87]
  s_waitcnt lgkmcnt(1)
  v_mfma_f32_16x16x32_bf16 v[112:115], v[176:179], v[220:223], v[112:115]
  v_mfma_f32_16x16x32_bf16 v[116:119], v[180:183], v[220:223], v[116:119]
  s_waitcnt lgkmcnt(0)
  v_mfma_f32_16x16x32_bf16 v[144:147], v[176:179], v[224:227], v[144:147]
  ds_read_b64_tr_b16 v[200:201], v235 offset:0
  ds_read_b64_tr_b16 v[202:203], v235 offset:4096
  v_mfma_f32_16x16x32_bf16 v[148:151], v[180:183], v[224:227], v[148:151]
  ds_read_b64_tr_b16 v[204:205], v235 offset:8
  ds_read_b64_tr_b16 v[206:207], v235 offset:4104
  v_mfma_f32_16x16x32_bf16 v[24:27], v[184:187], v[208:211], v[24:27]
  v_mfma_f32_16x16x32_bf16 v[28:31], v[188:191], v[208:211], v[28:31]
  v_mfma_f32_16x16x32_bf16 v[56:59], v[184:187], v[212:215], v[56:59]
  v_mfma_f32_16x16x32_bf16 v[60:63], v[188:191], v[212:215], v[60:63]
  v_mfma_f32_16x16x32_bf16 v[88:91], v[184:187], v[216:219], v[88:91]
  s_waitcnt vmcnt(8) lgkmcnt(0)
  s_barrier
  v_mfma_f32_16x16x32_bf16 v[92:95], v[188:191], v[216:219], v[92:95]
  ds_read_b64_tr_b16 v[176:177], v236 offset:0
  ds_read_b64_tr_b16 v[178:179], v236 offset:4096
  v_mfma_f32_16x16x32_bf16 v[120:123], v[184:187], v[220:223], v[120:123]
  ds_read_b64_tr_b16 v[180:181], v236 offset:8
  ds_read_b64_tr_b16 v[182:183], v236 offset:4104
  v_mfma_f32_16x16x32_bf16 v[124:127], v[188:191], v[220:223], v[124:127]
  s_mov_b32 m0, s63
  v_mfma_f32_16x16x32_bf16 v[152:155], v[184:187], v[224:227], v[152:155]
  s_nop 0
  v_mfma_f32_16x16x32_bf16 v[156:159], v[188:191], v[224:227], v[156:159]
  buffer_load_dwordx4 v250, s[44:47], s70 offen offset:0 lds
  v_mfma_f32_16x16x32_bf16 v[32:35], v[192:195], v[208:211], v[32:35]
  ds_read_b64_tr_b16 v[184:185], v237 offset:0
  ds_read_b64_tr_b16 v[186:187], v237 offset:4096
  v_mfma_f32_16x16x32_bf16 v[36:39], v[196:199], v[208:211], v[36:39]
  ds_read_b64_tr_b16 v[188:189], v237 offset:8
  ds_read_b64_tr_b16 v[190:191], v237 offset:4104
  v_mfma_f32_16x16x32_bf16 v[64:67], v[192:195], v[212:215], v[64:67]
  buffer_load_dwordx4 v251, s[44:47], s70 offen offset:1024 lds
  s_mov_b32 m0, s100
  v_mfma_f32_16x16x32_bf16 v[68:71], v[196:199], v[212:215], v[68:71]
  v_mfma_f32_16x16x32_bf16 v[96:99], v[192:195], v[216:219], v[96:99]
  s_nop 0
  v_mfma_f32_16x16x32_bf16 v[100:103], v[196:199], v[216:219], v[100:103]
  buffer_load_dwordx4 v246, s[40:43], s69 offen offset:0 lds
  v_mfma_f32_16x16x32_bf16 v[128:131], v[192:195], v[220:223], v[128:131]
  v_mfma_f32_16x16x32_bf16 v[132:135], v[196:199], v[220:223], v[132:135]
  buffer_load_dwordx4 v247, s[40:43], s69 offen offset:1024 lds
  v_mfma_f32_16x16x32_bf16 v[160:163], v[192:195], v[224:227], v[160:163]
  buffer_load_dwordx4 v248, s[40:43], s69 offen offset:2048 lds
  v_mfma_f32_16x16x32_bf16 v[164:167], v[196:199], v[224:227], v[164:167]
  buffer_load_dwordx4 v249, s[40:43], s69 offen offset:3072 lds
  v_mfma_f32_16x16x32_bf16 v[40:43], v[200:203], v[208:211], v[40:43]
  ds_read_b64_tr_b16 v[192:193], v238 offset:0
  ds_read_b64_tr_b16 v[194:195], v238 offset:4096
  v_mfma_f32_16x16x32_bf16 v[44:47], v[204:207], v[208:211], v[44:47]
  ds_read_b128 v[208:211], v242 offset:0
  s_add_u32 m0, s100, 4096
  v_mfma_f32_16x16x32_bf16 v[72:75], v[200:203], v[212:215], v[72:75]
  ds_read_b64_tr_b16 v[196:197], v238 offset:8
  ds_read_b64_tr_b16 v[198:199], v238 offset:4104
  v_mfma_f32_16x16x32_bf16 v[76:79], v[204:207], v[212:215], v[76:79]
  ds_read_b128 v[212:215], v242 offset:2048
  s_add_u32 s67, s69, 32768
  v_mfma_f32_16x16x32_bf16 v[104:107], v[200:203], v[216:219], v[104:107]
  buffer_load_dwordx4 v246, s[40:43], s67 offen offset:0 lds
  v_mfma_f32_16x16x32_bf16 v[108:111], v[204:207], v[216:219], v[108:111]
  ds_read_b128 v[216:219], v242 offset:4096
  buffer_load_dwordx4 v247, s[40:43], s67 offen offset:1024 lds
  v_mfma_f32_16x16x32_bf16 v[136:139], v[200:203], v[220:223], v[136:139]
  v_mfma_f32_16x16x32_bf16 v[140:143], v[204:207], v[220:223], v[140:143]
  ds_read_b128 v[220:223], v242 offset:6144
  buffer_load_dwordx4 v248, s[40:43], s67 offen offset:2048 lds
  v_mfma_f32_16x16x32_bf16 v[168:171], v[200:203], v[224:227], v[168:171]
  buffer_load_dwordx4 v249, s[40:43], s67 offen offset:3072 lds
  v_mfma_f32_16x16x32_bf16 v[172:175], v[204:207], v[224:227], v[172:175]
  ds_read_b128 v[224:227], v242 offset:8192
  s_waitcnt lgkmcnt(6)
  v_mfma_f32_16x16x32_bf16 v[16:19], v[176:179], v[208:211], v[16:19]
  s_add_u32 s75, s75, 262144
  v_mfma_f32_16x16x32_bf16 v[20:23], v[180:183], v[208:211], v[20:23]
  s_waitcnt lgkmcnt(3)
  v_mfma_f32_16x16x32_bf16 v[48:51], v[176:179], v[212:215], v[48:51]
  s_cmp_eq_u32 s75, 4718592
  s_cselect_b32 s75, 0, s75
  v_mfma_f32_16x16x32_bf16 v[52:55], v[180:183], v[212:215], v[52:55]
  s_waitcnt lgkmcnt(2)
  v_mfma_f32_16x16x32_bf16 v[80:83], v[176:179], v[216:219], v[80:83]
  s_mov_b32 s69, s75
  v_mfma_f32_16x16x32_bf16 v[84:87], v[180:183], v[216:219], v[84:87]
  s_waitcnt lgkmcnt(1)
  v_mfma_f32_16x16x32_bf16 v[112:115], v[176:179], v[220:223], v[112:115]
  v_mfma_f32_16x16x32_bf16 v[116:119], v[180:183], v[220:223], v[116:119]
  s_waitcnt lgkmcnt(0)
  v_mfma_f32_16x16x32_bf16 v[144:147], v[176:179], v[224:227], v[144:147]
  ds_read_b64_tr_b16 v[200:201], v239 offset:0
  ds_read_b64_tr_b16 v[202:203], v239 offset:4096
  v_mfma_f32_16x16x32_bf16 v[148:151], v[180:183], v[224:227], v[148:151]
  ds_read_b64_tr_b16 v[204:205], v239 offset:8
  ds_read_b64_tr_b16 v[206:207], v239 offset:4104
  v_mfma_f32_16x16x32_bf16 v[24:27], v[184:187], v[208:211], v[24:27]
  v_mfma_f32_16x16x32_bf16 v[28:31], v[188:191], v[208:211], v[28:31]
  v_mfma_f32_16x16x32_bf16 v[56:59], v[184:187], v[212:215], v[56:59]
  v_mfma_f32_16x16x32_bf16 v[60:63], v[188:191], v[212:215], v[60:63]
  v_mfma_f32_16x16x32_bf16 v[88:91], v[184:187], v[216:219], v[88:91]
  s_waitcnt vmcnt(10) lgkmcnt(0)
  s_barrier
  v_mfma_f32_16x16x32_bf16 v[92:95], v[188:191], v[216:219], v[92:95]
  ds_read_b64_tr_b16 v[176:177], v228 offset:0
  ds_read_b64_tr_b16 v[178:179], v228 offset:4096
  v_mfma_f32_16x16x32_bf16 v[120:123], v[184:187], v[220:223], v[120:123]
  ds_read_b64_tr_b16 v[180:181], v228 offset:8
  ds_read_b64_tr_b16 v[182:183], v228 offset:4104
  v_mfma_f32_16x16x32_bf16 v[124:127], v[188:191], v[220:223], v[124:127]
  s_add_u32 m0, s63, 0
  s_nop 0
  v_mfma_f32_16x16x32_bf16 v[152:155], v[184:187], v[224:227], v[152:155]
  s_mov_b32 exec_hi, 0
  buffer_load_dwordx4 v252, s[44:47], s70 offen offset:2048 lds
  s_mov_b32 exec_hi, -1
  v_mfma_f32_16x16x32_bf16 v[156:159], v[188:191], v[224:227], v[156:159]
  v_mfma_f32_16x16x32_bf16 v[32:35], v[192:195], v[208:211], v[32:35]
  ds_read_b64_tr_b16 v[184:185], v229 offset:0
  ds_read_b64_tr_b16 v[186:187], v229 offset:4096
  v_mfma_f32_16x16x32_bf16 v[36:39], v[196:199], v[208:211], v[36:39]
  ds_read_b64_tr_b16 v[188:189], v229 offset:8
  ds_read_b64_tr_b16 v[190:191], v229 offset:4104
  v_mfma_f32_16x16x32_bf16 v[64:67], v[192:195], v[212:215], v[64:67]
  s_mov_b32 m0, s101
  s_nop 0
  v_mfma_f32_16x16x32_bf16 v[68:71], v[196:199], v[212:215], v[68:71]
  buffer_load_dwordx4 v246, s[40:43], s69 offen offset:0 lds
  v_mfma_f32_16x16x32_bf16 v[96:99], v[192:195], v[216:219], v[96:99]
  v_mfma_f32_16x16x32_bf16 v[100:103], v[196:199], v[216:219], v[100:103]
  buffer_load_dwordx4 v247, s[40:43], s69 offen offset:1024 lds
  v_mfma_f32_16x16x32_bf16 v[128:131], v[192:195], v[220:223], v[128:131]
  buffer_load_dwordx4 v248, s[40:43], s69 offen offset:2048 lds
  v_mfma_f32_16x16x32_bf16 v[132:135], v[196:199], v[220:223], v[132:135]
  v_mfma_f32_16x16x32_bf16 v[160:163], v[192:195], v[224:227], v[160:163]
  buffer_load_dwordx4 v249, s[40:43], s69 offen offset:3072 lds
  v_mfma_f32_16x16x32_bf16 v[164:167], v[196:199], v[224:227], v[164:167]
  v_mfma_f32_16x16x32_bf16 v[40:43], v[200:203], v[208:211], v[40:43]
  ds_read_b64_tr_b16 v[192:193], v230 offset:0
  ds_read_b64_tr_b16 v[194:195], v230 offset:4096
  v_mfma_f32_16x16x32_bf16 v[44:47], v[204:207], v[208:211], v[44:47]
  ds_read_b128 v[208:211], v243 offset:0
  s_add_u32 m0, s101, 4096
  v_mfma_f32_16x16x32_bf16 v[72:75], v[200:203], v[212:215], v[72:75]
  ds_read_b64_tr_b16 v[196:197], v230 offset:8
  ds_read_b64_tr_b16 v[198:199], v230 offset:4104
  v_mfma_f32_16x16x32_bf16 v[76:79], v[204:207], v[212:215], v[76:79]
  ds_read_b128 v[212:215], v243 offset:2048
  s_add_u32 s67, s69, 32768
  v_mfma_f32_16x16x32_bf16 v[104:107], v[200:203], v[216:219], v[104:107]
  buffer_load_dwordx4 v246, s[40:43], s67 offen offset:0 lds
  v_mfma_f32_16x16x32_bf16 v[108:111], v[204:207], v[216:219], v[108:111]
  ds_read_b128 v[216:219], v243 offset:4096
  buffer_load_dwordx4 v247, s[40:43], s67 offen offset:1024 lds
  v_mfma_f32_16x16x32_bf16 v[136:139], v[200:203], v[220:223], v[136:139]
  buffer_load_dwordx4 v248, s[40:43], s67 offen offset:2048 lds
  v_mfma_f32_16x16x32_bf16 v[140:143], v[204:207], v[220:223], v[140:143]
  ds_read_b128 v[220:223], v243 offset:6144
  v_mfma_f32_16x16x32_bf16 v[168:171], v[200:203], v[224:227], v[168:171]
  buffer_load_dwordx4 v249, s[40:43], s67 offen offset:3072 lds
  v_mfma_f32_16x16x32_bf16 v[172:175], v[204:207], v[224:227], v[172:175]
  ds_read_b128 v[224:227], v243 offset:8192
  s_waitcnt lgkmcnt(6)
  v_mfma_f32_16x16x32_bf16 v[16:19], v[176:179], v[208:211], v[16:19]
  v_mfma_f32_16x16x32_bf16 v[20:23], v[180:183], v[208:211], v[20:23]
  s_waitcnt lgkmcnt(3)
  v_mfma_f32_16x16x32_bf16 v[48:51], v[176:179], v[212:215], v[48:51]
  v_mfma_f32_16x16x32_bf16 v[52:55], v[180:183], v[212:215], v[52:55]
  s_waitcnt lgkmcnt(2)
  v_mfma_f32_16x16x32_bf16 v[80:83], v[176:179], v[216:219], v[80:83]
  v_mfma_f32_16x16x32_bf16 v[84:87], v[180:183], v[216:219], v[84:87]
  s_waitcnt lgkmcnt(1)
  v_mfma_f32_16x16x32_bf16 v[112:115], v[176:179], v[220:223], v[112:115]
  v_mfma_f32_16x16x32_bf16 v[116:119], v[180:183], v[220:223], v[116:119]
  s_waitcnt lgkmcnt(0)
  v_mfma_f32_16x16x32_bf16 v[144:147], v[176:179], v[224:227], v[144:147]
  ds_read_b64_tr_b16 v[200:201], v231 offset:0
  ds_read_b64_tr_b16 v[202:203], v231 offset:4096
  v_mfma_f32_16x16x32_bf16 v[148:151], v[180:183], v[224:227], v[148:151]
  ds_read_b64_tr_b16 v[204:205], v231 offset:8
  ds_read_b64_tr_b16 v[206:207], v231 offset:4104
  v_mfma_f32_16x16x32_bf16 v[24:27], v[184:187], v[208:211], v[24:27]
  v_add_u32 v13, 0, v9
  v_mfma_f32_16x16x32_bf16 v[28:31], v[188:191], v[208:211], v[28:31]
  v_xor_b32 v13, v13, v10
  v_mfma_f32_16x16x32_bf16 v[56:59], v[184:187], v[212:215], v[56:59]
  v_lshlrev_b32 v13, 4, v13
  v_mfma_f32_16x16x32_bf16 v[60:63], v[188:191], v[212:215], v[60:63]
  v_lshl_add_u32 v246, v9, 8, v13
  v_mfma_f32_16x16x32_bf16 v[88:91], v[184:187], v[216:219], v[88:91]
  s_waitcnt vmcnt(8) lgkmcnt(0)
  s_barrier
  v_mfma_f32_16x16x32_bf16 v[92:95], v[188:191], v[216:219], v[92:95]
  ds_read_b64_tr_b16 v[176:177], v232 offset:0
  ds_read_b64_tr_b16 v[178:179], v232 offset:4096
  v_mfma_f32_16x16x32_bf16 v[120:123], v[184:187], v[220:223], v[120:123]
  ds_read_b64_tr_b16 v[180:181], v232 offset:8
  ds_read_b64_tr_b16 v[182:183], v232 offset:4104
  v_mfma_f32_16x16x32_bf16 v[124:127], v[188:191], v[220:223], v[124:127]
  v_add_u32 v13, 4, v9
  v_xor_b32 v13, v13, v10
  v_mfma_f32_16x16x32_bf16 v[152:155], v[184:187], v[224:227], v[152:155]
  v_lshlrev_b32 v13, 4, v13
  v_lshl_add_u32 v247, v9, 8, v13
  v_mfma_f32_16x16x32_bf16 v[156:159], v[188:191], v[224:227], v[156:159]
  v_add_u32 v13, 8, v9
  v_mfma_f32_16x16x32_bf16 v[32:35], v[192:195], v[208:211], v[32:35]
  ds_read_b64_tr_b16 v[184:185], v233 offset:0
  ds_read_b64_tr_b16 v[186:187], v233 offset:4096
  v_mfma_f32_16x16x32_bf16 v[36:39], v[196:199], v[208:211], v[36:39]
  ds_read_b64_tr_b16 v[188:189], v233 offset:8
  ds_read_b64_tr_b16 v[190:191], v233 offset:4104
  v_mfma_f32_16x16x32_bf16 v[64:67], v[192:195], v[212:215], v[64:67]
  v_xor_b32 v13, v13, v10
  v_lshlrev_b32 v13, 4, v13
  v_mfma_f32_16x16x32_bf16 v[68:71], v[196:199], v[212:215], v[68:71]
  v_lshl_add_u32 v248, v9, 8, v13
  v_add_u32 v13, 12, v9
  v_mfma_f32_16x16x32_bf16 v[96:99], v[192:195], v[216:219], v[96:99]
  v_mfma_f32_16x16x32_bf16 v[100:103], v[196:199], v[216:219], v[100:103]
  v_xor_b32 v13, v13, v10
  v_mfma_f32_16x16x32_bf16 v[128:131], v[192:195], v[220:223], v[128:131]
  v_lshlrev_b32 v13, 4, v13
  v_mfma_f32_16x16x32_bf16 v[132:135], v[196:199], v[220:223], v[132:135]
  v_lshl_add_u32 v249, v9, 8, v13
  v_mfma_f32_16x16x32_bf16 v[160:163], v[192:195], v[224:227], v[160:163]
  v_add_u32 v13, 0, v9
  v_mfma_f32_16x16x32_bf16 v[164:167], v[196:199], v[224:227], v[164:167]
  v_lshlrev_b32 v13, 1, v13
  v_mfma_f32_16x16x32_bf16 v[40:43], v[200:203], v[208:211], v[40:43]
  ds_read_b64_tr_b16 v[192:193], v234 offset:0
  ds_read_b64_tr_b16 v[194:195], v234 offset:4096
  v_mfma_f32_16x16x32_bf16 v[44:47], v[204:207], v[208:211], v[44:47]
  ds_read_b128 v[208:211], v244 offset:0
  v_xor_b32 v13, v13, v10
  v_mfma_f32_16x16x32_bf16 v[72:75], v[200:203], v[212:215], v[72:75]
  ds_read_b64_tr_b16 v[196:197], v234 offset:8
  ds_read_b64_tr_b16 v[198:199], v234 offset:4104
  v_mfma_f32_16x16x32_bf16 v[76:79], v[204:207], v[212:215], v[76:79]
  ds_read_b128 v[212:215], v244 offset:2048
  v_lshlrev_b32 v13, 4, v13
  v_mfma_f32_16x16x32_bf16 v[104:107], v[200:203], v[216:219], v[104:107]
  v_lshl_add_u32 v250, v9, 8, v13
  v_add_u32 v13, 4, v9
  v_mfma_f32_16x16x32_bf16 v[108:111], v[204:207], v[216:219], v[108:111]
  ds_read_b128 v[216:219], v244 offset:4096
  v_lshlrev_b32 v13, 1, v13
  v_mfma_f32_16x16x32_bf16 v[136:139], v[200:203], v[220:223], v[136:139]
  v_xor_b32 v13, v13, v10
  v_mfma_f32_16x16x32_bf16 v[140:143], v[204:207], v[220:223], v[140:143]
  ds_read_b128 v[220:223], v244 offset:6144
  v_lshlrev_b32 v13, 4, v13
  v_mfma_f32_16x16x32_bf16 v[168:171], v[200:203], v[224:227], v[168:171]
  v_lshl_add_u32 v251, v9, 8, v13
  v_mfma_f32_16x16x32_bf16 v[172:175], v[204:207], v[224:227], v[172:175]
  ds_read_b128 v[224:227], v244 offset:8192
  s_cmp_eq_u32 s57, 0
  s_cbranch_scc0 K1_B_PATH
  s_waitcnt lgkmcnt(6)
  v_mfma_f32_16x16x32_bf16 v[16:19], v[176:179], v[208:211], v[16:19]
  s_mov_b32 s74, s96
  s_lshl_b32 s74, s74, 13
  v_mfma_f32_16x16x32_bf16 v[20:23], v[180:183], v[208:211], v[20:23]
  s_waitcnt lgkmcnt(3)
  v_mfma_f32_16x16x32_bf16 v[48:51], v[176:179], v[212:215], v[48:51]
  v_mfma_f32_16x16x32_bf16 v[52:55], v[180:183], v[212:215], v[52:55]
  s_waitcnt lgkmcnt(2)
  v_mfma_f32_16x16x32_bf16 v[80:83], v[176:179], v[216:219], v[80:83]
  v_mfma_f32_16x16x32_bf16 v[84:87], v[180:183], v[216:219], v[84:87]
  s_waitcnt lgkmcnt(1)
  v_mfma_f32_16x16x32_bf16 v[112:115], v[176:179], v[220:223], v[112:115]
  v_mfma_f32_16x16x32_bf16 v[116:119], v[180:183], v[220:223], v[116:119]
  s_waitcnt lgkmcnt(0)
  v_mfma_f32_16x16x32_bf16 v[144:147], v[176:179], v[224:227], v[144:147]
  ds_read_b64_tr_b16 v[200:201], v235 offset:0
  ds_read_b64_tr_b16 v[202:203], v235 offset:4096
  v_mfma_f32_16x16x32_bf16 v[148:151], v[180:183], v[224:227], v[148:151]
  ds_read_b64_tr_b16 v[204:205], v235 offset:8
  ds_read_b64_tr_b16 v[206:207], v235 offset:4104
  v_mfma_f32_16x16x32_bf16 v[24:27], v[184:187], v[208:211], v[24:27]
  v_mfma_f32_16x16x32_bf16 v[28:31], v[188:191], v[208:211], v[28:31]
  v_mfma_f32_16x16x32_bf16 v[56:59], v[184:187], v[212:215], v[56:59]
  v_mfma_f32_16x16x32_bf16 v[60:63], v[188:191], v[212:215], v[60:63]
  v_mfma_f32_16x16x32_bf16 v[88:91], v[184:187], v[216:219], v[88:91]
  s_waitcnt vmcnt(0) lgkmcnt(0)
  s_barrier
  v_mfma_f32_16x16x32_bf16 v[92:95], v[188:191], v[216:219], v[92:95]
  ds_read_b64_tr_b16 v[176:177], v236 offset:0
  ds_read_b64_tr_b16 v[178:179], v236 offset:4096
  v_mfma_f32_16x16x32_bf16 v[120:123], v[184:187], v[220:223], v[120:123]
  ds_read_b64_tr_b16 v[180:181], v236 offset:8
  ds_read_b64_tr_b16 v[182:183], v236 offset:4104
  v_mfma_f32_16x16x32_bf16 v[124:127], v[188:191], v[220:223], v[124:127]
  s_add_u32 s64, s62, s76
  v_mfma_f32_16x16x32_bf16 v[152:155], v[184:187], v[224:227], v[152:155]
  s_add_u32 m0, s64, 0
  v_mfma_f32_16x16x32_bf16 v[156:159], v[188:191], v[224:227], v[156:159]
  v_mfma_f32_16x16x32_bf16 v[32:35], v[192:195], v[208:211], v[32:35]
  ds_read_b64_tr_b16 v[184:185], v237 offset:0
  ds_read_b64_tr_b16 v[186:187], v237 offset:4096
  v_mfma_f32_16x16x32_bf16 v[36:39], v[196:199], v[208:211], v[36:39]
  ds_read_b64_tr_b16 v[188:189], v237 offset:8
  ds_read_b64_tr_b16 v[190:191], v237 offset:4104
  v_mfma_f32_16x16x32_bf16 v[64:67], v[192:195], v[212:215], v[64:67]
  s_add_u32 s64, s74, s76
  buffer_load_dwordx4 v246, s[32:35], s64 offen offset:0 nt lds
  v_mfma_f32_16x16x32_bf16 v[68:71], v[196:199], v[212:215], v[68:71]
  buffer_load_dwordx4 v247, s[32:35], s64 offen offset:1024 nt lds
  v_mfma_f32_16x16x32_bf16 v[96:99], v[192:195], v[216:219], v[96:99]
  v_mfma_f32_16x16x32_bf16 v[100:103], v[196:199], v[216:219], v[100:103]
  buffer_load_dwordx4 v248, s[32:35], s64 offen offset:2048 nt lds
  v_mfma_f32_16x16x32_bf16 v[128:131], v[192:195], v[220:223], v[128:131]
  buffer_load_dwordx4 v249, s[32:35], s64 offen offset:3072 nt lds
  v_mfma_f32_16x16x32_bf16 v[132:135], v[196:199], v[220:223], v[132:135]
  v_mfma_f32_16x16x32_bf16 v[160:163], v[192:195], v[224:227], v[160:163]
  s_add_u32 s65, s62, s76
  v_mfma_f32_16x16x32_bf16 v[164:167], v[196:199], v[224:227], v[164:167]
  v_mfma_f32_16x16x32_bf16 v[40:43], v[200:203], v[208:211], v[40:43]
  ds_read_b64_tr_b16 v[192:193], v238 offset:0
  ds_read_b64_tr_b16 v[194:195], v238 offset:4096
  v_mfma_f32_16x16x32_bf16 v[44:47], v[204:207], v[208:211], v[44:47]
  ds_read_b128 v[208:211], v245 offset:0
  s_add_u32 m0, s65, 8192
  v_mfma_f32_16x16x32_bf16 v[72:75], v[200:203], v[212:215], v[72:75]
  ds_read_b64_tr_b16 v[196:197], v238 offset:8
  ds_read_b64_tr_b16 v[198:199], v238 offset:4104
  v_mfma_f32_16x16x32_bf16 v[76:79], v[204:207], v[212:215], v[76:79]
  ds_read_b128 v[212:215], v245 offset:2048
  s_add_u32 s65, s74, s76
  v_mfma_f32_16x16x32_bf16 v[104:107], v[200:203], v[216:219], v[104:107]
  buffer_load_dwordx4 v250, s[36:39], s65 offen offset:0 nt lds
  v_mfma_f32_16x16x32_bf16 v[108:111], v[204:207], v[216:219], v[108:111]
  ds_read_b128 v[216:219], v245 offset:4096
  buffer_load_dwordx4 v251, s[36:39], s65 offen offset:1024 nt lds
  v_mfma_f32_16x16x32_bf16 v[136:139], v[200:203], v[220:223], v[136:139]
  buffer_load_dwordx4 v250, s[36:39], s65 offen offset:2048 nt lds
  v_mfma_f32_16x16x32_bf16 v[140:143], v[204:207], v[220:223], v[140:143]
  ds_read_b128 v[220:223], v245 offset:6144
  v_mfma_f32_16x16x32_bf16 v[168:171], v[200:203], v[224:227], v[168:171]
  buffer_load_dwordx4 v251, s[36:39], s65 offen offset:3072 nt lds
  v_mfma_f32_16x16x32_bf16 v[172:175], v[204:207], v[224:227], v[172:175]
  ds_read_b128 v[224:227], v245 offset:8192
  s_waitcnt lgkmcnt(6)
  v_mfma_f32_16x16x32_bf16 v[16:19], v[176:179], v[208:211], v[16:19]
  s_add_u32 s74, s96, 1
  s_and_b32 s74, s74, 15
  v_mfma_f32_16x16x32_bf16 v[20:23], v[180:183], v[208:211], v[20:23]
  s_waitcnt lgkmcnt(3)
  s_lshl_b32 s74, s74, 13
  v_mfma_f32_16x16x32_bf16 v[48:51], v[176:179], v[212:215], v[48:51]
  v_mfma_f32_16x16x32_bf16 v[52:55], v[180:183], v[212:215], v[52:55]
  s_waitcnt lgkmcnt(2)
  v_mfma_f32_16x16x32_bf16 v[80:83], v[176:179], v[216:219], v[80:83]
  v_mfma_f32_16x16x32_bf16 v[84:87], v[180:183], v[216:219], v[84:87]
  s_waitcnt lgkmcnt(1)
  v_mfma_f32_16x16x32_bf16 v[112:115], v[176:179], v[220:223], v[112:115]
  v_mfma_f32_16x16x32_bf16 v[116:119], v[180:183], v[220:223], v[116:119]
  s_waitcnt lgkmcnt(0)
  v_mfma_f32_16x16x32_bf16 v[144:147], v[176:179], v[224:227], v[144:147]
  ds_read_b64_tr_b16 v[200:201], v239 offset:0
  ds_read_b64_tr_b16 v[202:203], v239 offset:4096
  v_mfma_f32_16x16x32_bf16 v[148:151], v[180:183], v[224:227], v[148:151]
  ds_read_b64_tr_b16 v[204:205], v239 offset:8
  ds_read_b64_tr_b16 v[206:207], v239 offset:4104
  v_mfma_f32_16x16x32_bf16 v[24:27], v[184:187], v[208:211], v[24:27]
  v_mfma_f32_16x16x32_bf16 v[28:31], v[188:191], v[208:211], v[28:31]
  v_mfma_f32_16x16x32_bf16 v[56:59], v[184:187], v[212:215], v[56:59]
  v_mfma_f32_16x16x32_bf16 v[60:63], v[188:191], v[212:215], v[60:63]
  v_mfma_f32_16x16x32_bf16 v[88:91], v[184:187], v[216:219], v[88:91]
  s_waitcnt lgkmcnt(0)
  s_barrier
  v_mfma_f32_16x16x32_bf16 v[92:95], v[188:191], v[216:219], v[92:95]
  v_mfma_f32_16x16x32_bf16 v[120:123], v[184:187], v[220:223], v[120:123]
  v_mfma_f32_16x16x32_bf16 v[124:127], v[188:191], v[220:223], v[124:127]
  s_add_u32 s64, s62, s76
  v_mfma_f32_16x16x32_bf16 v[152:155], v[184:187], v[224:227], v[152:155]
  v_mfma_f32_16x16x32_bf16 v[156:159], v[188:191], v[224:227], v[156:159]
  v_mfma_f32_16x16x32_bf16 v[32:35], v[192:195], v[208:211], v[32:35]
  s_add_u32 m0, s64, 16384
  v_mfma_f32_16x16x32_bf16 v[36:39], v[196:199], v[208:211], v[36:39]
  v_mfma_f32_16x16x32_bf16 v[64:67], v[192:195], v[212:215], v[64:67]
  v_mfma_f32_16x16x32_bf16 v[68:71], v[196:199], v[212:215], v[68:71]
  s_add_u32 s64, s74, s76
  v_mfma_f32_16x16x32_bf16 v[96:99], v[192:195], v[216:219], v[96:99]
  v_mfma_f32_16x16x32_bf16 v[100:103], v[196:199], v[216:219], v[100:103]
  v_mfma_f32_16x16x32_bf16 v[128:131], v[192:195], v[220:223], v[128:131]
  buffer_load_dwordx4 v246, s[32:35], s64 offen offset:0 nt lds
  v_mfma_f32_16x16x32_bf16 v[132:135], v[196:199], v[220:223], v[132:135]
  v_mfma_f32_16x16x32_bf16 v[160:163], v[192:195], v[224:227], v[160:163]
  v_mfma_f32_16x16x32_bf16 v[164:167], v[196:199], v[224:227], v[164:167]
  v_mfma_f32_16x16x32_bf16 v[40:43], v[200:203], v[208:211], v[40:43]
  buffer_load_dwordx4 v247, s[32:35], s64 offen offset:1024 nt lds
  v_mfma_f32_16x16x32_bf16 v[44:47], v[204:207], v[208:211], v[44:47]
  v_mfma_f32_16x16x32_bf16 v[72:75], v[200:203], v[212:215], v[72:75]
  v_mfma_f32_16x16x32_bf16 v[76:79], v[204:207], v[212:215], v[76:79]
  buffer_load_dwordx4 v248, s[32:35], s64 offen offset:2048 nt lds
  v_mfma_f32_16x16x32_bf16 v[104:107], v[200:203], v[216:219], v[104:107]
  v_mfma_f32_16x16x32_bf16 v[108:111], v[204:207], v[216:219], v[108:111]
  v_mfma_f32_16x16x32_bf16 v[136:139], v[200:203], v[220:223], v[136:139]
  buffer_load_dwordx4 v249, s[32:35], s64 offen offset:3072 nt lds
  v_mfma_f32_16x16x32_bf16 v[140:143], v[204:207], v[220:223], v[140:143]
  v_mfma_f32_16x16x32_bf16 v[168:171], v[200:203], v[224:227], v[168:171]
  v_mfma_f32_16x16x32_bf16 v[172:175], v[204:207], v[224:227], v[172:175]
  s_nop 7
  s_nop 1
  s_mov_b32 s66, 0x3e0293ee
  s_mov_b32 s67, s66
  v_pk_mul_f32 v[16:17], v[16:17], s[66:67]
  v_pk_mul_f32 v[18:19], v[18:19], s[66:67]
  v_pk_mul_f32 v[20:21], v[20:21], s[66:67]
  v_pk_mul_f32 v[22:23], v[22:23], s[66:67]
  v_cvt_pk_bf16_f32 v16, v16, v17
  v_cvt_pk_bf16_f32 v17, v18, v19
  v_cvt_pk_bf16_f32 v18, v20, v21
  v_cvt_pk_bf16_f32 v19, v22, v23
  v_pk_mul_f32 v[24:25], v[24:25], s[66:67]
  v_pk_mul_f32 v[26:27], v[26:27], s[66:67]
  v_pk_mul_f32 v[28:29], v[28:29], s[66:67]
  v_pk_mul_f32 v[30:31], v[30:31], s[66:67]
  v_cvt_pk_bf16_f32 v20, v24, v25
  v_cvt_pk_bf16_f32 v21, v26, v27
  v_cvt_pk_bf16_f32 v22, v28, v29
  v_cvt_pk_bf16_f32 v23, v30, v31
  v_pk_mul_f32 v[32:33], v[32:33], s[66:67]
  v_pk_mul_f32 v[34:35], v[34:35], s[66:67]
  v_pk_mul_f32 v[36:37], v[36:37], s[66:67]
  v_pk_mul_f32 v[38:39], v[38:39], s[66:67]
  v_cvt_pk_bf16_f32 v24, v32, v33
  v_cvt_pk_bf16_f32 v25, v34, v35
  v_cvt_pk_bf16_f32 v26, v36, v37
  v_cvt_pk_bf16_f32 v27, v38, v39
  v_pk_mul_f32 v[40:41], v[40:41], s[66:67]
  v_pk_mul_f32 v[42:43], v[42:43], s[66:67]
  v_pk_mul_f32 v[44:45], v[44:45], s[66:67]
  v_pk_mul_f32 v[46:47], v[46:47], s[66:67]
  v_cvt_pk_bf16_f32 v28, v40, v41
  v_cvt_pk_bf16_f32 v29, v42, v43
  v_cvt_pk_bf16_f32 v30, v44, v45
  v_cvt_pk_bf16_f32 v31, v46, v47
  v_pk_mul_f32 v[48:49], v[48:49], s[66:67]
  v_pk_mul_f32 v[50:51], v[50:51], s[66:67]
  v_pk_mul_f32 v[52:53], v[52:53], s[66:67]
  v_pk_mul_f32 v[54:55], v[54:55], s[66:67]
  v_cvt_pk_bf16_f32 v32, v48, v49
  v_cvt_pk_bf16_f32 v33, v50, v51
  v_cvt_pk_bf16_f32 v34, v52, v53
  v_cvt_pk_bf16_f32 v35, v54, v55
  v_pk_mul_f32 v[56:57], v[56:57], s[66:67]
  v_pk_mul_f32 v[58:59], v[58:59], s[66:67]
  v_pk_mul_f32 v[60:61], v[60:61], s[66:67]
  v_pk_mul_f32 v[62:63], v[62:63], s[66:67]
  v_cvt_pk_bf16_f32 v36, v56, v57
  v_cvt_pk_bf16_f32 v37, v58, v59
  v_cvt_pk_bf16_f32 v38, v60, v61
  v_cvt_pk_bf16_f32 v39, v62, v63
  v_pk_mul_f32 v[64:65], v[64:65], s[66:67]
  v_pk_mul_f32 v[66:67], v[66:67], s[66:67]
  v_pk_mul_f32 v[68:69], v[68:69], s[66:67]
  v_pk_mul_f32 v[70:71], v[70:71], s[66:67]
  v_cvt_pk_bf16_f32 v40, v64, v65
  v_cvt_pk_bf16_f32 v41, v66, v67
  v_cvt_pk_bf16_f32 v42, v68, v69
  v_cvt_pk_bf16_f32 v43, v70, v71
  v_pk_mul_f32 v[72:73], v[72:73], s[66:67]
  v_pk_mul_f32 v[74:75], v[74:75], s[66:67]
  v_pk_mul_f32 v[76:77], v[76:77], s[66:67]
  v_pk_mul_f32 v[78:79], v[78:79], s[66:67]
  v_cvt_pk_bf16_f32 v44, v72, v73
  v_cvt_pk_bf16_f32 v45, v74, v75
  v_cvt_pk_bf16_f32 v46, v76, v77
  v_cvt_pk_bf16_f32 v47, v78, v79
  v_pk_mul_f32 v[80:81], v[80:81], s[66:67]
  v_pk_mul_f32 v[82:83], v[82:83], s[66:67]
  v_pk_mul_f32 v[84:85], v[84:85], s[66:67]
  v_pk_mul_f32 v[86:87], v[86:87], s[66:67]
  v_cvt_pk_bf16_f32 v48, v80, v81
  v_cvt_pk_bf16_f32 v49, v82, v83
  v_cvt_pk_bf16_f32 v50, v84, v85
  v_cvt_pk_bf16_f32 v51, v86, v87
  v_pk_mul_f32 v[88:89], v[88:89], s[66:67]
  v_pk_mul_f32 v[90:91], v[90:91], s[66:67]
  v_pk_mul_f32 v[92:93], v[92:93], s[66:67]
  v_pk_mul_f32 v[94:95], v[94:95], s[66:67]
  v_cvt_pk_bf16_f32 v52, v88, v89
  v_cvt_pk_bf16_f32 v53, v90, v91
  v_cvt_pk_bf16_f32 v54, v92, v93
  v_cvt_pk_bf16_f32 v55, v94, v95
  v_pk_mul_f32 v[96:97], v[96:97], s[66:67]
  v_pk_mul_f32 v[98:99], v[98:99], s[66:67]
  v_pk_mul_f32 v[100:101], v[100:101], s[66:67]
  v_pk_mul_f32 v[102:103], v[102:103], s[66:67]
  v_cvt_pk_bf16_f32 v56, v96, v97
  v_cvt_pk_bf16_f32 v57, v98, v99
  v_cvt_pk_bf16_f32 v58, v100, v101
  v_cvt_pk_bf16_f32 v59, v102, v103
  v_pk_mul_f32 v[104:105], v[104:105], s[66:67]
  v_pk_mul_f32 v[106:107], v[106:107], s[66:67]
  v_pk_mul_f32 v[108:109], v[108:109], s[66:67]
  v_pk_mul_f32 v[110:111], v[110:111], s[66:67]
  v_cvt_pk_bf16_f32 v60, v104, v105
  v_cvt_pk_bf16_f32 v61, v106, v107
  v_cvt_pk_bf16_f32 v62, v108, v109
  v_cvt_pk_bf16_f32 v63, v110, v111
  v_pk_mul_f32 v[112:113], v[112:113], s[66:67]
  v_pk_mul_f32 v[114:115], v[114:115], s[66:67]
  v_pk_mul_f32 v[116:117], v[116:117], s[66:67]
  v_pk_mul_f32 v[118:119], v[118:119], s[66:67]
  v_cvt_pk_bf16_f32 v64, v112, v113
  v_cvt_pk_bf16_f32 v65, v114, v115
  v_cvt_pk_bf16_f32 v66, v116, v117
  v_cvt_pk_bf16_f32 v67, v118, v119
  v_pk_mul_f32 v[120:121], v[120:121], s[66:67]
  v_pk_mul_f32 v[122:123], v[122:123], s[66:67]
  v_pk_mul_f32 v[124:125], v[124:125], s[66:67]
  v_pk_mul_f32 v[126:127], v[126:127], s[66:67]
  v_cvt_pk_bf16_f32 v68, v120, v121
  v_cvt_pk_bf16_f32 v69, v122, v123
  v_cvt_pk_bf16_f32 v70, v124, v125
  v_cvt_pk_bf16_f32 v71, v126, v127
  v_pk_mul_f32 v[128:129], v[128:129], s[66:67]
  v_pk_mul_f32 v[130:131], v[130:131], s[66:67]
  v_pk_mul_f32 v[132:133], v[132:133], s[66:67]
  v_pk_mul_f32 v[134:135], v[134:135], s[66:67]
  v_cvt_pk_bf16_f32 v72, v128, v129
  v_cvt_pk_bf16_f32 v73, v130, v131
  v_cvt_pk_bf16_f32 v74, v132, v133
  v_cvt_pk_bf16_f32 v75, v134, v135
  v_pk_mul_f32 v[136:137], v[136:137], s[66:67]
  v_pk_mul_f32 v[138:139], v[138:139], s[66:67]
  v_pk_mul_f32 v[140:141], v[140:141], s[66:67]
  v_pk_mul_f32 v[142:143], v[142:143], s[66:67]
  v_cvt_pk_bf16_f32 v76, v136, v137
  v_cvt_pk_bf16_f32 v77, v138, v139
  v_cvt_pk_bf16_f32 v78, v140, v141
  v_cvt_pk_bf16_f32 v79, v142, v143
  v_pk_mul_f32 v[144:145], v[144:145], s[66:67]
  v_pk_mul_f32 v[146:147], v[146:147], s[66:67]
  v_pk_mul_f32 v[148:149], v[148:149], s[66:67]
  v_pk_mul_f32 v[150:151], v[150:151], s[66:67]
  v_cvt_pk_bf16_f32 v80, v144, v145
  v_cvt_pk_bf16_f32 v81, v146, v147
  v_cvt_pk_bf16_f32 v82, v148, v149
  v_cvt_pk_bf16_f32 v83, v150, v151
  v_pk_mul_f32 v[152:153], v[152:153], s[66:67]
  v_pk_mul_f32 v[154:155], v[154:155], s[66:67]
  v_pk_mul_f32 v[156:157], v[156:157], s[66:67]
  v_pk_mul_f32 v[158:159], v[158:159], s[66:67]
  v_cvt_pk_bf16_f32 v84, v152, v153
  v_cvt_pk_bf16_f32 v85, v154, v155
  v_cvt_pk_bf16_f32 v86, v156, v157
  v_cvt_pk_bf16_f32 v87, v158, v159
  v_pk_mul_f32 v[160:161], v[160:161], s[66:67]
  v_pk_mul_f32 v[162:163], v[162:163], s[66:67]
  v_pk_mul_f32 v[164:165], v[164:165], s[66:67]
  v_pk_mul_f32 v[166:167], v[166:167], s[66:67]
  v_cvt_pk_bf16_f32 v88, v160, v161
  v_cvt_pk_bf16_f32 v89, v162, v163
  v_cvt_pk_bf16_f32 v90, v164, v165
  v_cvt_pk_bf16_f32 v91, v166, v167
  v_pk_mul_f32 v[168:169], v[168:169], s[66:67]
  v_pk_mul_f32 v[170:171], v[170:171], s[66:67]
  v_pk_mul_f32 v[172:173], v[172:173], s[66:67]
  v_pk_mul_f32 v[174:175], v[174:175], s[66:67]
  v_cvt_pk_bf16_f32 v92, v168, v169
  v_cvt_pk_bf16_f32 v93, v170, v171
  v_cvt_pk_bf16_f32 v94, v172, v173
  v_cvt_pk_bf16_f32 v95, v174, v175
  v_add_u32 v13, 0, v9
  v_xor_b32 v13, v13, v10
  v_lshlrev_b32 v13, 4, v13
  v_lshl_add_u32 v13, v10, 8, v13
  v_add_u32 v228, s62, v13
  v_add_u32 v13, 4, v9
  v_xor_b32 v13, v13, v10
  v_lshlrev_b32 v13, 4, v13
  v_lshl_add_u32 v13, v10, 8, v13
  v_add_u32 v229, s62, v13
  v_add_u32 v13, 8, v9
  v_xor_b32 v13, v13, v10
  v_lshlrev_b32 v13, 4, v13
  v_lshl_add_u32 v13, v10, 8, v13
  v_add_u32 v230, s62, v13
  v_add_u32 v13, 12, v9
  v_xor_b32 v13, v13, v10
  v_lshlrev_b32 v13, 4, v13
  v_lshl_add_u32 v13, v10, 8, v13
  v_add_u32 v231, s62, v13
  v_lshl_add_u32 v14, v9, 2, v11
  v_and_b32 v15, 7, v14
  v_lshlrev_b32 v14, 8, v14
  v_lshl_add_u32 v14, v12, 3, v14
  v_add_u32 v14, s62, v14
  v_xor_b32 v13, 0, v15
  v_lshl_add_u32 v232, v13, 5, v14
  v_xor_b32 v13, 1, v15
  v_lshl_add_u32 v233, v13, 5, v14
  v_xor_b32 v13, 2, v15
  v_lshl_add_u32 v234, v13, 5, v14
  v_xor_b32 v13, 3, v15
  v_lshl_add_u32 v235, v13, 5, v14
  v_xor_b32 v13, 4, v15
  v_lshl_add_u32 v236, v13, 5, v14
  v_xor_b32 v13, 5, v15
  v_lshl_add_u32 v237, v13, 5, v14
  v_xor_b32 v13, 6, v15
  v_lshl_add_u32 v238, v13, 5, v14
  v_xor_b32 v13, 7, v15
  v_lshl_add_u32 v239, v13, 5, v14
  s_mov_b32 s73, s74
  s_add_u32 s65, s62, s76
  s_add_u32 m0, s65, 24576
  s_add_u32 s65, s73, s76
  buffer_load_dwordx4 v250, s[36:39], s65 offen offset:0 nt lds
  buffer_load_dwordx4 v251, s[36:39], s65 offen offset:1024 nt lds
  buffer_load_dwordx4 v250, s[36:39], s65 offen offset:2048 nt lds
  buffer_load_dwordx4 v251, s[36:39], s65 offen offset:3072 nt lds
  s_waitcnt vmcnt(12)
  s_barrier
  ds_read_b128 v[144:147], v228 offset:0
  ds_read_b128 v[148:151], v229 offset:0
  ds_read_b128 v[152:155], v230 offset:0
  ds_read_b128 v[156:159], v231 offset:0
  ds_read_b128 v[160:163], v228 offset:4096
  ds_read_b128 v[164:167], v229 offset:4096
  ds_read_b128 v[168:171], v230 offset:4096
  ds_read_b128 v[172:175], v231 offset:4096
K1_ATT_COMMON_A:
  s_waitcnt lgkmcnt(0)
  s_barrier
  s_add_u32 s74, s96, 2
  s_and_b32 s74, s74, 15
  s_lshl_b32 s74, s74, 13
  s_add_u32 s64, s62, s76
  s_add_u32 m0, s64, 0
  s_add_u32 s64, s74, s76
  buffer_load_dwordx4 v246, s[32:35], s64 offen offset:0 nt lds
  buffer_load_dwordx4 v247, s[32:35], s64 offen offset:1024 nt lds
  buffer_load_dwordx4 v248, s[32:35], s64 offen offset:2048 nt lds
  buffer_load_dwordx4 v249, s[32:35], s64 offen offset:3072 nt lds
  s_add_u32 s73, s96, 2
  s_and_b32 s73, s73, 15
  s_lshl_b32 s73, s73, 13
  s_add_u32 s74, s96, 3
  s_and_b32 s74, s74, 15
  s_lshl_b32 s74, s74, 13
  s_mov_b32 s97, 0
  v_mfma_f32_16x16x32_bf16 v[96:99], v[144:147], v[16:19], 0
  v_mfma_f32_16x16x32_bf16 v[96:99], v[148:151], v[20:23], v[96:99]
  v_mfma_f32_16x16x32_bf16 v[96:99], v[152:155], v[24:27], v[96:99]
  v_mfma_f32_16x16x32_bf16 v[96:99], v[156:159], v[28:31], v[96:99]
  v_mfma_f32_16x16x32_bf16 v[100:103], v[160:163], v[16:19], 0
  v_mfma_f32_16x16x32_bf16 v[100:103], v[164:167], v[20:23], v[100:103]
  v_mfma_f32_16x16x32_bf16 v[100:103], v[168:171], v[24:27], v[100:103]
  v_mfma_f32_16x16x32_bf16 v[100:103], v[172:175], v[28:31], v[100:103]
  v_mfma_f32_16x16x32_bf16 v[104:107], v[144:147], v[32:35], 0
  v_mfma_f32_16x16x32_bf16 v[104:107], v[148:151], v[36:39], v[104:107]
  v_mfma_f32_16x16x32_bf16 v[104:107], v[152:155], v[40:43], v[104:107]
  v_mfma_f32_16x16x32_bf16 v[104:107], v[156:159], v[44:47], v[104:107]
  v_mfma_f32_16x16x32_bf16 v[108:111], v[160:163], v[32:35], 0
  v_mfma_f32_16x16x32_bf16 v[108:111], v[164:167], v[36:39], v[108:111]
  v_mfma_f32_16x16x32_bf16 v[108:111], v[168:171], v[40:43], v[108:111]
  v_mfma_f32_16x16x32_bf16 v[108:111], v[172:175], v[44:47], v[108:111]
  v_mfma_f32_16x16x32_bf16 v[112:115], v[144:147], v[48:51], 0
  v_mfma_f32_16x16x32_bf16 v[112:115], v[148:151], v[52:55], v[112:115]
  v_mfma_f32_16x16x32_bf16 v[112:115], v[152:155], v[56:59], v[112:115]
  v_mfma_f32_16x16x32_bf16 v[112:115], v[156:159], v[60:63], v[112:115]
  v_mfma_f32_16x16x32_bf16 v[116:119], v[160:163], v[48:51], 0
  v_mfma_f32_16x16x32_bf16 v[116:119], v[164:167], v[52:55], v[116:119]
  v_mfma_f32_16x16x32_bf16 v[116:119], v[168:171], v[56:59], v[116:119]
  v_mfma_f32_16x16x32_bf16 v[116:119], v[172:175], v[60:63], v[116:119]
  v_mfma_f32_16x16x32_bf16 v[120:123], v[144:147], v[64:67], 0
  v_mfma_f32_16x16x32_bf16 v[120:123], v[148:151], v[68:71], v[120:123]
  v_mfma_f32_16x16x32_bf16 v[120:123], v[152:155], v[72:75], v[120:123]
  v_mfma_f32_16x16x32_bf16 v[120:123], v[156:159], v[76:79], v[120:123]
  v_mfma_f32_16x16x32_bf16 v[124:127], v[160:163], v[64:67], 0
  v_mfma_f32_16x16x32_bf16 v[124:127], v[164:167], v[68:71], v[124:127]
  v_mfma_f32_16x16x32_bf16 v[124:127], v[168:171], v[72:75], v[124:127]
  v_mfma_f32_16x16x32_bf16 v[124:127], v[172:175], v[76:79], v[124:127]
  v_mfma_f32_16x16x32_bf16 v[128:131], v[144:147], v[80:83], 0
  v_mfma_f32_16x16x32_bf16 v[128:131], v[148:151], v[84:87], v[128:131]
  v_mfma_f32_16x16x32_bf16 v[128:131], v[152:155], v[88:91], v[128:131]
  v_mfma_f32_16x16x32_bf16 v[128:131], v[156:159], v[92:95], v[128:131]
  v_mfma_f32_16x16x32_bf16 v[132:135], v[160:163], v[80:83], 0
  v_mfma_f32_16x16x32_bf16 v[132:135], v[164:167], v[84:87], v[132:135]
  v_mfma_f32_16x16x32_bf16 v[132:135], v[168:171], v[88:91], v[132:135]
  v_mfma_f32_16x16x32_bf16 v[132:135], v[172:175], v[92:95], v[132:135]
  s_nop 7
  s_nop 1
  v_max3_f32 v13, v96, v97, v98
  v_max3_f32 v13, v13, v99, v100
  v_max3_f32 v13, v13, v101, v102
  v_max_f32 v13, v13, v103
  v_mov_b32 v14, v13
  s_nop 1
  v_permlane32_swap_b32 v13, v14
  s_nop 1
  v_max_f32 v13, v13, v14
  v_mov_b32 v14, v13
  s_nop 1
  v_permlane16_swap_b32 v13, v14
  s_nop 1
  v_max_f32 v13, v13, v14
  v_sub_f32 v208, 0, v13
  v_sub_f32 v209, 0, v13
  v_sub_f32 v210, 0, v13
  v_sub_f32 v211, 0, v13
  v_max3_f32 v13, v104, v105, v106
  v_max3_f32 v13, v13, v107, v108
  v_max3_f32 v13, v13, v109, v110
  v_max_f32 v13, v13, v111
  v_mov_b32 v14, v13
  s_nop 1
  v_permlane32_swap_b32 v13, v14
  s_nop 1
  v_max_f32 v13, v13, v14
  v_mov_b32 v14, v13
  s_nop 1
  v_permlane16_swap_b32 v13, v14
  s_nop 1
  v_max_f32 v13, v13, v14
  v_sub_f32 v212, 0, v13
  v_sub_f32 v213, 0, v13
  v_sub_f32 v214, 0, v13
  v_sub_f32 v215, 0, v13
  v_max3_f32 v13, v112, v113, v114
  v_max3_f32 v13, v13, v115, v116
  v_max3_f32 v13, v13, v117, v118
  v_max_f32 v13, v13, v119
  v_mov_b32 v14, v13
  s_nop 1
  v_permlane32_swap_b32 v13, v14
  s_nop 1
  v_max_f32 v13, v13, v14
  v_mov_b32 v14, v13
  s_nop 1
  v_permlane16_swap_b32 v13, v14
  s_nop 1
  v_max_f32 v13, v13, v14
  v_sub_f32 v216, 0, v13
  v_sub_f32 v217, 0, v13
  v_sub_f32 v218, 0, v13
  v_sub_f32 v219, 0, v13
  v_max3_f32 v13, v120, v121, v122
  v_max3_f32 v13, v13, v123, v124
  v_max3_f32 v13, v13, v125, v126
  v_max_f32 v13, v13, v127
  v_mov_b32 v14, v13
  s_nop 1
  v_permlane32_swap_b32 v13, v14
  s_nop 1
  v_max_f32 v13, v13, v14
  v_mov_b32 v14, v13
  s_nop 1
  v_permlane16_swap_b32 v13, v14
  s_nop 1
  v_max_f32 v13, v13, v14
  v_sub_f32 v220, 0, v13
  v_sub_f32 v221, 0, v13
  v_sub_f32 v222, 0, v13
  v_sub_f32 v223, 0, v13
  v_max3_f32 v13, v128, v129, v130
  v_max3_f32 v13, v13, v131, v132
  v_max3_f32 v13, v13, v133, v134
  v_max_f32 v13, v13, v135
  v_mov_b32 v14, v13
  s_nop 1
  v_permlane32_swap_b32 v13, v14
  s_nop 1
  v_max_f32 v13, v13, v14
  v_mov_b32 v14, v13
  s_nop 1
  v_permlane16_swap_b32 v13, v14
  s_nop 1
  v_max_f32 v13, v13, v14
  v_sub_f32 v224, 0, v13
  v_sub_f32 v225, 0, v13
  v_sub_f32 v226, 0, v13
  v_sub_f32 v227, 0, v13
  v_add_f32 v96, v96, v208
  v_add_f32 v97, v97, v208
  v_add_f32 v98, v98, v208
  v_add_f32 v99, v99, v208
  v_add_f32 v100, v100, v208
  v_add_f32 v101, v101, v208
  v_add_f32 v102, v102, v208
  v_add_f32 v103, v103, v208
  v_add_f32 v104, v104, v212
  v_add_f32 v105, v105, v212
  v_add_f32 v106, v106, v212
  v_add_f32 v107, v107, v212
  v_add_f32 v108, v108, v212
  v_add_f32 v109, v109, v212
  v_add_f32 v110, v110, v212
  v_add_f32 v111, v111, v212
  v_add_f32 v112, v112, v216
  v_add_f32 v113, v113, v216
  v_add_f32 v114, v114, v216
  v_add_f32 v115, v115, v216
  v_add_f32 v116, v116, v216
  v_add_f32 v117, v117, v216
  v_add_f32 v118, v118, v216
  v_add_f32 v119, v119, v216
  v_mov_b32 v136, 0
  v_mov_b32 v137, 0
  v_mov_b32 v138, 0
  v_mov_b32 v139, 0
  v_mov_b32 v176, 0
  v_mov_b32 v177, 0
  v_mov_b32 v178, 0
  v_mov_b32 v179, 0
  v_mov_b32 v180, 0
  v_mov_b32 v181, 0
  v_mov_b32 v182, 0
  v_mov_b32 v183, 0
  v_mov_b32 v184, 0
  v_mov_b32 v185, 0
  v_mov_b32 v186, 0
  v_mov_b32 v187, 0
  v_mov_b32 v188, 0
  v_mov_b32 v189, 0
  v_mov_b32 v190, 0
  v_mov_b32 v191, 0
  v_mov_b32 v192, 0
  v_mov_b32 v193, 0
  v_mov_b32 v194, 0
  v_mov_b32 v195, 0
  v_mov_b32 v196, 0
  v_mov_b32 v197, 0
  v_mov_b32 v198, 0
  v_mov_b32 v199, 0
  v_mov_b32 v200, 0
  v_mov_b32 v201, 0
  v_mov_b32 v202, 0
  v_mov_b32 v203, 0
  v_mov_b32 v204, 0
  v_mov_b32 v205, 0
  v_mov_b32 v206, 0
  v_mov_b32 v207, 0
  s_mov_b32 s68, 0
K1_ALOOP_A:
  s_waitcnt vmcnt(8)
  s_barrier
  v_mfma_f32_16x16x32_bf16 a[128:131], v[176:179], v[136:139], a[128:131]
  ds_read_b64_tr_b16 v[176:177], v232 offset:8192
  ds_read_b64_tr_b16 v[178:179], v232 offset:12288
  v_mfma_f32_16x16x32_bf16 a[132:135], v[180:183], v[136:139], a[132:135]
  ds_read_b64_tr_b16 v[180:181], v233 offset:8192
  ds_read_b64_tr_b16 v[182:183], v233 offset:12288
  v_mfma_f32_16x16x32_bf16 a[136:139], v[184:187], v[136:139], a[136:139]
  ds_read_b64_tr_b16 v[184:185], v234 offset:8192
  ds_read_b64_tr_b16 v[186:187], v234 offset:12288
  v_mfma_f32_16x16x32_bf16 a[140:143], v[188:191], v[136:139], a[140:143]
  ds_read_b64_tr_b16 v[188:189], v235 offset:8192
  ds_read_b64_tr_b16 v[190:191], v235 offset:12288
  v_mfma_f32_16x16x32_bf16 a[144:147], v[192:195], v[136:139], a[144:147]
  ds_read_b64_tr_b16 v[192:193], v236 offset:8192
  ds_read_b64_tr_b16 v[194:195], v236 offset:12288
  v_mfma_f32_16x16x32_bf16 a[148:151], v[196:199], v[136:139], a[148:151]
  ds_read_b64_tr_b16 v[196:197], v237 offset:8192
  ds_read_b64_tr_b16 v[198:199], v237 offset:12288
  v_mfma_f32_16x16x32_bf16 a[152:155], v[200:203], v[136:139], a[152:155]
  ds_read_b64_tr_b16 v[200:201], v238 offset:8192
  ds_read_b64_tr_b16 v[202:203], v238 offset:12288
  v_mfma_f32_16x16x32_bf16 a[156:159], v[204:207], v[136:139], a[156:159]
  ds_read_b64_tr_b16 v[204:205], v239 offset:8192
  ds_read_b64_tr_b16 v[206:207], v239 offset:12288
  v_mfma_f32_16x16x32_bf16 a[176:179], a[180:183], v[136:139], a[176:179]
  v_exp_f32 v96, v96
  v_mfma_f32_16x16x32_bf16 v[120:123], v[144:147], v[64:67], v[220:223]
  v_exp_f32 v97, v97
  v_mfma_f32_16x16x32_bf16 v[120:123], v[148:151], v[68:71], v[120:123]
  v_exp_f32 v98, v98
  v_mfma_f32_16x16x32_bf16 v[120:123], v[152:155], v[72:75], v[120:123]
  v_exp_f32 v99, v99
  v_cvt_pk_bf16_f32 v136, v96, v97
  v_mfma_f32_16x16x32_bf16 v[120:123], v[156:159], v[76:79], v[120:123]
  v_exp_f32 v100, v100
  v_mfma_f32_16x16x32_bf16 v[124:127], v[160:163], v[64:67], v[220:223]
  v_exp_f32 v101, v101
  v_cvt_pk_bf16_f32 v137, v98, v99
  v_mfma_f32_16x16x32_bf16 v[124:127], v[164:167], v[68:71], v[124:127]
  v_exp_f32 v102, v102
  v_mfma_f32_16x16x32_bf16 v[124:127], v[168:171], v[72:75], v[124:127]
  v_exp_f32 v103, v103
  v_cvt_pk_bf16_f32 v138, v100, v101
  v_mfma_f32_16x16x32_bf16 v[124:127], v[172:175], v[76:79], v[124:127]
  s_nop 0
  v_cvt_pk_bf16_f32 v139, v102, v103
  v_mfma_f32_16x16x32_bf16 v[128:131], v[144:147], v[80:83], v[224:227]
  ds_read_b128 v[144:147], v228 offset:16384
  v_exp_f32 v104, v104
  v_mfma_f32_16x16x32_bf16 v[128:131], v[148:151], v[84:87], v[128:131]
  ds_read_b128 v[148:151], v229 offset:16384
  v_mfma_f32_16x16x32_bf16 v[128:131], v[152:155], v[88:91], v[128:131]
  ds_read_b128 v[152:155], v230 offset:16384
  v_exp_f32 v105, v105
  v_mfma_f32_16x16x32_bf16 v[128:131], v[156:159], v[92:95], v[128:131]
  ds_read_b128 v[156:159], v231 offset:16384
  v_mfma_f32_16x16x32_bf16 v[132:135], v[160:163], v[80:83], v[224:227]
  ds_read_b128 v[160:163], v228 offset:20480
  v_exp_f32 v106, v106
  v_mfma_f32_16x16x32_bf16 v[132:135], v[164:167], v[84:87], v[132:135]
  ds_read_b128 v[164:167], v229 offset:20480
  v_cvt_pk_bf16_f32 v140, v104, v105
  v_mfma_f32_16x16x32_bf16 v[132:135], v[168:171], v[88:91], v[132:135]
  ds_read_b128 v[168:171], v230 offset:20480
  v_exp_f32 v107, v107
  v_mfma_f32_16x16x32_bf16 v[132:135], v[172:175], v[92:95], v[132:135]
  ds_read_b128 v[172:175], v231 offset:20480
  s_waitcnt lgkmcnt(8)
  v_mfma_f32_16x16x32_bf16 a[0:3], v[176:179], v[136:139], a[0:3]
  v_exp_f32 v108, v108
  v_mfma_f32_16x16x32_bf16 a[4:7], v[180:183], v[136:139], a[4:7]
  v_cvt_pk_bf16_f32 v141, v106, v107
  v_mfma_f32_16x16x32_bf16 a[8:11], v[184:187], v[136:139], a[8:11]
  v_exp_f32 v109, v109
  v_mfma_f32_16x16x32_bf16 a[12:15], v[188:191], v[136:139], a[12:15]
  v_mfma_f32_16x16x32_bf16 a[16:19], v[192:195], v[136:139], a[16:19]
  v_exp_f32 v110, v110
  v_mfma_f32_16x16x32_bf16 a[20:23], v[196:199], v[136:139], a[20:23]
  v_cvt_pk_bf16_f32 v142, v108, v109
  v_mfma_f32_16x16x32_bf16 a[24:27], v[200:203], v[136:139], a[24:27]
  v_exp_f32 v111, v111
  v_mfma_f32_16x16x32_bf16 a[28:31], v[204:207], v[136:139], a[28:31]
  v_mfma_f32_16x16x32_bf16 a[160:163], a[180:183], v[136:139], a[160:163]
  v_cvt_pk_bf16_f32 v143, v110, v111
  s_waitcnt lgkmcnt(0)
  s_barrier
  v_mfma_f32_16x16x32_bf16 v[96:99], v[144:147], v[16:19], v[208:211]
  v_exp_f32 v112, v112
  v_mfma_f32_16x16x32_bf16 v[96:99], v[148:151], v[20:23], v[96:99]
  s_add_u32 s65, s62, s76
  s_add_u32 m0, s65, 8192
  s_add_u32 s65, s73, s76
  s_waitcnt vmcnt(4)
  buffer_load_dwordx4 v250, s[36:39], s65 offen offset:0 nt lds
  v_mfma_f32_16x16x32_bf16 v[96:99], v[152:155], v[24:27], v[96:99]
  v_exp_f32 v113, v113
  v_mfma_f32_16x16x32_bf16 v[96:99], v[156:159], v[28:31], v[96:99]
  v_cvt_pk_bf16_f32 v136, v112, v113
  v_mfma_f32_16x16x32_bf16 v[100:103], v[160:163], v[16:19], v[208:211]
  v_exp_f32 v114, v114
  v_mfma_f32_16x16x32_bf16 v[100:103], v[164:167], v[20:23], v[100:103]
  s_waitcnt vmcnt(4)
  buffer_load_dwordx4 v251, s[36:39], s65 offen offset:1024 nt lds
  v_mfma_f32_16x16x32_bf16 v[100:103], v[168:171], v[24:27], v[100:103]
  v_exp_f32 v115, v115
  v_mfma_f32_16x16x32_bf16 v[100:103], v[172:175], v[28:31], v[100:103]
  v_cvt_pk_bf16_f32 v137, v114, v115
  v_mfma_f32_16x16x32_bf16 a[32:35], v[176:179], v[140:143], a[32:35]
  v_exp_f32 v116, v116
  v_mfma_f32_16x16x32_bf16 a[36:39], v[180:183], v[140:143], a[36:39]
  s_waitcnt vmcnt(4)
  buffer_load_dwordx4 v250, s[36:39], s65 offen offset:2048 nt lds
  v_mfma_f32_16x16x32_bf16 a[40:43], v[184:187], v[140:143], a[40:43]
  v_exp_f32 v117, v117
  v_mfma_f32_16x16x32_bf16 a[44:47], v[188:191], v[140:143], a[44:47]
  v_cvt_pk_bf16_f32 v138, v116, v117
  v_mfma_f32_16x16x32_bf16 a[48:51], v[192:195], v[140:143], a[48:51]
  v_exp_f32 v118, v118
  v_mfma_f32_16x16x32_bf16 a[52:55], v[196:199], v[140:143], a[52:55]
  s_waitcnt vmcnt(4)
  buffer_load_dwordx4 v251, s[36:39], s65 offen offset:3072 nt lds
  v_mfma_f32_16x16x32_bf16 a[56:59], v[200:203], v[140:143], a[56:59]
  v_exp_f32 v119, v119
  v_mfma_f32_16x16x32_bf16 a[60:63], v[204:207], v[140:143], a[60:63]
  v_cvt_pk_bf16_f32 v139, v118, v119
  v_mfma_f32_16x16x32_bf16 a[164:167], a[180:183], v[140:143], a[164:167]
  v_mfma_f32_16x16x32_bf16 v[104:107], v[144:147], v[32:35], v[212:215]
  v_exp_f32 v120, v120
  v_mfma_f32_16x16x32_bf16 v[104:107], v[148:151], v[36:39], v[104:107]
  s_add_u32 s64, s62, s76
  s_add_u32 m0, s64, 16384
  s_add_u32 s64, s74, s76
  s_waitcnt vmcnt(4)
  buffer_load_dwordx4 v246, s[32:35], s64 offen offset:0 nt lds
  v_mfma_f32_16x16x32_bf16 v[104:107], v[152:155], v[40:43], v[104:107]
  v_exp_f32 v121, v121
  v_mfma_f32_16x16x32_bf16 v[104:107], v[156:159], v[44:47], v[104:107]
  v_cvt_pk_bf16_f32 v140, v120, v121
  v_mfma_f32_16x16x32_bf16 v[108:111], v[160:163], v[32:35], v[212:215]
  v_exp_f32 v122, v122
  v_mfma_f32_16x16x32_bf16 v[108:111], v[164:167], v[36:39], v[108:111]
  s_waitcnt vmcnt(4)
  buffer_load_dwordx4 v247, s[32:35], s64 offen offset:1024 nt lds
  v_mfma_f32_16x16x32_bf16 v[108:111], v[168:171], v[40:43], v[108:111]
  v_exp_f32 v123, v123
  v_mfma_f32_16x16x32_bf16 v[108:111], v[172:175], v[44:47], v[108:111]
  v_cvt_pk_bf16_f32 v141, v122, v123
  v_mfma_f32_16x16x32_bf16 a[64:67], v[176:179], v[136:139], a[64:67]
  v_exp_f32 v124, v124
  v_mfma_f32_16x16x32_bf16 a[68:71], v[180:183], v[136:139], a[68:71]
  s_waitcnt vmcnt(4)
  buffer_load_dwordx4 v248, s[32:35], s64 offen offset:2048 nt lds
  v_mfma_f32_16x16x32_bf16 a[72:75], v[184:187], v[136:139], a[72:75]
  v_exp_f32 v125, v125
  v_mfma_f32_16x16x32_bf16 a[76:79], v[188:191], v[136:139], a[76:79]
  v_cvt_pk_bf16_f32 v142, v124, v125
  v_mfma_f32_16x16x32_bf16 a[80:83], v[192:195], v[136:139], a[80:83]
  v_exp_f32 v126, v126
  v_mfma_f32_16x16x32_bf16 a[84:87], v[196:199], v[136:139], a[84:87]
  s_waitcnt vmcnt(4)
  buffer_load_dwordx4 v249, s[32:35], s64 offen offset:3072 nt lds
  v_mfma_f32_16x16x32_bf16 a[88:91], v[200:203], v[136:139], a[88:91]
  v_exp_f32 v127, v127
  v_mfma_f32_16x16x32_bf16 a[92:95], v[204:207], v[136:139], a[92:95]
  v_cvt_pk_bf16_f32 v143, v126, v127
  v_mfma_f32_16x16x32_bf16 a[168:171], a[180:183], v[136:139], a[168:171]
  v_mfma_f32_16x16x32_bf16 v[112:115], v[144:147], v[48:51], v[216:219]
  v_exp_f32 v128, v128
  v_mfma_f32_16x16x32_bf16 v[112:115], v[148:151], v[52:55], v[112:115]
  s_add_u32 s97, s97, 1
  s_add_u32 s66, s97, s96
  v_mfma_f32_16x16x32_bf16 v[112:115], v[152:155], v[56:59], v[112:115]
  v_exp_f32 v129, v129
  v_mfma_f32_16x16x32_bf16 v[112:115], v[156:159], v[60:63], v[112:115]
  v_cvt_pk_bf16_f32 v136, v128, v129
  v_mfma_f32_16x16x32_bf16 v[116:119], v[160:163], v[48:51], v[216:219]
  v_exp_f32 v130, v130
  v_mfma_f32_16x16x32_bf16 v[116:119], v[164:167], v[52:55], v[116:119]
  s_add_u32 s73, s66, 2
  s_and_b32 s73, s73, 15
  v_mfma_f32_16x16x32_bf16 v[116:119], v[168:171], v[56:59], v[116:119]
  v_exp_f32 v131, v131
  v_mfma_f32_16x16x32_bf16 v[116:119], v[172:175], v[60:63], v[116:119]
  v_cvt_pk_bf16_f32 v137, v130, v131
  v_mfma_f32_16x16x32_bf16 a[96:99], v[176:179], v[140:143], a[96:99]
  v_exp_f32 v132, v132
  v_mfma_f32_16x16x32_bf16 a[100:103], v[180:183], v[140:143], a[100:103]
  s_lshl_b32 s73, s73, 13
  s_cmp_lt_u32 s97, 14
  s_cselect_b32 s73, s73, 0x40000000
  v_mfma_f32_16x16x32_bf16 a[104:107], v[184:187], v[140:143], a[104:107]
  v_exp_f32 v133, v133
  v_mfma_f32_16x16x32_bf16 a[108:111], v[188:191], v[140:143], a[108:111]
  v_cvt_pk_bf16_f32 v138, v132, v133
  v_mfma_f32_16x16x32_bf16 a[112:115], v[192:195], v[140:143], a[112:115]
  v_exp_f32 v134, v134
  v_mfma_f32_16x16x32_bf16 a[116:119], v[196:199], v[140:143], a[116:119]
  s_add_u32 s74, s66, 3
  s_and_b32 s74, s74, 15
  v_mfma_f32_16x16x32_bf16 a[120:123], v[200:203], v[140:143], a[120:123]
  v_exp_f32 v135, v135
  v_mfma_f32_16x16x32_bf16 a[124:127], v[204:207], v[140:143], a[124:127]
  v_cvt_pk_bf16_f32 v139, v134, v135
  v_mfma_f32_16x16x32_bf16 a[172:175], a[180:183], v[140:143], a[172:175]
  s_lshl_b32 s74, s74, 13
  s_cmp_lt_u32 s97, 13
  s_cselect_b32 s74, s74, 0x40000000
  s_waitcnt vmcnt(8)
  s_barrier
  v_mfma_f32_16x16x32_bf16 a[128:131], v[176:179], v[136:139], a[128:131]
  ds_read_b64_tr_b16 v[176:177], v232 offset:24576
  ds_read_b64_tr_b16 v[178:179], v232 offset:28672
  v_mfma_f32_16x16x32_bf16 a[132:135], v[180:183], v[136:139], a[132:135]
  ds_read_b64_tr_b16 v[180:181], v233 offset:24576
  ds_read_b64_tr_b16 v[182:183], v233 offset:28672
  v_mfma_f32_16x16x32_bf16 a[136:139], v[184:187], v[136:139], a[136:139]
  ds_read_b64_tr_b16 v[184:185], v234 offset:24576
  ds_read_b64_tr_b16 v[186:187], v234 offset:28672
  v_mfma_f32_16x16x32_bf16 a[140:143], v[188:191], v[136:139], a[140:143]
  ds_read_b64_tr_b16 v[188:189], v235 offset:24576
  ds_read_b64_tr_b16 v[190:191], v235 offset:28672
  v_mfma_f32_16x16x32_bf16 a[144:147], v[192:195], v[136:139], a[144:147]
  ds_read_b64_tr_b16 v[192:193], v236 offset:24576
  ds_read_b64_tr_b16 v[194:195], v236 offset:28672
  v_mfma_f32_16x16x32_bf16 a[148:151], v[196:199], v[136:139], a[148:151]
  ds_read_b64_tr_b16 v[196:197], v237 offset:24576
  ds_read_b64_tr_b16 v[198:199], v237 offset:28672
  v_mfma_f32_16x16x32_bf16 a[152:155], v[200:203], v[136:139], a[152:155]
  ds_read_b64_tr_b16 v[200:201], v238 offset:24576
  ds_read_b64_tr_b16 v[202:203], v238 offset:28672
  v_mfma_f32_16x16x32_bf16 a[156:159], v[204:207], v[136:139], a[156:159]
  ds_read_b64_tr_b16 v[204:205], v239 offset:24576
  ds_read_b64_tr_b16 v[206:207], v239 offset:28672
  v_mfma_f32_16x16x32_bf16 a[176:179], a[180:183], v[136:139], a[176:179]
  v_exp_f32 v96, v96
  v_mfma_f32_16x16x32_bf16 v[120:123], v[144:147], v[64:67], v[220:223]
  v_exp_f32 v97, v97
  v_mfma_f32_16x16x32_bf16 v[120:123], v[148:151], v[68:71], v[120:123]
  v_exp_f32 v98, v98
  v_mfma_f32_16x16x32_bf16 v[120:123], v[152:155], v[72:75], v[120:123]
  v_exp_f32 v99, v99
  v_cvt_pk_bf16_f32 v136, v96, v97
  v_mfma_f32_16x16x32_bf16 v[120:123], v[156:159], v[76:79], v[120:123]
  v_exp_f32 v100, v100
  v_mfma_f32_16x16x32_bf16 v[124:127], v[160:163], v[64:67], v[220:223]
  v_exp_f32 v101, v101
  v_cvt_pk_bf16_f32 v137, v98, v99
  v_mfma_f32_16x16x32_bf16 v[124:127], v[164:167], v[68:71], v[124:127]
  v_exp_f32 v102, v102
  v_mfma_f32_16x16x32_bf16 v[124:127], v[168:171], v[72:75], v[124:127]
  v_exp_f32 v103, v103
  v_cvt_pk_bf16_f32 v138, v100, v101
  v_mfma_f32_16x16x32_bf16 v[124:127], v[172:175], v[76:79], v[124:127]
  s_nop 0
  v_cvt_pk_bf16_f32 v139, v102, v103
  v_mfma_f32_16x16x32_bf16 v[128:131], v[144:147], v[80:83], v[224:227]
  ds_read_b128 v[144:147], v228 offset:0
  v_exp_f32 v104, v104
  v_mfma_f32_16x16x32_bf16 v[128:131], v[148:151], v[84:87], v[128:131]
  ds_read_b128 v[148:151], v229 offset:0
  v_mfma_f32_16x16x32_bf16 v[128:131], v[152:155], v[88:91], v[128:131]
  ds_read_b128 v[152:155], v230 offset:0
  v_exp_f32 v105, v105
  v_mfma_f32_16x16x32_bf16 v[128:131], v[156:159], v[92:95], v[128:131]
  ds_read_b128 v[156:159], v231 offset:0
  v_mfma_f32_16x16x32_bf16 v[132:135], v[160:163], v[80:83], v[224:227]
  ds_read_b128 v[160:163], v228 offset:4096
  v_exp_f32 v106, v106
  v_mfma_f32_16x16x32_bf16 v[132:135], v[164:167], v[84:87], v[132:135]
  ds_read_b128 v[164:167], v229 offset:4096
  v_cvt_pk_bf16_f32 v140, v104, v105
  v_mfma_f32_16x16x32_bf16 v[132:135], v[168:171], v[88:91], v[132:135]
  ds_read_b128 v[168:171], v230 offset:4096
  v_exp_f32 v107, v107
  v_mfma_f32_16x16x32_bf16 v[132:135], v[172:175], v[92:95], v[132:135]
  ds_read_b128 v[172:175], v231 offset:4096
  s_waitcnt lgkmcnt(8)
  v_mfma_f32_16x16x32_bf16 a[0:3], v[176:179], v[136:139], a[0:3]
  v_exp_f32 v108, v108
  v_mfma_f32_16x16x32_bf16 a[4:7], v[180:183], v[136:139], a[4:7]
  v_cvt_pk_bf16_f32 v141, v106, v107
  v_mfma_f32_16x16x32_bf16 a[8:11], v[184:187], v[136:139], a[8:11]
  v_exp_f32 v109, v109
  v_mfma_f32_16x16x32_bf16 a[12:15], v[188:191], v[136:139], a[12:15]
  v_mfma_f32_16x16x32_bf16 a[16:19], v[192:195], v[136:139], a[16:19]
  v_exp_f32 v110, v110
  v_mfma_f32_16x16x32_bf16 a[20:23], v[196:199], v[136:139], a[20:23]
  v_cvt_pk_bf16_f32 v142, v108, v109
  v_mfma_f32_16x16x32_bf16 a[24:27], v[200:203], v[136:139], a[24:27]
  v_exp_f32 v111, v111
  v_mfma_f32_16x16x32_bf16 a[28:31], v[204:207], v[136:139], a[28:31]
  v_mfma_f32_16x16x32_bf16 a[160:163], a[180:183], v[136:139], a[160:163]
  v_cvt_pk_bf16_f32 v143, v110, v111
  s_waitcnt lgkmcnt(0)
  s_barrier
  v_mfma_f32_16x16x32_bf16 v[96:99], v[144:147], v[16:19], v[208:211]
  v_exp_f32 v112, v112
  v_mfma_f32_16x16x32_bf16 v[96:99], v[148:151], v[20:23], v[96:99]
  s_add_u32 s65, s62, s76
  s_add_u32 m0, s65, 24576
  s_add_u32 s65, s73, s76
  s_waitcnt vmcnt(4)
  buffer_load_dwordx4 v250, s[36:39], s65 offen offset:0 nt lds
  v_mfma_f32_16x16x32_bf16 v[96:99], v[152:155], v[24:27], v[96:99]
  v_exp_f32 v113, v113
  v_mfma_f32_16x16x32_bf16 v[96:99], v[156:159], v[28:31], v[96:99]
  v_cvt_pk_bf16_f32 v136, v112, v113
  v_mfma_f32_16x16x32_bf16 v[100:103], v[160:163], v[16:19], v[208:211]
  v_exp_f32 v114, v114
  v_mfma_f32_16x16x32_bf16 v[100:103], v[164:167], v[20:23], v[100:103]
  s_waitcnt vmcnt(4)
  buffer_load_dwordx4 v251, s[36:39], s65 offen offset:1024 nt lds
  v_mfma_f32_16x16x32_bf16 v[100:103], v[168:171], v[24:27], v[100:103]
  v_exp_f32 v115, v115
  v_mfma_f32_16x16x32_bf16 v[100:103], v[172:175], v[28:31], v[100:103]
  v_cvt_pk_bf16_f32 v137, v114, v115
  v_mfma_f32_16x16x32_bf16 a[32:35], v[176:179], v[140:143], a[32:35]
  v_exp_f32 v116, v116
  v_mfma_f32_16x16x32_bf16 a[36:39], v[180:183], v[140:143], a[36:39]
  s_waitcnt vmcnt(4)
  buffer_load_dwordx4 v250, s[36:39], s65 offen offset:2048 nt lds
  v_mfma_f32_16x16x32_bf16 a[40:43], v[184:187], v[140:143], a[40:43]
  v_exp_f32 v117, v117
  v_mfma_f32_16x16x32_bf16 a[44:47], v[188:191], v[140:143], a[44:47]
  v_cvt_pk_bf16_f32 v138, v116, v117
  v_mfma_f32_16x16x32_bf16 a[48:51], v[192:195], v[140:143], a[48:51]
  v_exp_f32 v118, v118
  v_mfma_f32_16x16x32_bf16 a[52:55], v[196:199], v[140:143], a[52:55]
  s_waitcnt vmcnt(4)
  buffer_load_dwordx4 v251, s[36:39], s65 offen offset:3072 nt lds
  v_mfma_f32_16x16x32_bf16 a[56:59], v[200:203], v[140:143], a[56:59]
  v_exp_f32 v119, v119
  v_mfma_f32_16x16x32_bf16 a[60:63], v[204:207], v[140:143], a[60:63]
  v_cvt_pk_bf16_f32 v139, v118, v119
  v_mfma_f32_16x16x32_bf16 a[164:167], a[180:183], v[140:143], a[164:167]
  v_mfma_f32_16x16x32_bf16 v[104:107], v[144:147], v[32:35], v[212:215]
  v_exp_f32 v120, v120
  v_mfma_f32_16x16x32_bf16 v[104:107], v[148:151], v[36:39], v[104:107]
  s_add_u32 s64, s62, s76
  s_add_u32 m0, s64, 0
  s_add_u32 s64, s74, s76
  s_waitcnt vmcnt(4)
  buffer_load_dwordx4 v246, s[32:35], s64 offen offset:0 nt lds
  v_mfma_f32_16x16x32_bf16 v[104:107], v[152:155], v[40:43], v[104:107]
  v_exp_f32 v121, v121
  v_mfma_f32_16x16x32_bf16 v[104:107], v[156:159], v[44:47], v[104:107]
  v_cvt_pk_bf16_f32 v140, v120, v121
  v_mfma_f32_16x16x32_bf16 v[108:111], v[160:163], v[32:35], v[212:215]
  v_exp_f32 v122, v122
  v_mfma_f32_16x16x32_bf16 v[108:111], v[164:167], v[36:39], v[108:111]
  s_waitcnt vmcnt(4)
  buffer_load_dwordx4 v247, s[32:35], s64 offen offset:1024 nt lds
  v_mfma_f32_16x16x32_bf16 v[108:111], v[168:171], v[40:43], v[108:111]
  v_exp_f32 v123, v123
  v_mfma_f32_16x16x32_bf16 v[108:111], v[172:175], v[44:47], v[108:111]
  v_cvt_pk_bf16_f32 v141, v122, v123
  v_mfma_f32_16x16x32_bf16 a[64:67], v[176:179], v[136:139], a[64:67]
  v_exp_f32 v124, v124
  v_mfma_f32_16x16x32_bf16 a[68:71], v[180:183], v[136:139], a[68:71]
  s_waitcnt vmcnt(4)
  buffer_load_dwordx4 v248, s[32:35], s64 offen offset:2048 nt lds
  v_mfma_f32_16x16x32_bf16 a[72:75], v[184:187], v[136:139], a[72:75]
  v_exp_f32 v125, v125
  v_mfma_f32_16x16x32_bf16 a[76:79], v[188:191], v[136:139], a[76:79]
  v_cvt_pk_bf16_f32 v142, v124, v125
  v_mfma_f32_16x16x32_bf16 a[80:83], v[192:195], v[136:139], a[80:83]
  v_exp_f32 v126, v126
  v_mfma_f32_16x16x32_bf16 a[84:87], v[196:199], v[136:139], a[84:87]
  s_waitcnt vmcnt(4)
  buffer_load_dwordx4 v249, s[32:35], s64 offen offset:3072 nt lds
  v_mfma_f32_16x16x32_bf16 a[88:91], v[200:203], v[136:139], a[88:91]
  v_exp_f32 v127, v127
  v_mfma_f32_16x16x32_bf16 a[92:95], v[204:207], v[136:139], a[92:95]
  v_cvt_pk_bf16_f32 v143, v126, v127
  v_mfma_f32_16x16x32_bf16 a[168:171], a[180:183], v[136:139], a[168:171]
  v_mfma_f32_16x16x32_bf16 v[112:115], v[144:147], v[48:51], v[216:219]
  v_exp_f32 v128, v128
  v_mfma_f32_16x16x32_bf16 v[112:115], v[148:151], v[52:55], v[112:115]
  s_add_u32 s97, s97, 1
  s_add_u32 s66, s97, s96
  v_mfma_f32_16x16x32_bf16 v[112:115], v[152:155], v[56:59], v[112:115]
  v_exp_f32 v129, v129
  v_mfma_f32_16x16x32_bf16 v[112:115], v[156:159], v[60:63], v[112:115]
  v_cvt_pk_bf16_f32 v136, v128, v129
  v_mfma_f32_16x16x32_bf16 v[116:119], v[160:163], v[48:51], v[216:219]
  v_exp_f32 v130, v130
  v_mfma_f32_16x16x32_bf16 v[116:119], v[164:167], v[52:55], v[116:119]
  s_add_u32 s73, s66, 2
  s_and_b32 s73, s73, 15
  v_mfma_f32_16x16x32_bf16 v[116:119], v[168:171], v[56:59], v[116:119]
  v_exp_f32 v131, v131
  v_mfma_f32_16x16x32_bf16 v[116:119], v[172:175], v[60:63], v[116:119]
  v_cvt_pk_bf16_f32 v137, v130, v131
  v_mfma_f32_16x16x32_bf16 a[96:99], v[176:179], v[140:143], a[96:99]
  v_exp_f32 v132, v132
  v_mfma_f32_16x16x32_bf16 a[100:103], v[180:183], v[140:143], a[100:103]
  s_lshl_b32 s73, s73, 13
  s_cmp_lt_u32 s97, 14
  s_cselect_b32 s73, s73, 0x40000000
  v_mfma_f32_16x16x32_bf16 a[104:107], v[184:187], v[140:143], a[104:107]
  v_exp_f32 v133, v133
  v_mfma_f32_16x16x32_bf16 a[108:111], v[188:191], v[140:143], a[108:111]
  v_cvt_pk_bf16_f32 v138, v132, v133
  v_mfma_f32_16x16x32_bf16 a[112:115], v[192:195], v[140:143], a[112:115]
  v_exp_f32 v134, v134
  v_mfma_f32_16x16x32_bf16 a[116:119], v[196:199], v[140:143], a[116:119]
  s_add_u32 s74, s66, 3
  s_and_b32 s74, s74, 15
  v_mfma_f32_16x16x32_bf16 a[120:123], v[200:203], v[140:143], a[120:123]
  v_exp_f32 v135, v135
  v_mfma_f32_16x16x32_bf16 a[124:127], v[204:207], v[140:143], a[124:127]
  v_cvt_pk_bf16_f32 v139, v134, v135
  v_mfma_f32_16x16x32_bf16 a[172:175], a[180:183], v[140:143], a[172:175]
  s_lshl_b32 s74, s74, 13
  s_cmp_lt_u32 s97, 13
  s_cselect_b32 s74, s74, 0x40000000
  s_add_u32 s68, s68, 2
  s_cmp_lt_u32 s68, 16
  s_cbranch_scc1 K1_ALOOP_A
  s_waitcnt vmcnt(0)
  s_barrier
  s_branch K1_POST
K1_B_PATH:
  s_waitcnt lgkmcnt(6)
  v_mfma_f32_16x16x32_bf16 v[16:19], v[176:179], v[208:211], v[16:19]
  s_mov_b32 s74, s96
  s_lshl_b32 s74, s74, 13
  v_mfma_f32_16x16x32_bf16 v[20:23], v[180:183], v[208:211], v[20:23]
  s_waitcnt lgkmcnt(3)
  v_mfma_f32_16x16x32_bf16 v[48:51], v[176:179], v[212:215], v[48:51]
  v_mfma_f32_16x16x32_bf16 v[52:55], v[180:183], v[212:215], v[52:55]
  s_waitcnt lgkmcnt(2)
  v_mfma_f32_16x16x32_bf16 v[80:83], v[176:179], v[216:219], v[80:83]
  v_mfma_f32_16x16x32_bf16 v[84:87], v[180:183], v[216:219], v[84:87]
  s_waitcnt lgkmcnt(1)
  v_mfma_f32_16x16x32_bf16 v[112:115], v[176:179], v[220:223], v[112:115]
  v_mfma_f32_16x16x32_bf16 v[116:119], v[180:183], v[220:223], v[116:119]
  s_waitcnt lgkmcnt(0)
  v_mfma_f32_16x16x32_bf16 v[144:147], v[176:179], v[224:227], v[144:147]
  ds_read_b64_tr_b16 v[200:201], v235 offset:0
  ds_read_b64_tr_b16 v[202:203], v235 offset:4096
  v_mfma_f32_16x16x32_bf16 v[148:151], v[180:183], v[224:227], v[148:151]
  ds_read_b64_tr_b16 v[204:205], v235 offset:8
  ds_read_b64_tr_b16 v[206:207], v235 offset:4104
  v_mfma_f32_16x16x32_bf16 v[24:27], v[184:187], v[208:211], v[24:27]
  v_mfma_f32_16x16x32_bf16 v[28:31], v[188:191], v[208:211], v[28:31]
  v_mfma_f32_16x16x32_bf16 v[56:59], v[184:187], v[212:215], v[56:59]
  v_mfma_f32_16x16x32_bf16 v[60:63], v[188:191], v[212:215], v[60:63]
  v_mfma_f32_16x16x32_bf16 v[88:91], v[184:187], v[216:219], v[88:91]
  s_waitcnt vmcnt(0) lgkmcnt(0)
  s_barrier
  v_mfma_f32_16x16x32_bf16 v[92:95], v[188:191], v[216:219], v[92:95]
  ds_read_b64_tr_b16 v[176:177], v236 offset:0
  ds_read_b64_tr_b16 v[178:179], v236 offset:4096
  v_mfma_f32_16x16x32_bf16 v[120:123], v[184:187], v[220:223], v[120:123]
  ds_read_b64_tr_b16 v[180:181], v236 offset:8
  ds_read_b64_tr_b16 v[182:183], v236 offset:4104
  v_mfma_f32_16x16x32_bf16 v[124:127], v[188:191], v[220:223], v[124:127]
  s_add_u32 m0, s62, 0
  s_nop 0
  v_mfma_f32_16x16x32_bf16 v[152:155], v[184:187], v[224:227], v[152:155]
  buffer_load_dwordx4 v246, s[32:35], s74 offen offset:0 nt lds
  v_mfma_f32_16x16x32_bf16 v[156:159], v[188:191], v[224:227], v[156:159]
  buffer_load_dwordx4 v247, s[32:35], s74 offen offset:1024 nt lds
  v_mfma_f32_16x16x32_bf16 v[32:35], v[192:195], v[208:211], v[32:35]
  ds_read_b64_tr_b16 v[184:185], v237 offset:0
  ds_read_b64_tr_b16 v[186:187], v237 offset:4096
  v_mfma_f32_16x16x32_bf16 v[36:39], v[196:199], v[208:211], v[36:39]
  ds_read_b64_tr_b16 v[188:189], v237 offset:8
  ds_read_b64_tr_b16 v[190:191], v237 offset:4104
  v_mfma_f32_16x16x32_bf16 v[64:67], v[192:195], v[212:215], v[64:67]
  buffer_load_dwordx4 v248, s[32:35], s74 offen offset:2048 nt lds
  buffer_load_dwordx4 v249, s[32:35], s74 offen offset:3072 nt lds
  v_mfma_f32_16x16x32_bf16 v[68:71], v[196:199], v[212:215], v[68:71]
  s_add_u32 m0, s62, 4096
  s_add_u32 s64, s74, 4096
  v_mfma_f32_16x16x32_bf16 v[96:99], v[192:195], v[216:219], v[96:99]
  buffer_load_dwordx4 v246, s[32:35], s64 offen offset:0 nt lds
  v_mfma_f32_16x16x32_bf16 v[100:103], v[196:199], v[216:219], v[100:103]
  buffer_load_dwordx4 v247, s[32:35], s64 offen offset:1024 nt lds
  v_mfma_f32_16x16x32_bf16 v[128:131], v[192:195], v[220:223], v[128:131]
  buffer_load_dwordx4 v248, s[32:35], s64 offen offset:2048 nt lds
  v_mfma_f32_16x16x32_bf16 v[132:135], v[196:199], v[220:223], v[132:135]
  buffer_load_dwordx4 v249, s[32:35], s64 offen offset:3072 nt lds
  v_mfma_f32_16x16x32_bf16 v[160:163], v[192:195], v[224:227], v[160:163]
  s_add_u32 m0, s62, 8192
  v_mfma_f32_16x16x32_bf16 v[164:167], v[196:199], v[224:227], v[164:167]
  s_nop 0
  v_mfma_f32_16x16x32_bf16 v[40:43], v[200:203], v[208:211], v[40:43]
  ds_read_b64_tr_b16 v[192:193], v238 offset:0
  ds_read_b64_tr_b16 v[194:195], v238 offset:4096
  v_mfma_f32_16x16x32_bf16 v[44:47], v[204:207], v[208:211], v[44:47]
  ds_read_b128 v[208:211], v245 offset:0
  buffer_load_dwordx4 v250, s[36:39], s74 offen offset:0 nt lds
  v_mfma_f32_16x16x32_bf16 v[72:75], v[200:203], v[212:215], v[72:75]
  ds_read_b64_tr_b16 v[196:197], v238 offset:8
  ds_read_b64_tr_b16 v[198:199], v238 offset:4104
  v_mfma_f32_16x16x32_bf16 v[76:79], v[204:207], v[212:215], v[76:79]
  ds_read_b128 v[212:215], v245 offset:2048
  buffer_load_dwordx4 v251, s[36:39], s74 offen offset:1024 nt lds
  v_mfma_f32_16x16x32_bf16 v[104:107], v[200:203], v[216:219], v[104:107]
  buffer_load_dwordx4 v250, s[36:39], s74 offen offset:2048 nt lds
  buffer_load_dwordx4 v251, s[36:39], s74 offen offset:3072 nt lds
  v_mfma_f32_16x16x32_bf16 v[108:111], v[204:207], v[216:219], v[108:111]
  ds_read_b128 v[216:219], v245 offset:4096
  s_add_u32 m0, s62, 12288
  v_mfma_f32_16x16x32_bf16 v[136:139], v[200:203], v[220:223], v[136:139]
  s_add_u32 s65, s74, 4096
  buffer_load_dwordx4 v250, s[36:39], s65 offen offset:0 nt lds
  v_mfma_f32_16x16x32_bf16 v[140:143], v[204:207], v[220:223], v[140:143]
  ds_read_b128 v[220:223], v245 offset:6144
  buffer_load_dwordx4 v251, s[36:39], s65 offen offset:1024 nt lds
  v_mfma_f32_16x16x32_bf16 v[168:171], v[200:203], v[224:227], v[168:171]
  buffer_load_dwordx4 v250, s[36:39], s65 offen offset:2048 nt lds
  v_mfma_f32_16x16x32_bf16 v[172:175], v[204:207], v[224:227], v[172:175]
  ds_read_b128 v[224:227], v245 offset:8192
  buffer_load_dwordx4 v251, s[36:39], s65 offen offset:3072 nt lds
  s_waitcnt lgkmcnt(6)
  v_mfma_f32_16x16x32_bf16 v[16:19], v[176:179], v[208:211], v[16:19]
  s_add_u32 s74, s96, 1
  s_and_b32 s74, s74, 15
  v_mfma_f32_16x16x32_bf16 v[20:23], v[180:183], v[208:211], v[20:23]
  s_waitcnt lgkmcnt(3)
  s_lshl_b32 s74, s74, 13
  v_mfma_f32_16x16x32_bf16 v[48:51], v[176:179], v[212:215], v[48:51]
  v_mfma_f32_16x16x32_bf16 v[52:55], v[180:183], v[212:215], v[52:55]
  s_waitcnt lgkmcnt(2)
  v_mfma_f32_16x16x32_bf16 v[80:83], v[176:179], v[216:219], v[80:83]
  v_mfma_f32_16x16x32_bf16 v[84:87], v[180:183], v[216:219], v[84:87]
  s_waitcnt lgkmcnt(1)
  v_mfma_f32_16x16x32_bf16 v[112:115], v[176:179], v[220:223], v[112:115]
  v_mfma_f32_16x16x32_bf16 v[116:119], v[180:183], v[220:223], v[116:119]
  s_waitcnt lgkmcnt(0)
  v_mfma_f32_16x16x32_bf16 v[144:147], v[176:179], v[224:227], v[144:147]
  ds_read_b64_tr_b16 v[200:201], v239 offset:0
  ds_read_b64_tr_b16 v[202:203], v239 offset:4096
  v_mfma_f32_16x16x32_bf16 v[148:151], v[180:183], v[224:227], v[148:151]
  ds_read_b64_tr_b16 v[204:205], v239 offset:8
  ds_read_b64_tr_b16 v[206:207], v239 offset:4104
  v_mfma_f32_16x16x32_bf16 v[24:27], v[184:187], v[208:211], v[24:27]
  v_mfma_f32_16x16x32_bf16 v[28:31], v[188:191], v[208:211], v[28:31]
  v_mfma_f32_16x16x32_bf16 v[56:59], v[184:187], v[212:215], v[56:59]
  v_mfma_f32_16x16x32_bf16 v[60:63], v[188:191], v[212:215], v[60:63]
  v_mfma_f32_16x16x32_bf16 v[88:91], v[184:187], v[216:219], v[88:91]
  s_waitcnt lgkmcnt(0)
  s_barrier
  v_mfma_f32_16x16x32_bf16 v[92:95], v[188:191], v[216:219], v[92:95]
  v_mfma_f32_16x16x32_bf16 v[120:123], v[184:187], v[220:223], v[120:123]
  v_mfma_f32_16x16x32_bf16 v[124:127], v[188:191], v[220:223], v[124:127]
  s_add_u32 m0, s62, 16384
  v_mfma_f32_16x16x32_bf16 v[152:155], v[184:187], v[224:227], v[152:155]
  s_nop 0
  v_mfma_f32_16x16x32_bf16 v[156:159], v[188:191], v[224:227], v[156:159]
  v_mfma_f32_16x16x32_bf16 v[32:35], v[192:195], v[208:211], v[32:35]
  buffer_load_dwordx4 v246, s[32:35], s74 offen offset:0 nt lds
  v_mfma_f32_16x16x32_bf16 v[36:39], v[196:199], v[208:211], v[36:39]
  v_mfma_f32_16x16x32_bf16 v[64:67], v[192:195], v[212:215], v[64:67]
  buffer_load_dwordx4 v247, s[32:35], s74 offen offset:1024 nt lds
  v_mfma_f32_16x16x32_bf16 v[68:71], v[196:199], v[212:215], v[68:71]
  v_mfma_f32_16x16x32_bf16 v[96:99], v[192:195], v[216:219], v[96:99]
  buffer_load_dwordx4 v248, s[32:35], s74 offen offset:2048 nt lds
  v_mfma_f32_16x16x32_bf16 v[100:103], v[196:199], v[216:219], v[100:103]
  v_mfma_f32_16x16x32_bf16 v[128:131], v[192:195], v[220:223], v[128:131]
  buffer_load_dwordx4 v249, s[32:35], s74 offen offset:3072 nt lds
  v_mfma_f32_16x16x32_bf16 v[132:135], v[196:199], v[220:223], v[132:135]
  v_mfma_f32_16x16x32_bf16 v[160:163], v[192:195], v[224:227], v[160:163]
  s_add_u32 m0, s62, 20480
  v_mfma_f32_16x16x32_bf16 v[164:167], v[196:199], v[224:227], v[164:167]
  v_mfma_f32_16x16x32_bf16 v[40:43], v[200:203], v[208:211], v[40:43]
  s_add_u32 s64, s74, 4096
  v_mfma_f32_16x16x32_bf16 v[44:47], v[204:207], v[208:211], v[44:47]
  v_mfma_f32_16x16x32_bf16 v[72:75], v[200:203], v[212:215], v[72:75]
  buffer_load_dwordx4 v246, s[32:35], s64 offen offset:0 nt lds
  v_mfma_f32_16x16x32_bf16 v[76:79], v[204:207], v[212:215], v[76:79]
  v_mfma_f32_16x16x32_bf16 v[104:107], v[200:203], v[216:219], v[104:107]
  buffer_load_dwordx4 v247, s[32:35], s64 offen offset:1024 nt lds
  v_mfma_f32_16x16x32_bf16 v[108:111], v[204:207], v[216:219], v[108:111]
  v_mfma_f32_16x16x32_bf16 v[136:139], v[200:203], v[220:223], v[136:139]
  buffer_load_dwordx4 v248, s[32:35], s64 offen offset:2048 nt lds
  v_mfma_f32_16x16x32_bf16 v[140:143], v[204:207], v[220:223], v[140:143]
  v_mfma_f32_16x16x32_bf16 v[168:171], v[200:203], v[224:227], v[168:171]
  buffer_load_dwordx4 v249, s[32:35], s64 offen offset:3072 nt lds
  v_mfma_f32_16x16x32_bf16 v[172:175], v[204:207], v[224:227], v[172:175]
  s_nop 7
  s_nop 1
  s_mov_b32 s66, 0x3e0293ee
  s_mov_b32 s67, s66
  v_pk_mul_f32 v[16:17], v[16:17], s[66:67]
  v_pk_mul_f32 v[18:19], v[18:19], s[66:67]
  v_pk_mul_f32 v[20:21], v[20:21], s[66:67]
  v_pk_mul_f32 v[22:23], v[22:23], s[66:67]
  v_cvt_pk_bf16_f32 v16, v16, v17
  v_cvt_pk_bf16_f32 v17, v18, v19
  v_cvt_pk_bf16_f32 v18, v20, v21
  v_cvt_pk_bf16_f32 v19, v22, v23
  v_pk_mul_f32 v[24:25], v[24:25], s[66:67]
  v_pk_mul_f32 v[26:27], v[26:27], s[66:67]
  v_pk_mul_f32 v[28:29], v[28:29], s[66:67]
  v_pk_mul_f32 v[30:31], v[30:31], s[66:67]
  v_cvt_pk_bf16_f32 v20, v24, v25
  v_cvt_pk_bf16_f32 v21, v26, v27
  v_cvt_pk_bf16_f32 v22, v28, v29
  v_cvt_pk_bf16_f32 v23, v30, v31
  v_pk_mul_f32 v[32:33], v[32:33], s[66:67]
  v_pk_mul_f32 v[34:35], v[34:35], s[66:67]
  v_pk_mul_f32 v[36:37], v[36:37], s[66:67]
  v_pk_mul_f32 v[38:39], v[38:39], s[66:67]
  v_cvt_pk_bf16_f32 v24, v32, v33
  v_cvt_pk_bf16_f32 v25, v34, v35
  v_cvt_pk_bf16_f32 v26, v36, v37
  v_cvt_pk_bf16_f32 v27, v38, v39
  v_pk_mul_f32 v[40:41], v[40:41], s[66:67]
  v_pk_mul_f32 v[42:43], v[42:43], s[66:67]
  v_pk_mul_f32 v[44:45], v[44:45], s[66:67]
  v_pk_mul_f32 v[46:47], v[46:47], s[66:67]
  v_cvt_pk_bf16_f32 v28, v40, v41
  v_cvt_pk_bf16_f32 v29, v42, v43
  v_cvt_pk_bf16_f32 v30, v44, v45
  v_cvt_pk_bf16_f32 v31, v46, v47
  v_pk_mul_f32 v[48:49], v[48:49], s[66:67]
  v_pk_mul_f32 v[50:51], v[50:51], s[66:67]
  v_pk_mul_f32 v[52:53], v[52:53], s[66:67]
  v_pk_mul_f32 v[54:55], v[54:55], s[66:67]
  v_cvt_pk_bf16_f32 v32, v48, v49
  v_cvt_pk_bf16_f32 v33, v50, v51
  v_cvt_pk_bf16_f32 v34, v52, v53
  v_cvt_pk_bf16_f32 v35, v54, v55
  v_pk_mul_f32 v[56:57], v[56:57], s[66:67]
  v_pk_mul_f32 v[58:59], v[58:59], s[66:67]
  v_pk_mul_f32 v[60:61], v[60:61], s[66:67]
  v_pk_mul_f32 v[62:63], v[62:63], s[66:67]
  v_cvt_pk_bf16_f32 v36, v56, v57
  v_cvt_pk_bf16_f32 v37, v58, v59
  v_cvt_pk_bf16_f32 v38, v60, v61
  v_cvt_pk_bf16_f32 v39, v62, v63
  v_pk_mul_f32 v[64:65], v[64:65], s[66:67]
  v_pk_mul_f32 v[66:67], v[66:67], s[66:67]
  v_pk_mul_f32 v[68:69], v[68:69], s[66:67]
  v_pk_mul_f32 v[70:71], v[70:71], s[66:67]
  v_cvt_pk_bf16_f32 v40, v64, v65
  v_cvt_pk_bf16_f32 v41, v66, v67
  v_cvt_pk_bf16_f32 v42, v68, v69
  v_cvt_pk_bf16_f32 v43, v70, v71
  v_pk_mul_f32 v[72:73], v[72:73], s[66:67]
  v_pk_mul_f32 v[74:75], v[74:75], s[66:67]
  v_pk_mul_f32 v[76:77], v[76:77], s[66:67]
  v_pk_mul_f32 v[78:79], v[78:79], s[66:67]
  v_cvt_pk_bf16_f32 v44, v72, v73
  v_cvt_pk_bf16_f32 v45, v74, v75
  v_cvt_pk_bf16_f32 v46, v76, v77
  v_cvt_pk_bf16_f32 v47, v78, v79
  v_pk_mul_f32 v[80:81], v[80:81], s[66:67]
  v_pk_mul_f32 v[82:83], v[82:83], s[66:67]
  v_pk_mul_f32 v[84:85], v[84:85], s[66:67]
  v_pk_mul_f32 v[86:87], v[86:87], s[66:67]
  v_cvt_pk_bf16_f32 v48, v80, v81
  v_cvt_pk_bf16_f32 v49, v82, v83
  v_cvt_pk_bf16_f32 v50, v84, v85
  v_cvt_pk_bf16_f32 v51, v86, v87
  v_pk_mul_f32 v[88:89], v[88:89], s[66:67]
  v_pk_mul_f32 v[90:91], v[90:91], s[66:67]
  v_pk_mul_f32 v[92:93], v[92:93], s[66:67]
  v_pk_mul_f32 v[94:95], v[94:95], s[66:67]
  v_cvt_pk_bf16_f32 v52, v88, v89
  v_cvt_pk_bf16_f32 v53, v90, v91
  v_cvt_pk_bf16_f32 v54, v92, v93
  v_cvt_pk_bf16_f32 v55, v94, v95
  v_pk_mul_f32 v[96:97], v[96:97], s[66:67]
  v_pk_mul_f32 v[98:99], v[98:99], s[66:67]
  v_pk_mul_f32 v[100:101], v[100:101], s[66:67]
  v_pk_mul_f32 v[102:103], v[102:103], s[66:67]
  v_cvt_pk_bf16_f32 v56, v96, v97
  v_cvt_pk_bf16_f32 v57, v98, v99
  v_cvt_pk_bf16_f32 v58, v100, v101
  v_cvt_pk_bf16_f32 v59, v102, v103
  v_pk_mul_f32 v[104:105], v[104:105], s[66:67]
  v_pk_mul_f32 v[106:107], v[106:107], s[66:67]
  v_pk_mul_f32 v[108:109], v[108:109], s[66:67]
  v_pk_mul_f32 v[110:111], v[110:111], s[66:67]
  v_cvt_pk_bf16_f32 v60, v104, v105
  v_cvt_pk_bf16_f32 v61, v106, v107
  v_cvt_pk_bf16_f32 v62, v108, v109
  v_cvt_pk_bf16_f32 v63, v110, v111
  v_pk_mul_f32 v[112:113], v[112:113], s[66:67]
  v_pk_mul_f32 v[114:115], v[114:115], s[66:67]
  v_pk_mul_f32 v[116:117], v[116:117], s[66:67]
  v_pk_mul_f32 v[118:119], v[118:119], s[66:67]
  v_cvt_pk_bf16_f32 v64, v112, v113
  v_cvt_pk_bf16_f32 v65, v114, v115
  v_cvt_pk_bf16_f32 v66, v116, v117
  v_cvt_pk_bf16_f32 v67, v118, v119
  v_pk_mul_f32 v[120:121], v[120:121], s[66:67]
  v_pk_mul_f32 v[122:123], v[122:123], s[66:67]
  v_pk_mul_f32 v[124:125], v[124:125], s[66:67]
  v_pk_mul_f32 v[126:127], v[126:127], s[66:67]
  v_cvt_pk_bf16_f32 v68, v120, v121
  v_cvt_pk_bf16_f32 v69, v122, v123
  v_cvt_pk_bf16_f32 v70, v124, v125
  v_cvt_pk_bf16_f32 v71, v126, v127
  v_pk_mul_f32 v[128:129], v[128:129], s[66:67]
  v_pk_mul_f32 v[130:131], v[130:131], s[66:67]
  v_pk_mul_f32 v[132:133], v[132:133], s[66:67]
  v_pk_mul_f32 v[134:135], v[134:135], s[66:67]
  v_cvt_pk_bf16_f32 v72, v128, v129
  v_cvt_pk_bf16_f32 v73, v130, v131
  v_cvt_pk_bf16_f32 v74, v132, v133
  v_cvt_pk_bf16_f32 v75, v134, v135
  v_pk_mul_f32 v[136:137], v[136:137], s[66:67]
  v_pk_mul_f32 v[138:139], v[138:139], s[66:67]
  v_pk_mul_f32 v[140:141], v[140:141], s[66:67]
  v_pk_mul_f32 v[142:143], v[142:143], s[66:67]
  v_cvt_pk_bf16_f32 v76, v136, v137
  v_cvt_pk_bf16_f32 v77, v138, v139
  v_cvt_pk_bf16_f32 v78, v140, v141
  v_cvt_pk_bf16_f32 v79, v142, v143
  v_pk_mul_f32 v[144:145], v[144:145], s[66:67]
  v_pk_mul_f32 v[146:147], v[146:147], s[66:67]
  v_pk_mul_f32 v[148:149], v[148:149], s[66:67]
  v_pk_mul_f32 v[150:151], v[150:151], s[66:67]
  v_cvt_pk_bf16_f32 v80, v144, v145
  v_cvt_pk_bf16_f32 v81, v146, v147
  v_cvt_pk_bf16_f32 v82, v148, v149
  v_cvt_pk_bf16_f32 v83, v150, v151
  v_pk_mul_f32 v[152:153], v[152:153], s[66:67]
  v_pk_mul_f32 v[154:155], v[154:155], s[66:67]
  v_pk_mul_f32 v[156:157], v[156:157], s[66:67]
  v_pk_mul_f32 v[158:159], v[158:159], s[66:67]
  v_cvt_pk_bf16_f32 v84, v152, v153
  v_cvt_pk_bf16_f32 v85, v154, v155
  v_cvt_pk_bf16_f32 v86, v156, v157
  v_cvt_pk_bf16_f32 v87, v158, v159
  v_pk_mul_f32 v[160:161], v[160:161], s[66:67]
  v_pk_mul_f32 v[162:163], v[162:163], s[66:67]
  v_pk_mul_f32 v[164:165], v[164:165], s[66:67]
  v_pk_mul_f32 v[166:167], v[166:167], s[66:67]
  v_cvt_pk_bf16_f32 v88, v160, v161
  v_cvt_pk_bf16_f32 v89, v162, v163
  v_cvt_pk_bf16_f32 v90, v164, v165
  v_cvt_pk_bf16_f32 v91, v166, v167
  v_pk_mul_f32 v[168:169], v[168:169], s[66:67]
  v_pk_mul_f32 v[170:171], v[170:171], s[66:67]
  v_pk_mul_f32 v[172:173], v[172:173], s[66:67]
  v_pk_mul_f32 v[174:175], v[174:175], s[66:67]
  v_cvt_pk_bf16_f32 v92, v168, v169
  v_cvt_pk_bf16_f32 v93, v170, v171
  v_cvt_pk_bf16_f32 v94, v172, v173
  v_cvt_pk_bf16_f32 v95, v174, v175
  v_add_u32 v13, 0, v9
  v_xor_b32 v13, v13, v10
  v_lshlrev_b32 v13, 4, v13
  v_lshl_add_u32 v13, v10, 8, v13
  v_add_u32 v228, s62, v13
  v_add_u32 v13, 4, v9
  v_xor_b32 v13, v13, v10
  v_lshlrev_b32 v13, 4, v13
  v_lshl_add_u32 v13, v10, 8, v13
  v_add_u32 v229, s62, v13
  v_add_u32 v13, 8, v9
  v_xor_b32 v13, v13, v10
  v_lshlrev_b32 v13, 4, v13
  v_lshl_add_u32 v13, v10, 8, v13
  v_add_u32 v230, s62, v13
  v_add_u32 v13, 12, v9
  v_xor_b32 v13, v13, v10
  v_lshlrev_b32 v13, 4, v13
  v_lshl_add_u32 v13, v10, 8, v13
  v_add_u32 v231, s62, v13
  v_lshl_add_u32 v14, v9, 2, v11
  v_and_b32 v15, 7, v14
  v_lshlrev_b32 v14, 8, v14
  v_lshl_add_u32 v14, v12, 3, v14
  v_add_u32 v14, s62, v14
  v_xor_b32 v13, 0, v15
  v_lshl_add_u32 v232, v13, 5, v14
  v_xor_b32 v13, 1, v15
  v_lshl_add_u32 v233, v13, 5, v14
  v_xor_b32 v13, 2, v15
  v_lshl_add_u32 v234, v13, 5, v14
  v_xor_b32 v13, 3, v15
  v_lshl_add_u32 v235, v13, 5, v14
  v_xor_b32 v13, 4, v15
  v_lshl_add_u32 v236, v13, 5, v14
  v_xor_b32 v13, 5, v15
  v_lshl_add_u32 v237, v13, 5, v14
  v_xor_b32 v13, 6, v15
  v_lshl_add_u32 v238, v13, 5, v14
  v_xor_b32 v13, 7, v15
  v_lshl_add_u32 v239, v13, 5, v14
  s_mov_b32 s73, s74
  s_add_u32 m0, s62, 24576
  s_nop 0
  buffer_load_dwordx4 v250, s[36:39], s73 offen offset:0 nt lds
  buffer_load_dwordx4 v251, s[36:39], s73 offen offset:1024 nt lds
  buffer_load_dwordx4 v250, s[36:39], s73 offen offset:2048 nt lds
  buffer_load_dwordx4 v251, s[36:39], s73 offen offset:3072 nt lds
  s_add_u32 m0, s62, 28672
  s_add_u32 s65, s73, 4096
  buffer_load_dwordx4 v250, s[36:39], s65 offen offset:0 nt lds
  buffer_load_dwordx4 v251, s[36:39], s65 offen offset:1024 nt lds
  buffer_load_dwordx4 v250, s[36:39], s65 offen offset:2048 nt lds
  buffer_load_dwordx4 v251, s[36:39], s65 offen offset:3072 nt lds
  s_waitcnt vmcnt(24)
  ds_read_b128 v[144:147], v228 offset:0
  ds_read_b128 v[148:151], v229 offset:0
  ds_read_b128 v[152:155], v230 offset:0
  ds_read_b128 v[156:159], v231 offset:0
  ds_read_b128 v[160:163], v228 offset:4096
  ds_read_b128 v[164:167], v229 offset:4096
  ds_read_b128 v[168:171], v230 offset:4096
  ds_read_b128 v[172:175], v231 offset:4096
K1_ATT_COMMON_B:
  s_waitcnt lgkmcnt(0)
  s_add_u32 s74, s96, 2
  s_and_b32 s74, s74, 15
  s_lshl_b32 s74, s74, 13
  s_add_u32 m0, s62, 0
  s_nop 0
  buffer_load_dwordx4 v246, s[32:35], s74 offen offset:0 nt lds
  buffer_load_dwordx4 v247, s[32:35], s74 offen offset:1024 nt lds
  buffer_load_dwordx4 v248, s[32:35], s74 offen offset:2048 nt lds
  buffer_load_dwordx4 v249, s[32:35], s74 offen offset:3072 nt lds
  s_add_u32 m0, s62, 4096
  s_add_u32 s64, s74, 4096
  buffer_load_dwordx4 v246, s[32:35], s64 offen offset:0 nt lds
  buffer_load_dwordx4 v247, s[32:35], s64 offen offset:1024 nt lds
  buffer_load_dwordx4 v248, s[32:35], s64 offen offset:2048 nt lds
  buffer_load_dwordx4 v249, s[32:35], s64 offen offset:3072 nt lds
  s_add_u32 s73, s96, 2
  s_and_b32 s73, s73, 15
  s_lshl_b32 s73, s73, 13
  s_add_u32 s74, s96, 3
  s_and_b32 s74, s74, 15
  s_lshl_b32 s74, s74, 13
  s_mov_b32 s97, 0
  v_mfma_f32_16x16x32_bf16 v[96:99], v[144:147], v[16:19], 0
  v_mfma_f32_16x16x32_bf16 v[96:99], v[148:151], v[20:23], v[96:99]
  v_mfma_f32_16x16x32_bf16 v[96:99], v[152:155], v[24:27], v[96:99]
  v_mfma_f32_16x16x32_bf16 v[96:99], v[156:159], v[28:31], v[96:99]
  v_mfma_f32_16x16x32_bf16 v[100:103], v[160:163], v[16:19], 0
  v_mfma_f32_16x16x32_bf16 v[100:103], v[164:167], v[20:23], v[100:103]
  v_mfma_f32_16x16x32_bf16 v[100:103], v[168:171], v[24:27], v[100:103]
  v_mfma_f32_16x16x32_bf16 v[100:103], v[172:175], v[28:31], v[100:103]
  v_mfma_f32_16x16x32_bf16 v[104:107], v[144:147], v[32:35], 0
  v_mfma_f32_16x16x32_bf16 v[104:107], v[148:151], v[36:39], v[104:107]
  v_mfma_f32_16x16x32_bf16 v[104:107], v[152:155], v[40:43], v[104:107]
  v_mfma_f32_16x16x32_bf16 v[104:107], v[156:159], v[44:47], v[104:107]
  v_mfma_f32_16x16x32_bf16 v[108:111], v[160:163], v[32:35], 0
  v_mfma_f32_16x16x32_bf16 v[108:111], v[164:167], v[36:39], v[108:111]
  v_mfma_f32_16x16x32_bf16 v[108:111], v[168:171], v[40:43], v[108:111]
  v_mfma_f32_16x16x32_bf16 v[108:111], v[172:175], v[44:47], v[108:111]
  v_mfma_f32_16x16x32_bf16 v[112:115], v[144:147], v[48:51], 0
  v_mfma_f32_16x16x32_bf16 v[112:115], v[148:151], v[52:55], v[112:115]
  v_mfma_f32_16x16x32_bf16 v[112:115], v[152:155], v[56:59], v[112:115]
  v_mfma_f32_16x16x32_bf16 v[112:115], v[156:159], v[60:63], v[112:115]
  v_mfma_f32_16x16x32_bf16 v[116:119], v[160:163], v[48:51], 0
  v_mfma_f32_16x16x32_bf16 v[116:119], v[164:167], v[52:55], v[116:119]
  v_mfma_f32_16x16x32_bf16 v[116:119], v[168:171], v[56:59], v[116:119]
  v_mfma_f32_16x16x32_bf16 v[116:119], v[172:175], v[60:63], v[116:119]
  v_mfma_f32_16x16x32_bf16 v[120:123], v[144:147], v[64:67], 0
  v_mfma_f32_16x16x32_bf16 v[120:123], v[148:151], v[68:71], v[120:123]
  v_mfma_f32_16x16x32_bf16 v[120:123], v[152:155], v[72:75], v[120:123]
  v_mfma_f32_16x16x32_bf16 v[120:123], v[156:159], v[76:79], v[120:123]
  v_mfma_f32_16x16x32_bf16 v[124:127], v[160:163], v[64:67], 0
  v_mfma_f32_16x16x32_bf16 v[124:127], v[164:167], v[68:71], v[124:127]
  v_mfma_f32_16x16x32_bf16 v[124:127], v[168:171], v[72:75], v[124:127]
  v_mfma_f32_16x16x32_bf16 v[124:127], v[172:175], v[76:79], v[124:127]
  v_mfma_f32_16x16x32_bf16 v[128:131], v[144:147], v[80:83], 0
  v_mfma_f32_16x16x32_bf16 v[128:131], v[148:151], v[84:87], v[128:131]
  v_mfma_f32_16x16x32_bf16 v[128:131], v[152:155], v[88:91], v[128:131]
  v_mfma_f32_16x16x32_bf16 v[128:131], v[156:159], v[92:95], v[128:131]
  v_mfma_f32_16x16x32_bf16 v[132:135], v[160:163], v[80:83], 0
  v_mfma_f32_16x16x32_bf16 v[132:135], v[164:167], v[84:87], v[132:135]
  v_mfma_f32_16x16x32_bf16 v[132:135], v[168:171], v[88:91], v[132:135]
  v_mfma_f32_16x16x32_bf16 v[132:135], v[172:175], v[92:95], v[132:135]
  s_nop 7
  s_nop 1
  v_max3_f32 v13, v96, v97, v98
  v_max3_f32 v13, v13, v99, v100
  v_max3_f32 v13, v13, v101, v102
  v_max_f32 v13, v13, v103
  v_mov_b32 v14, v13
  s_nop 1
  v_permlane32_swap_b32 v13, v14
  s_nop 1
  v_max_f32 v13, v13, v14
  v_mov_b32 v14, v13
  s_nop 1
  v_permlane16_swap_b32 v13, v14
  s_nop 1
  v_max_f32 v13, v13, v14
  v_sub_f32 v208, 0, v13
  v_sub_f32 v209, 0, v13
  v_sub_f32 v210, 0, v13
  v_sub_f32 v211, 0, v13
  v_max3_f32 v13, v104, v105, v106
  v_max3_f32 v13, v13, v107, v108
  v_max3_f32 v13, v13, v109, v110
  v_max_f32 v13, v13, v111
  v_mov_b32 v14, v13
  s_nop 1
  v_permlane32_swap_b32 v13, v14
  s_nop 1
  v_max_f32 v13, v13, v14
  v_mov_b32 v14, v13
  s_nop 1
  v_permlane16_swap_b32 v13, v14
  s_nop 1
  v_max_f32 v13, v13, v14
  v_sub_f32 v212, 0, v13
  v_sub_f32 v213, 0, v13
  v_sub_f32 v214, 0, v13
  v_sub_f32 v215, 0, v13
  v_max3_f32 v13, v112, v113, v114
  v_max3_f32 v13, v13, v115, v116
  v_max3_f32 v13, v13, v117, v118
  v_max_f32 v13, v13, v119
  v_mov_b32 v14, v13
  s_nop 1
  v_permlane32_swap_b32 v13, v14
  s_nop 1
  v_max_f32 v13, v13, v14
  v_mov_b32 v14, v13
  s_nop 1
  v_permlane16_swap_b32 v13, v14
  s_nop 1
  v_max_f32 v13, v13, v14
  v_sub_f32 v216, 0, v13
  v_sub_f32 v217, 0, v13
  v_sub_f32 v218, 0, v13
  v_sub_f32 v219, 0, v13
  v_max3_f32 v13, v120, v121, v122
  v_max3_f32 v13, v13, v123, v124
  v_max3_f32 v13, v13, v125, v126
  v_max_f32 v13, v13, v127
  v_mov_b32 v14, v13
  s_nop 1
  v_permlane32_swap_b32 v13, v14
  s_nop 1
  v_max_f32 v13, v13, v14
  v_mov_b32 v14, v13
  s_nop 1
  v_permlane16_swap_b32 v13, v14
  s_nop 1
  v_max_f32 v13, v13, v14
  v_sub_f32 v220, 0, v13
  v_sub_f32 v221, 0, v13
  v_sub_f32 v222, 0, v13
  v_sub_f32 v223, 0, v13
  v_max3_f32 v13, v128, v129, v130
  v_max3_f32 v13, v13, v131, v132
  v_max3_f32 v13, v13, v133, v134
  v_max_f32 v13, v13, v135
  v_mov_b32 v14, v13
  s_nop 1
  v_permlane32_swap_b32 v13, v14
  s_nop 1
  v_max_f32 v13, v13, v14
  v_mov_b32 v14, v13
  s_nop 1
  v_permlane16_swap_b32 v13, v14
  s_nop 1
  v_max_f32 v13, v13, v14
  v_sub_f32 v224, 0, v13
  v_sub_f32 v225, 0, v13
  v_sub_f32 v226, 0, v13
  v_sub_f32 v227, 0, v13
  v_add_f32 v96, v96, v208
  v_add_f32 v97, v97, v208
  v_add_f32 v98, v98, v208
  v_add_f32 v99, v99, v208
  v_add_f32 v100, v100, v208
  v_add_f32 v101, v101, v208
  v_add_f32 v102, v102, v208
  v_add_f32 v103, v103, v208
  v_add_f32 v104, v104, v212
  v_add_f32 v105, v105, v212
  v_add_f32 v106, v106, v212
  v_add_f32 v107, v107, v212
  v_add_f32 v108, v108, v212
  v_add_f32 v109, v109, v212
  v_add_f32 v110, v110, v212
  v_add_f32 v111, v111, v212
  v_add_f32 v112, v112, v216
  v_add_f32 v113, v113, v216
  v_add_f32 v114, v114, v216
  v_add_f32 v115, v115, v216
  v_add_f32 v116, v116, v216
  v_add_f32 v117, v117, v216
  v_add_f32 v118, v118, v216
  v_add_f32 v119, v119, v216
  v_mov_b32 v136, 0
  v_mov_b32 v137, 0
  v_mov_b32 v138, 0
  v_mov_b32 v139, 0
  v_mov_b32 v176, 0
  v_mov_b32 v177, 0
  v_mov_b32 v178, 0
  v_mov_b32 v179, 0
  v_mov_b32 v180, 0
  v_mov_b32 v181, 0
  v_mov_b32 v182, 0
  v_mov_b32 v183, 0
  v_mov_b32 v184, 0
  v_mov_b32 v185, 0
  v_mov_b32 v186, 0
  v_mov_b32 v187, 0
  v_mov_b32 v188, 0
  v_mov_b32 v189, 0
  v_mov_b32 v190, 0
  v_mov_b32 v191, 0
  v_mov_b32 v192, 0
  v_mov_b32 v193, 0
  v_mov_b32 v194, 0
  v_mov_b32 v195, 0
  v_mov_b32 v196, 0
  v_mov_b32 v197, 0
  v_mov_b32 v198, 0
  v_mov_b32 v199, 0
  v_mov_b32 v200, 0
  v_mov_b32 v201, 0
  v_mov_b32 v202, 0
  v_mov_b32 v203, 0
  v_mov_b32 v204, 0
  v_mov_b32 v205, 0
  v_mov_b32 v206, 0
  v_mov_b32 v207, 0
  s_mov_b32 s68, 0
K1_ALOOP_B:
  s_waitcnt vmcnt(24)
  v_mfma_f32_16x16x32_bf16 a[128:131], v[176:179], v[136:139], a[128:131]
  ds_read_b64_tr_b16 v[176:177], v232 offset:8192
  ds_read_b64_tr_b16 v[178:179], v232 offset:12288
  v_mfma_f32_16x16x32_bf16 a[132:135], v[180:183], v[136:139], a[132:135]
  ds_read_b64_tr_b16 v[180:181], v233 offset:8192
  ds_read_b64_tr_b16 v[182:183], v233 offset:12288
  v_mfma_f32_16x16x32_bf16 a[136:139], v[184:187], v[136:139], a[136:139]
  ds_read_b64_tr_b16 v[184:185], v234 offset:8192
  ds_read_b64_tr_b16 v[186:187], v234 offset:12288
  v_mfma_f32_16x16x32_bf16 a[140:143], v[188:191], v[136:139], a[140:143]
  ds_read_b64_tr_b16 v[188:189], v235 offset:8192
  ds_read_b64_tr_b16 v[190:191], v235 offset:12288
  v_mfma_f32_16x16x32_bf16 a[144:147], v[192:195], v[136:139], a[144:147]
  ds_read_b64_tr_b16 v[192:193], v236 offset:8192
  ds_read_b64_tr_b16 v[194:195], v236 offset:12288
  v_mfma_f32_16x16x32_bf16 a[148:151], v[196:199], v[136:139], a[148:151]
  ds_read_b64_tr_b16 v[196:197], v237 offset:8192
  ds_read_b64_tr_b16 v[198:199], v237 offset:12288
  v_mfma_f32_16x16x32_bf16 a[152:155], v[200:203], v[136:139], a[152:155]
  ds_read_b64_tr_b16 v[200:201], v238 offset:8192
  ds_read_b64_tr_b16 v[202:203], v238 offset:12288
  v_mfma_f32_16x16x32_bf16 a[156:159], v[204:207], v[136:139], a[156:159]
  ds_read_b64_tr_b16 v[204:205], v239 offset:8192
  ds_read_b64_tr_b16 v[206:207], v239 offset:12288
  v_mfma_f32_16x16x32_bf16 a[176:179], a[180:183], v[136:139], a[176:179]
  v_exp_f32 v96, v96
  v_mfma_f32_16x16x32_bf16 v[120:123], v[144:147], v[64:67], v[220:223]
  v_exp_f32 v97, v97
  v_mfma_f32_16x16x32_bf16 v[120:123], v[148:151], v[68:71], v[120:123]
  v_exp_f32 v98, v98
  v_mfma_f32_16x16x32_bf16 v[120:123], v[152:155], v[72:75], v[120:123]
  v_exp_f32 v99, v99
  v_cvt_pk_bf16_f32 v136, v96, v97
  v_mfma_f32_16x16x32_bf16 v[120:123], v[156:159], v[76:79], v[120:123]
  v_exp_f32 v100, v100
  v_mfma_f32_16x16x32_bf16 v[124:127], v[160:163], v[64:67], v[220:223]
  v_exp_f32 v101, v101
  v_cvt_pk_bf16_f32 v137, v98, v99
  v_mfma_f32_16x16x32_bf16 v[124:127], v[164:167], v[68:71], v[124:127]
  v_exp_f32 v102, v102
  v_mfma_f32_16x16x32_bf16 v[124:127], v[168:171], v[72:75], v[124:127]
  v_exp_f32 v103, v103
  v_cvt_pk_bf16_f32 v138, v100, v101
  v_mfma_f32_16x16x32_bf16 v[124:127], v[172:175], v[76:79], v[124:127]
  s_nop 0
  v_cvt_pk_bf16_f32 v139, v102, v103
  s_waitcnt vmcnt(16)
  v_mfma_f32_16x16x32_bf16 v[128:131], v[144:147], v[80:83], v[224:227]
  ds_read_b128 v[144:147], v228 offset:16384
  v_exp_f32 v104, v104
  v_mfma_f32_16x16x32_bf16 v[128:131], v[148:151], v[84:87], v[128:131]
  ds_read_b128 v[148:151], v229 offset:16384
  v_mfma_f32_16x16x32_bf16 v[128:131], v[152:155], v[88:91], v[128:131]
  ds_read_b128 v[152:155], v230 offset:16384
  v_exp_f32 v105, v105
  v_mfma_f32_16x16x32_bf16 v[128:131], v[156:159], v[92:95], v[128:131]
  ds_read_b128 v[156:159], v231 offset:16384
  v_mfma_f32_16x16x32_bf16 v[132:135], v[160:163], v[80:83], v[224:227]
  ds_read_b128 v[160:163], v228 offset:20480
  v_exp_f32 v106, v106
  v_mfma_f32_16x16x32_bf16 v[132:135], v[164:167], v[84:87], v[132:135]
  ds_read_b128 v[164:167], v229 offset:20480
  v_cvt_pk_bf16_f32 v140, v104, v105
  v_mfma_f32_16x16x32_bf16 v[132:135], v[168:171], v[88:91], v[132:135]
  ds_read_b128 v[168:171], v230 offset:20480
  v_exp_f32 v107, v107
  v_mfma_f32_16x16x32_bf16 v[132:135], v[172:175], v[92:95], v[132:135]
  ds_read_b128 v[172:175], v231 offset:20480
  s_waitcnt lgkmcnt(8)
  v_mfma_f32_16x16x32_bf16 a[0:3], v[176:179], v[136:139], a[0:3]
  v_exp_f32 v108, v108
  v_mfma_f32_16x16x32_bf16 a[4:7], v[180:183], v[136:139], a[4:7]
  v_cvt_pk_bf16_f32 v141, v106, v107
  v_mfma_f32_16x16x32_bf16 a[8:11], v[184:187], v[136:139], a[8:11]
  v_exp_f32 v109, v109
  v_mfma_f32_16x16x32_bf16 a[12:15], v[188:191], v[136:139], a[12:15]
  s_add_u32 m0, s62, 8192
  s_nop 0
  buffer_load_dwordx4 v250, s[36:39], s73 offen offset:0 nt lds
  v_mfma_f32_16x16x32_bf16 a[16:19], v[192:195], v[136:139], a[16:19]
  v_exp_f32 v110, v110
  v_mfma_f32_16x16x32_bf16 a[20:23], v[196:199], v[136:139], a[20:23]
  v_cvt_pk_bf16_f32 v142, v108, v109
  buffer_load_dwordx4 v251, s[36:39], s73 offen offset:1024 nt lds
  v_mfma_f32_16x16x32_bf16 a[24:27], v[200:203], v[136:139], a[24:27]
  v_exp_f32 v111, v111
  v_mfma_f32_16x16x32_bf16 a[28:31], v[204:207], v[136:139], a[28:31]
  buffer_load_dwordx4 v250, s[36:39], s73 offen offset:2048 nt lds
  v_mfma_f32_16x16x32_bf16 a[160:163], a[180:183], v[136:139], a[160:163]
  v_cvt_pk_bf16_f32 v143, v110, v111
  s_waitcnt lgkmcnt(0)
  v_mfma_f32_16x16x32_bf16 v[96:99], v[144:147], v[16:19], v[208:211]
  v_exp_f32 v112, v112
  v_mfma_f32_16x16x32_bf16 v[96:99], v[148:151], v[20:23], v[96:99]
  buffer_load_dwordx4 v251, s[36:39], s73 offen offset:3072 nt lds
  v_mfma_f32_16x16x32_bf16 v[96:99], v[152:155], v[24:27], v[96:99]
  v_exp_f32 v113, v113
  v_mfma_f32_16x16x32_bf16 v[96:99], v[156:159], v[28:31], v[96:99]
  v_cvt_pk_bf16_f32 v136, v112, v113
  v_mfma_f32_16x16x32_bf16 v[100:103], v[160:163], v[16:19], v[208:211]
  v_exp_f32 v114, v114
  v_mfma_f32_16x16x32_bf16 v[100:103], v[164:167], v[20:23], v[100:103]
  s_add_u32 m0, s62, 12288
  s_add_u32 s65, s73, 4096
  buffer_load_dwordx4 v250, s[36:39], s65 offen offset:0 nt lds
  v_mfma_f32_16x16x32_bf16 v[100:103], v[168:171], v[24:27], v[100:103]
  v_exp_f32 v115, v115
  v_mfma_f32_16x16x32_bf16 v[100:103], v[172:175], v[28:31], v[100:103]
  v_cvt_pk_bf16_f32 v137, v114, v115
  v_mfma_f32_16x16x32_bf16 a[32:35], v[176:179], v[140:143], a[32:35]
  v_exp_f32 v116, v116
  v_mfma_f32_16x16x32_bf16 a[36:39], v[180:183], v[140:143], a[36:39]
  buffer_load_dwordx4 v251, s[36:39], s65 offen offset:1024 nt lds
  v_mfma_f32_16x16x32_bf16 a[40:43], v[184:187], v[140:143], a[40:43]
  v_exp_f32 v117, v117
  v_mfma_f32_16x16x32_bf16 a[44:47], v[188:191], v[140:143], a[44:47]
  v_cvt_pk_bf16_f32 v138, v116, v117
  v_mfma_f32_16x16x32_bf16 a[48:51], v[192:195], v[140:143], a[48:51]
  v_exp_f32 v118, v118
  v_mfma_f32_16x16x32_bf16 a[52:55], v[196:199], v[140:143], a[52:55]
  buffer_load_dwordx4 v250, s[36:39], s65 offen offset:2048 nt lds
  v_mfma_f32_16x16x32_bf16 a[56:59], v[200:203], v[140:143], a[56:59]
  v_exp_f32 v119, v119
  v_mfma_f32_16x16x32_bf16 a[60:63], v[204:207], v[140:143], a[60:63]
  v_cvt_pk_bf16_f32 v139, v118, v119
  v_mfma_f32_16x16x32_bf16 a[164:167], a[180:183], v[140:143], a[164:167]
  buffer_load_dwordx4 v251, s[36:39], s65 offen offset:3072 nt lds
  v_mfma_f32_16x16x32_bf16 v[104:107], v[144:147], v[32:35], v[212:215]
  v_exp_f32 v120, v120
  v_mfma_f32_16x16x32_bf16 v[104:107], v[148:151], v[36:39], v[104:107]
  s_add_u32 m0, s62, 16384
  s_nop 0
  buffer_load_dwordx4 v246, s[32:35], s74 offen offset:0 nt lds
  v_mfma_f32_16x16x32_bf16 v[104:107], v[152:155], v[40:43], v[104:107]
  v_exp_f32 v121, v121
  v_mfma_f32_16x16x32_bf16 v[104:107], v[156:159], v[44:47], v[104:107]
  v_cvt_pk_bf16_f32 v140, v120, v121
  v_mfma_f32_16x16x32_bf16 v[108:111], v[160:163], v[32:35], v[212:215]
  v_exp_f32 v122, v122
  v_mfma_f32_16x16x32_bf16 v[108:111], v[164:167], v[36:39], v[108:111]
  buffer_load_dwordx4 v247, s[32:35], s74 offen offset:1024 nt lds
  v_mfma_f32_16x16x32_bf16 v[108:111], v[168:171], v[40:43], v[108:111]
  v_exp_f32 v123, v123
  v_mfma_f32_16x16x32_bf16 v[108:111], v[172:175], v[44:47], v[108:111]
  v_cvt_pk_bf16_f32 v141, v122, v123
  v_mfma_f32_16x16x32_bf16 a[64:67], v[176:179], v[136:139], a[64:67]
  v_exp_f32 v124, v124
  v_mfma_f32_16x16x32_bf16 a[68:71], v[180:183], v[136:139], a[68:71]
  buffer_load_dwordx4 v248, s[32:35], s74 offen offset:2048 nt lds
  v_mfma_f32_16x16x32_bf16 a[72:75], v[184:187], v[136:139], a[72:75]
  v_exp_f32 v125, v125
  v_mfma_f32_16x16x32_bf16 a[76:79], v[188:191], v[136:139], a[76:79]
  v_cvt_pk_bf16_f32 v142, v124, v125
  v_mfma_f32_16x16x32_bf16 a[80:83], v[192:195], v[136:139], a[80:83]
  v_exp_f32 v126, v126
  v_mfma_f32_16x16x32_bf16 a[84:87], v[196:199], v[136:139], a[84:87]
  buffer_load_dwordx4 v249, s[32:35], s74 offen offset:3072 nt lds
  v_mfma_f32_16x16x32_bf16 a[88:91], v[200:203], v[136:139], a[88:91]
  v_exp_f32 v127, v127
  v_mfma_f32_16x16x32_bf16 a[92:95], v[204:207], v[136:139], a[92:95]
  v_cvt_pk_bf16_f32 v143, v126, v127
  v_mfma_f32_16x16x32_bf16 a[168:171], a[180:183], v[136:139], a[168:171]
  v_mfma_f32_16x16x32_bf16 v[112:115], v[144:147], v[48:51], v[216:219]
  v_exp_f32 v128, v128
  v_mfma_f32_16x16x32_bf16 v[112:115], v[148:151], v[52:55], v[112:115]
  s_add_u32 m0, s62, 20480
  s_add_u32 s64, s74, 4096
  buffer_load_dwordx4 v246, s[32:35], s64 offen offset:0 nt lds
  v_mfma_f32_16x16x32_bf16 v[112:115], v[152:155], v[56:59], v[112:115]
  v_exp_f32 v129, v129
  v_mfma_f32_16x16x32_bf16 v[112:115], v[156:159], v[60:63], v[112:115]
  v_cvt_pk_bf16_f32 v136, v128, v129
  v_mfma_f32_16x16x32_bf16 v[116:119], v[160:163], v[48:51], v[216:219]
  v_exp_f32 v130, v130
  v_mfma_f32_16x16x32_bf16 v[116:119], v[164:167], v[52:55], v[116:119]
  buffer_load_dwordx4 v247, s[32:35], s64 offen offset:1024 nt lds
  v_mfma_f32_16x16x32_bf16 v[116:119], v[168:171], v[56:59], v[116:119]
  v_exp_f32 v131, v131
  v_mfma_f32_16x16x32_bf16 v[116:119], v[172:175], v[60:63], v[116:119]
  v_cvt_pk_bf16_f32 v137, v130, v131
  v_mfma_f32_16x16x32_bf16 a[96:99], v[176:179], v[140:143], a[96:99]
  v_exp_f32 v132, v132
  v_mfma_f32_16x16x32_bf16 a[100:103], v[180:183], v[140:143], a[100:103]
  buffer_load_dwordx4 v248, s[32:35], s64 offen offset:2048 nt lds
  v_mfma_f32_16x16x32_bf16 a[104:107], v[184:187], v[140:143], a[104:107]
  v_exp_f32 v133, v133
  v_mfma_f32_16x16x32_bf16 a[108:111], v[188:191], v[140:143], a[108:111]
  v_cvt_pk_bf16_f32 v138, v132, v133
  v_mfma_f32_16x16x32_bf16 a[112:115], v[192:195], v[140:143], a[112:115]
  v_exp_f32 v134, v134
  v_mfma_f32_16x16x32_bf16 a[116:119], v[196:199], v[140:143], a[116:119]
  buffer_load_dwordx4 v249, s[32:35], s64 offen offset:3072 nt lds
  v_mfma_f32_16x16x32_bf16 a[120:123], v[200:203], v[140:143], a[120:123]
  v_exp_f32 v135, v135
  v_mfma_f32_16x16x32_bf16 a[124:127], v[204:207], v[140:143], a[124:127]
  v_cvt_pk_bf16_f32 v139, v134, v135
  v_mfma_f32_16x16x32_bf16 a[172:175], a[180:183], v[140:143], a[172:175]
  s_add_u32 s97, s97, 1
  s_add_u32 s66, s97, s96
  s_add_u32 s73, s66, 2
  s_and_b32 s73, s73, 15
  s_lshl_b32 s73, s73, 13
  s_cmp_lt_u32 s97, 14
  s_cselect_b32 s73, s73, 0x40000000
  s_add_u32 s74, s66, 3
  s_and_b32 s74, s74, 15
  s_lshl_b32 s74, s74, 13
  s_cmp_lt_u32 s97, 13
  s_cselect_b32 s74, s74, 0x40000000
  s_waitcnt vmcnt(24)
  v_mfma_f32_16x16x32_bf16 a[128:131], v[176:179], v[136:139], a[128:131]
  ds_read_b64_tr_b16 v[176:177], v232 offset:24576
  ds_read_b64_tr_b16 v[178:179], v232 offset:28672
  v_mfma_f32_16x16x32_bf16 a[132:135], v[180:183], v[136:139], a[132:135]
  ds_read_b64_tr_b16 v[180:181], v233 offset:24576
  ds_read_b64_tr_b16 v[182:183], v233 offset:28672
  v_mfma_f32_16x16x32_bf16 a[136:139], v[184:187], v[136:139], a[136:139]
  ds_read_b64_tr_b16 v[184:185], v234 offset:24576
  ds_read_b64_tr_b16 v[186:187], v234 offset:28672
  v_mfma_f32_16x16x32_bf16 a[140:143], v[188:191], v[136:139], a[140:143]
  ds_read_b64_tr_b16 v[188:189], v235 offset:24576
  ds_read_b64_tr_b16 v[190:191], v235 offset:28672
  v_mfma_f32_16x16x32_bf16 a[144:147], v[192:195], v[136:139], a[144:147]
  ds_read_b64_tr_b16 v[192:193], v236 offset:24576
  ds_read_b64_tr_b16 v[194:195], v236 offset:28672
  v_mfma_f32_16x16x32_bf16 a[148:151], v[196:199], v[136:139], a[148:151]
  ds_read_b64_tr_b16 v[196:197], v237 offset:24576
  ds_read_b64_tr_b16 v[198:199], v237 offset:28672
  v_mfma_f32_16x16x32_bf16 a[152:155], v[200:203], v[136:139], a[152:155]
  ds_read_b64_tr_b16 v[200:201], v238 offset:24576
  ds_read_b64_tr_b16 v[202:203], v238 offset:28672
  v_mfma_f32_16x16x32_bf16 a[156:159], v[204:207], v[136:139], a[156:159]
  ds_read_b64_tr_b16 v[204:205], v239 offset:24576
  ds_read_b64_tr_b16 v[206:207], v239 offset:28672
  v_mfma_f32_16x16x32_bf16 a[176:179], a[180:183], v[136:139], a[176:179]
  v_exp_f32 v96, v96
  v_mfma_f32_16x16x32_bf16 v[120:123], v[144:147], v[64:67], v[220:223]
  v_exp_f32 v97, v97
  v_mfma_f32_16x16x32_bf16 v[120:123], v[148:151], v[68:71], v[120:123]
  v_exp_f32 v98, v98
  v_mfma_f32_16x16x32_bf16 v[120:123], v[152:155], v[72:75], v[120:123]
  v_exp_f32 v99, v99
  v_cvt_pk_bf16_f32 v136, v96, v97
  v_mfma_f32_16x16x32_bf16 v[120:123], v[156:159], v[76:79], v[120:123]
  v_exp_f32 v100, v100
  v_mfma_f32_16x16x32_bf16 v[124:127], v[160:163], v[64:67], v[220:223]
  v_exp_f32 v101, v101
  v_cvt_pk_bf16_f32 v137, v98, v99
  v_mfma_f32_16x16x32_bf16 v[124:127], v[164:167], v[68:71], v[124:127]
  v_exp_f32 v102, v102
  v_mfma_f32_16x16x32_bf16 v[124:127], v[168:171], v[72:75], v[124:127]
  v_exp_f32 v103, v103
  v_cvt_pk_bf16_f32 v138, v100, v101
  v_mfma_f32_16x16x32_bf16 v[124:127], v[172:175], v[76:79], v[124:127]
  s_nop 0
  v_cvt_pk_bf16_f32 v139, v102, v103
  s_waitcnt vmcnt(16)
  v_mfma_f32_16x16x32_bf16 v[128:131], v[144:147], v[80:83], v[224:227]
  ds_read_b128 v[144:147], v228 offset:0
  v_exp_f32 v104, v104
  v_mfma_f32_16x16x32_bf16 v[128:131], v[148:151], v[84:87], v[128:131]
  ds_read_b128 v[148:151], v229 offset:0
  v_mfma_f32_16x16x32_bf16 v[128:131], v[152:155], v[88:91], v[128:131]
  ds_read_b128 v[152:155], v230 offset:0
  v_exp_f32 v105, v105
  v_mfma_f32_16x16x32_bf16 v[128:131], v[156:159], v[92:95], v[128:131]
  ds_read_b128 v[156:159], v231 offset:0
  v_mfma_f32_16x16x32_bf16 v[132:135], v[160:163], v[80:83], v[224:227]
  ds_read_b128 v[160:163], v228 offset:4096
  v_exp_f32 v106, v106
  v_mfma_f32_16x16x32_bf16 v[132:135], v[164:167], v[84:87], v[132:135]
  ds_read_b128 v[164:167], v229 offset:4096
  v_cvt_pk_bf16_f32 v140, v104, v105
  v_mfma_f32_16x16x32_bf16 v[132:135], v[168:171], v[88:91], v[132:135]
  ds_read_b128 v[168:171], v230 offset:4096
  v_exp_f32 v107, v107
  v_mfma_f32_16x16x32_bf16 v[132:135], v[172:175], v[92:95], v[132:135]
  ds_read_b128 v[172:175], v231 offset:4096
  s_waitcnt lgkmcnt(8)
  v_mfma_f32_16x16x32_bf16 a[0:3], v[176:179], v[136:139], a[0:3]
  v_exp_f32 v108, v108
  v_mfma_f32_16x16x32_bf16 a[4:7], v[180:183], v[136:139], a[4:7]
  v_cvt_pk_bf16_f32 v141, v106, v107
  v_mfma_f32_16x16x32_bf16 a[8:11], v[184:187], v[136:139], a[8:11]
  v_exp_f32 v109, v109
  v_mfma_f32_16x16x32_bf16 a[12:15], v[188:191], v[136:139], a[12:15]
  s_add_u32 m0, s62, 24576
  s_nop 0
  buffer_load_dwordx4 v250, s[36:39], s73 offen offset:0 nt lds
  v_mfma_f32_16x16x32_bf16 a[16:19], v[192:195], v[136:139], a[16:19]
  v_exp_f32 v110, v110
  v_mfma_f32_16x16x32_bf16 a[20:23], v[196:199], v[136:139], a[20:23]
  v_cvt_pk_bf16_f32 v142, v108, v109
  buffer_load_dwordx4 v251, s[36:39], s73 offen offset:1024 nt lds
  v_mfma_f32_16x16x32_bf16 a[24:27], v[200:203], v[136:139], a[24:27]
  v_exp_f32 v111, v111
  v_mfma_f32_16x16x32_bf16 a[28:31], v[204:207], v[136:139], a[28:31]
  buffer_load_dwordx4 v250, s[36:39], s73 offen offset:2048 nt lds
  v_mfma_f32_16x16x32_bf16 a[160:163], a[180:183], v[136:139], a[160:163]
  v_cvt_pk_bf16_f32 v143, v110, v111
  s_waitcnt lgkmcnt(0)
  v_mfma_f32_16x16x32_bf16 v[96:99], v[144:147], v[16:19], v[208:211]
  v_exp_f32 v112, v112
  v_mfma_f32_16x16x32_bf16 v[96:99], v[148:151], v[20:23], v[96:99]
  buffer_load_dwordx4 v251, s[36:39], s73 offen offset:3072 nt lds
  v_mfma_f32_16x16x32_bf16 v[96:99], v[152:155], v[24:27], v[96:99]
  v_exp_f32 v113, v113
  v_mfma_f32_16x16x32_bf16 v[96:99], v[156:159], v[28:31], v[96:99]
  v_cvt_pk_bf16_f32 v136, v112, v113
  v_mfma_f32_16x16x32_bf16 v[100:103], v[160:163], v[16:19], v[208:211]
  v_exp_f32 v114, v114
  v_mfma_f32_16x16x32_bf16 v[100:103], v[164:167], v[20:23], v[100:103]
  s_add_u32 m0, s62, 28672
  s_add_u32 s65, s73, 4096
  buffer_load_dwordx4 v250, s[36:39], s65 offen offset:0 nt lds
  v_mfma_f32_16x16x32_bf16 v[100:103], v[168:171], v[24:27], v[100:103]
  v_exp_f32 v115, v115
  v_mfma_f32_16x16x32_bf16 v[100:103], v[172:175], v[28:31], v[100:103]
  v_cvt_pk_bf16_f32 v137, v114, v115
  v_mfma_f32_16x16x32_bf16 a[32:35], v[176:179], v[140:143], a[32:35]
  v_exp_f32 v116, v116
  v_mfma_f32_16x16x32_bf16 a[36:39], v[180:183], v[140:143], a[36:39]
  buffer_load_dwordx4 v251, s[36:39], s65 offen offset:1024 nt lds
  v_mfma_f32_16x16x32_bf16 a[40:43], v[184:187], v[140:143], a[40:43]
  v_exp_f32 v117, v117
  v_mfma_f32_16x16x32_bf16 a[44:47], v[188:191], v[140:143], a[44:47]
  v_cvt_pk_bf16_f32 v138, v116, v117
  v_mfma_f32_16x16x32_bf16 a[48:51], v[192:195], v[140:143], a[48:51]
  v_exp_f32 v118, v118
  v_mfma_f32_16x16x32_bf16 a[52:55], v[196:199], v[140:143], a[52:55]
  buffer_load_dwordx4 v250, s[36:39], s65 offen offset:2048 nt lds
  v_mfma_f32_16x16x32_bf16 a[56:59], v[200:203], v[140:143], a[56:59]
  v_exp_f32 v119, v119
  v_mfma_f32_16x16x32_bf16 a[60:63], v[204:207], v[140:143], a[60:63]
  v_cvt_pk_bf16_f32 v139, v118, v119
  v_mfma_f32_16x16x32_bf16 a[164:167], a[180:183], v[140:143], a[164:167]
  buffer_load_dwordx4 v251, s[36:39], s65 offen offset:3072 nt lds
  v_mfma_f32_16x16x32_bf16 v[104:107], v[144:147], v[32:35], v[212:215]
  v_exp_f32 v120, v120
  v_mfma_f32_16x16x32_bf16 v[104:107], v[148:151], v[36:39], v[104:107]
  s_add_u32 m0, s62, 0
  s_nop 0
  buffer_load_dwordx4 v246, s[32:35], s74 offen offset:0 nt lds
  v_mfma_f32_16x16x32_bf16 v[104:107], v[152:155], v[40:43], v[104:107]
  v_exp_f32 v121, v121
  v_mfma_f32_16x16x32_bf16 v[104:107], v[156:159], v[44:47], v[104:107]
  v_cvt_pk_bf16_f32 v140, v120, v121
  v_mfma_f32_16x16x32_bf16 v[108:111], v[160:163], v[32:35], v[212:215]
  v_exp_f32 v122, v122
  v_mfma_f32_16x16x32_bf16 v[108:111], v[164:167], v[36:39], v[108:111]
  buffer_load_dwordx4 v247, s[32:35], s74 offen offset:1024 nt lds
  v_mfma_f32_16x16x32_bf16 v[108:111], v[168:171], v[40:43], v[108:111]
  v_exp_f32 v123, v123
  v_mfma_f32_16x16x32_bf16 v[108:111], v[172:175], v[44:47], v[108:111]
  v_cvt_pk_bf16_f32 v141, v122, v123
  v_mfma_f32_16x16x32_bf16 a[64:67], v[176:179], v[136:139], a[64:67]
  v_exp_f32 v124, v124
  v_mfma_f32_16x16x32_bf16 a[68:71], v[180:183], v[136:139], a[68:71]
  buffer_load_dwordx4 v248, s[32:35], s74 offen offset:2048 nt lds
  v_mfma_f32_16x16x32_bf16 a[72:75], v[184:187], v[136:139], a[72:75]
  v_exp_f32 v125, v125
  v_mfma_f32_16x16x32_bf16 a[76:79], v[188:191], v[136:139], a[76:79]
  v_cvt_pk_bf16_f32 v142, v124, v125
  v_mfma_f32_16x16x32_bf16 a[80:83], v[192:195], v[136:139], a[80:83]
  v_exp_f32 v126, v126
  v_mfma_f32_16x16x32_bf16 a[84:87], v[196:199], v[136:139], a[84:87]
  buffer_load_dwordx4 v249, s[32:35], s74 offen offset:3072 nt lds
  v_mfma_f32_16x16x32_bf16 a[88:91], v[200:203], v[136:139], a[88:91]
  v_exp_f32 v127, v127
  v_mfma_f32_16x16x32_bf16 a[92:95], v[204:207], v[136:139], a[92:95]
  v_cvt_pk_bf16_f32 v143, v126, v127
  v_mfma_f32_16x16x32_bf16 a[168:171], a[180:183], v[136:139], a[168:171]
  v_mfma_f32_16x16x32_bf16 v[112:115], v[144:147], v[48:51], v[216:219]
  v_exp_f32 v128, v128
  v_mfma_f32_16x16x32_bf16 v[112:115], v[148:151], v[52:55], v[112:115]
  s_add_u32 m0, s62, 4096
  s_add_u32 s64, s74, 4096
  buffer_load_dwordx4 v246, s[32:35], s64 offen offset:0 nt lds
  v_mfma_f32_16x16x32_bf16 v[112:115], v[152:155], v[56:59], v[112:115]
  v_exp_f32 v129, v129
  v_mfma_f32_16x16x32_bf16 v[112:115], v[156:159], v[60:63], v[112:115]
  v_cvt_pk_bf16_f32 v136, v128, v129
  v_mfma_f32_16x16x32_bf16 v[116:119], v[160:163], v[48:51], v[216:219]
  v_exp_f32 v130, v130
  v_mfma_f32_16x16x32_bf16 v[116:119], v[164:167], v[52:55], v[116:119]
  buffer_load_dwordx4 v247, s[32:35], s64 offen offset:1024 nt lds
  v_mfma_f32_16x16x32_bf16 v[116:119], v[168:171], v[56:59], v[116:119]
  v_exp_f32 v131, v131
  v_mfma_f32_16x16x32_bf16 v[116:119], v[172:175], v[60:63], v[116:119]
  v_cvt_pk_bf16_f32 v137, v130, v131
  v_mfma_f32_16x16x32_bf16 a[96:99], v[176:179], v[140:143], a[96:99]
  v_exp_f32 v132, v132
  v_mfma_f32_16x16x32_bf16 a[100:103], v[180:183], v[140:143], a[100:103]
  buffer_load_dwordx4 v248, s[32:35], s64 offen offset:2048 nt lds
  v_mfma_f32_16x16x32_bf16 a[104:107], v[184:187], v[140:143], a[104:107]
  v_exp_f32 v133, v133
  v_mfma_f32_16x16x32_bf16 a[108:111], v[188:191], v[140:143], a[108:111]
  v_cvt_pk_bf16_f32 v138, v132, v133
  v_mfma_f32_16x16x32_bf16 a[112:115], v[192:195], v[140:143], a[112:115]
  v_exp_f32 v134, v134
  v_mfma_f32_16x16x32_bf16 a[116:119], v[196:199], v[140:143], a[116:119]
  buffer_load_dwordx4 v249, s[32:35], s64 offen offset:3072 nt lds
  v_mfma_f32_16x16x32_bf16 a[120:123], v[200:203], v[140:143], a[120:123]
  v_exp_f32 v135, v135
  v_mfma_f32_16x16x32_bf16 a[124:127], v[204:207], v[140:143], a[124:127]
  v_cvt_pk_bf16_f32 v139, v134, v135
  v_mfma_f32_16x16x32_bf16 a[172:175], a[180:183], v[140:143], a[172:175]
  s_add_u32 s97, s97, 1
  s_add_u32 s66, s97, s96
  s_add_u32 s73, s66, 2
  s_and_b32 s73, s73, 15
  s_lshl_b32 s73, s73, 13
  s_cmp_lt_u32 s97, 14
  s_cselect_b32 s73, s73, 0x40000000
  s_add_u32 s74, s66, 3
  s_and_b32 s74, s74, 15
  s_lshl_b32 s74, s74, 13
  s_cmp_lt_u32 s97, 13
  s_cselect_b32 s74, s74, 0x40000000
  s_add_u32 s68, s68, 2
  s_cmp_lt_u32 s68, 16
  s_cbranch_scc1 K1_ALOOP_B
K1_POST:
  v_mfma_f32_16x16x32_bf16 a[128:131], v[176:179], v[136:139], a[128:131]
  v_mfma_f32_16x16x32_bf16 a[132:135], v[180:183], v[136:139], a[132:135]
  v_mfma_f32_16x16x32_bf16 a[136:139], v[184:187], v[136:139], a[136:139]
  v_mfma_f32_16x16x32_bf16 a[140:143], v[188:191], v[136:139], a[140:143]
  v_mfma_f32_16x16x32_bf16 a[144:147], v[192:195], v[136:139], a[144:147]
  v_mfma_f32_16x16x32_bf16 a[148:151], v[196:199], v[136:139], a[148:151]
  v_mfma_f32_16x16x32_bf16 a[152:155], v[200:203], v[136:139], a[152:155]
  v_mfma_f32_16x16x32_bf16 a[156:159], v[204:207], v[136:139], a[156:159]
  v_mfma_f32_16x16x32_bf16 a[176:179], a[180:183], v[136:139], a[176:179]
  s_nop 7
  s_nop 1
  v_accvgpr_read_b32 v96, a160
  v_accvgpr_read_b32 v97, a164
  v_accvgpr_read_b32 v98, a168
  v_accvgpr_read_b32 v99, a172
  v_accvgpr_read_b32 v100, a176
  s_cmp_lg_u32 s5, 0
  s_cbranch_scc1 K1_NORM
  v_add_f32 v14, v96, v97
  v_add_f32 v14, v14, v98
  v_add_f32 v14, v14, v99
  v_add_f32 v14, v14, v100
  v_mov_b32 v15, 0x4e800000
  v_cmp_nlt_f32 vcc, v14, v15
  s_nop 4
  s_cbranch_vccnz K1_FALLBACK
K1_NORM:
  v_lshrrev_b32 v13, 3, v0
  s_lshl_b32 s65, s56, 7
  v_add_u32 v13, s65, v13
  v_mul_u32_u24 v13, 1152, v13
  v_lshlrev_b32 v14, 1, v9
  v_and_b32 v15, 7, v0
  v_xor_b32 v14, v14, v15
  v_lshl_add_u32 v1, v14, 4, v13
  v_add_u32 v2, 8192, v1
  v_add_u32 v3, 16384, v1
  v_add_u32 v4, 24576, v1
  v_lshlrev_b32 v5, 3, v0
  s_lshl_b32 s72, s56, 14
  s_add_u32 s71, s72, 98304
  s_mul_i32 s70, s56, 20480
  v_rcp_f32 v208, v96
  v_rcp_f32 v210, v97
  v_rcp_f32 v212, v98
  v_rcp_f32 v214, v99
  v_rcp_f32 v216, v100
  s_nop 0
  v_mov_b32 v209, v208
  v_mov_b32 v211, v210
  v_mov_b32 v213, v212
  v_mov_b32 v215, v214
  v_mov_b32 v217, v216
  v_accvgpr_read_b32 v144, a0
  v_accvgpr_read_b32 v148, a4
  v_accvgpr_read_b32 v145, a1
  v_accvgpr_read_b32 v149, a5
  v_accvgpr_read_b32 v146, a2
  v_accvgpr_read_b32 v150, a6
  v_accvgpr_read_b32 v147, a3
  v_accvgpr_read_b32 v151, a7
  v_pk_mul_f32 v[144:145], v[144:145], v[208:209]
  v_pk_mul_f32 v[146:147], v[146:147], v[208:209]
  v_pk_mul_f32 v[148:149], v[148:149], v[208:209]
  v_pk_mul_f32 v[150:151], v[150:151], v[208:209]
  v_cvt_pk_bf16_f32 v16, v144, v145
  v_cvt_pk_bf16_f32 v17, v146, v147
  v_cvt_pk_bf16_f32 v18, v148, v149
  v_cvt_pk_bf16_f32 v19, v150, v151
  v_accvgpr_read_b32 v152, a32
  v_accvgpr_read_b32 v156, a36
  v_accvgpr_read_b32 v153, a33
  v_accvgpr_read_b32 v157, a37
  v_accvgpr_read_b32 v154, a34
  v_accvgpr_read_b32 v158, a38
  v_accvgpr_read_b32 v155, a35
  v_accvgpr_read_b32 v159, a39
  v_pk_mul_f32 v[152:153], v[152:153], v[210:211]
  v_pk_mul_f32 v[154:155], v[154:155], v[210:211]
  v_pk_mul_f32 v[156:157], v[156:157], v[210:211]
  v_pk_mul_f32 v[158:159], v[158:159], v[210:211]
  v_cvt_pk_bf16_f32 v20, v152, v153
  v_cvt_pk_bf16_f32 v21, v154, v155
  v_cvt_pk_bf16_f32 v22, v156, v157
  v_cvt_pk_bf16_f32 v23, v158, v159
  v_accvgpr_read_b32 v160, a64
  v_accvgpr_read_b32 v164, a68
  v_accvgpr_read_b32 v161, a65
  v_accvgpr_read_b32 v165, a69
  v_accvgpr_read_b32 v162, a66
  v_accvgpr_read_b32 v166, a70
  v_accvgpr_read_b32 v163, a67
  v_accvgpr_read_b32 v167, a71
  v_pk_mul_f32 v[160:161], v[160:161], v[212:213]
  v_pk_mul_f32 v[162:163], v[162:163], v[212:213]
  v_pk_mul_f32 v[164:165], v[164:165], v[212:213]
  v_pk_mul_f32 v[166:167], v[166:167], v[212:213]
  v_cvt_pk_bf16_f32 v24, v160, v161
  v_cvt_pk_bf16_f32 v25, v162, v163
  v_cvt_pk_bf16_f32 v26, v164, v165
  v_cvt_pk_bf16_f32 v27, v166, v167
  v_accvgpr_read_b32 v168, a96
  v_accvgpr_read_b32 v172, a100
  v_accvgpr_read_b32 v169, a97
  v_accvgpr_read_b32 v173, a101
  v_accvgpr_read_b32 v170, a98
  v_accvgpr_read_b32 v174, a102
  v_accvgpr_read_b32 v171, a99
  v_accvgpr_read_b32 v175, a103
  v_pk_mul_f32 v[168:169], v[168:169], v[214:215]
  v_pk_mul_f32 v[170:171], v[170:171], v[214:215]
  v_pk_mul_f32 v[172:173], v[172:173], v[214:215]
  v_pk_mul_f32 v[174:175], v[174:175], v[214:215]
  v_cvt_pk_bf16_f32 v28, v168, v169
  v_cvt_pk_bf16_f32 v29, v170, v171
  v_cvt_pk_bf16_f32 v30, v172, v173
  v_cvt_pk_bf16_f32 v31, v174, v175
  v_accvgpr_read_b32 v144, a128
  v_accvgpr_read_b32 v148, a132
  v_accvgpr_read_b32 v145, a129
  v_accvgpr_read_b32 v149, a133
  v_accvgpr_read_b32 v146, a130
  v_accvgpr_read_b32 v150, a134
  v_accvgpr_read_b32 v147, a131
  v_accvgpr_read_b32 v151, a135
  v_pk_mul_f32 v[144:145], v[144:145], v[216:217]
  v_pk_mul_f32 v[146:147], v[146:147], v[216:217]
  v_pk_mul_f32 v[148:149], v[148:149], v[216:217]
  v_pk_mul_f32 v[150:151], v[150:151], v[216:217]
  v_cvt_pk_bf16_f32 v32, v144, v145
  v_cvt_pk_bf16_f32 v33, v146, v147
  v_cvt_pk_bf16_f32 v34, v148, v149
  v_cvt_pk_bf16_f32 v35, v150, v151
  v_accvgpr_read_b32 v152, a8
  v_accvgpr_read_b32 v156, a12
  v_accvgpr_read_b32 v153, a9
  v_accvgpr_read_b32 v157, a13
  v_accvgpr_read_b32 v154, a10
  v_accvgpr_read_b32 v158, a14
  v_accvgpr_read_b32 v155, a11
  v_accvgpr_read_b32 v159, a15
  v_pk_mul_f32 v[152:153], v[152:153], v[208:209]
  v_pk_mul_f32 v[154:155], v[154:155], v[208:209]
  v_pk_mul_f32 v[156:157], v[156:157], v[208:209]
  v_pk_mul_f32 v[158:159], v[158:159], v[208:209]
  v_cvt_pk_bf16_f32 v36, v152, v153
  v_cvt_pk_bf16_f32 v37, v154, v155
  v_cvt_pk_bf16_f32 v38, v156, v157
  v_cvt_pk_bf16_f32 v39, v158, v159
  v_accvgpr_read_b32 v160, a40
  v_accvgpr_read_b32 v164, a44
  v_accvgpr_read_b32 v161, a41
  v_accvgpr_read_b32 v165, a45
  v_accvgpr_read_b32 v162, a42
  v_accvgpr_read_b32 v166, a46
  v_accvgpr_read_b32 v163, a43
  v_accvgpr_read_b32 v167, a47
  v_pk_mul_f32 v[160:161], v[160:161], v[210:211]
  v_pk_mul_f32 v[162:163], v[162:163], v[210:211]
  v_pk_mul_f32 v[164:165], v[164:165], v[210:211]
  v_pk_mul_f32 v[166:167], v[166:167], v[210:211]
  v_cvt_pk_bf16_f32 v40, v160, v161
  v_cvt_pk_bf16_f32 v41, v162, v163
  v_cvt_pk_bf16_f32 v42, v164, v165
  v_cvt_pk_bf16_f32 v43, v166, v167
  v_accvgpr_read_b32 v168, a72
  v_accvgpr_read_b32 v172, a76
  v_accvgpr_read_b32 v169, a73
  v_accvgpr_read_b32 v173, a77
  v_accvgpr_read_b32 v170, a74
  v_accvgpr_read_b32 v174, a78
  v_accvgpr_read_b32 v171, a75
  v_accvgpr_read_b32 v175, a79
  v_pk_mul_f32 v[168:169], v[168:169], v[212:213]
  v_pk_mul_f32 v[170:171], v[170:171], v[212:213]
  v_pk_mul_f32 v[172:173], v[172:173], v[212:213]
  v_pk_mul_f32 v[174:175], v[174:175], v[212:213]
  v_cvt_pk_bf16_f32 v44, v168, v169
  v_cvt_pk_bf16_f32 v45, v170, v171
  v_cvt_pk_bf16_f32 v46, v172, v173
  v_cvt_pk_bf16_f32 v47, v174, v175
  v_accvgpr_read_b32 v144, a104
  v_accvgpr_read_b32 v148, a108
  v_accvgpr_read_b32 v145, a105
  v_accvgpr_read_b32 v149, a109
  v_accvgpr_read_b32 v146, a106
  v_accvgpr_read_b32 v150, a110
  v_accvgpr_read_b32 v147, a107
  v_accvgpr_read_b32 v151, a111
  v_pk_mul_f32 v[144:145], v[144:145], v[214:215]
  v_pk_mul_f32 v[146:147], v[146:147], v[214:215]
  v_pk_mul_f32 v[148:149], v[148:149], v[214:215]
  v_pk_mul_f32 v[150:151], v[150:151], v[214:215]
  v_cvt_pk_bf16_f32 v48, v144, v145
  v_cvt_pk_bf16_f32 v49, v146, v147
  v_cvt_pk_bf16_f32 v50, v148, v149
  v_cvt_pk_bf16_f32 v51, v150, v151
  v_accvgpr_read_b32 v152, a136
  v_accvgpr_read_b32 v156, a140
  v_accvgpr_read_b32 v153, a137
  v_accvgpr_read_b32 v157, a141
  v_accvgpr_read_b32 v154, a138
  v_accvgpr_read_b32 v158, a142
  v_accvgpr_read_b32 v155, a139
  v_accvgpr_read_b32 v159, a143
  v_pk_mul_f32 v[152:153], v[152:153], v[216:217]
  v_pk_mul_f32 v[154:155], v[154:155], v[216:217]
  v_pk_mul_f32 v[156:157], v[156:157], v[216:217]
  v_pk_mul_f32 v[158:159], v[158:159], v[216:217]
  v_cvt_pk_bf16_f32 v52, v152, v153
  v_cvt_pk_bf16_f32 v53, v154, v155
  v_cvt_pk_bf16_f32 v54, v156, v157
  v_cvt_pk_bf16_f32 v55, v158, v159
  v_accvgpr_read_b32 v160, a16
  v_accvgpr_read_b32 v164, a20
  v_accvgpr_read_b32 v161, a17
  v_accvgpr_read_b32 v165, a21
  v_accvgpr_read_b32 v162, a18
  v_accvgpr_read_b32 v166, a22
  v_accvgpr_read_b32 v163, a19
  v_accvgpr_read_b32 v167, a23
  v_pk_mul_f32 v[160:161], v[160:161], v[208:209]
  v_pk_mul_f32 v[162:163], v[162:163], v[208:209]
  v_pk_mul_f32 v[164:165], v[164:165], v[208:209]
  v_pk_mul_f32 v[166:167], v[166:167], v[208:209]
  v_cvt_pk_bf16_f32 v56, v160, v161
  v_cvt_pk_bf16_f32 v57, v162, v163
  v_cvt_pk_bf16_f32 v58, v164, v165
  v_cvt_pk_bf16_f32 v59, v166, v167
  v_accvgpr_read_b32 v168, a48
  v_accvgpr_read_b32 v172, a52
  v_accvgpr_read_b32 v169, a49
  v_accvgpr_read_b32 v173, a53
  v_accvgpr_read_b32 v170, a50
  v_accvgpr_read_b32 v174, a54
  v_accvgpr_read_b32 v171, a51
  v_accvgpr_read_b32 v175, a55
  v_pk_mul_f32 v[168:169], v[168:169], v[210:211]
  v_pk_mul_f32 v[170:171], v[170:171], v[210:211]
  v_pk_mul_f32 v[172:173], v[172:173], v[210:211]
  v_pk_mul_f32 v[174:175], v[174:175], v[210:211]
  v_cvt_pk_bf16_f32 v60, v168, v169
  v_cvt_pk_bf16_f32 v61, v170, v171
  v_cvt_pk_bf16_f32 v62, v172, v173
  v_cvt_pk_bf16_f32 v63, v174, v175
  v_accvgpr_read_b32 v144, a80
  v_accvgpr_read_b32 v148, a84
  v_accvgpr_read_b32 v145, a81
  v_accvgpr_read_b32 v149, a85
  v_accvgpr_read_b32 v146, a82
  v_accvgpr_read_b32 v150, a86
  v_accvgpr_read_b32 v147, a83
  v_accvgpr_read_b32 v151, a87
  v_pk_mul_f32 v[144:145], v[144:145], v[212:213]
  v_pk_mul_f32 v[146:147], v[146:147], v[212:213]
  v_pk_mul_f32 v[148:149], v[148:149], v[212:213]
  v_pk_mul_f32 v[150:151], v[150:151], v[212:213]
  v_cvt_pk_bf16_f32 v64, v144, v145
  v_cvt_pk_bf16_f32 v65, v146, v147
  v_cvt_pk_bf16_f32 v66, v148, v149
  v_cvt_pk_bf16_f32 v67, v150, v151
  v_accvgpr_read_b32 v152, a112
  v_accvgpr_read_b32 v156, a116
  v_accvgpr_read_b32 v153, a113
  v_accvgpr_read_b32 v157, a117
  v_accvgpr_read_b32 v154, a114
  v_accvgpr_read_b32 v158, a118
  v_accvgpr_read_b32 v155, a115
  v_accvgpr_read_b32 v159, a119
  v_pk_mul_f32 v[152:153], v[152:153], v[214:215]
  v_pk_mul_f32 v[154:155], v[154:155], v[214:215]
  v_pk_mul_f32 v[156:157], v[156:157], v[214:215]
  v_pk_mul_f32 v[158:159], v[158:159], v[214:215]
  v_cvt_pk_bf16_f32 v68, v152, v153
  v_cvt_pk_bf16_f32 v69, v154, v155
  v_cvt_pk_bf16_f32 v70, v156, v157
  v_cvt_pk_bf16_f32 v71, v158, v159
  v_accvgpr_read_b32 v160, a144
  v_accvgpr_read_b32 v164, a148
  v_accvgpr_read_b32 v161, a145
  v_accvgpr_read_b32 v165, a149
  v_accvgpr_read_b32 v162, a146
  v_accvgpr_read_b32 v166, a150
  v_accvgpr_read_b32 v163, a147
  v_accvgpr_read_b32 v167, a151
  v_pk_mul_f32 v[160:161], v[160:161], v[216:217]
  v_pk_mul_f32 v[162:163], v[162:163], v[216:217]
  v_pk_mul_f32 v[164:165], v[164:165], v[216:217]
  v_pk_mul_f32 v[166:167], v[166:167], v[216:217]
  v_cvt_pk_bf16_f32 v72, v160, v161
  v_cvt_pk_bf16_f32 v73, v162, v163
  v_cvt_pk_bf16_f32 v74, v164, v165
  v_cvt_pk_bf16_f32 v75, v166, v167
  v_accvgpr_read_b32 v168, a24
  v_accvgpr_read_b32 v172, a28
  v_accvgpr_read_b32 v169, a25
  v_accvgpr_read_b32 v173, a29
  v_accvgpr_read_b32 v170, a26
  v_accvgpr_read_b32 v174, a30
  v_accvgpr_read_b32 v171, a27
  v_accvgpr_read_b32 v175, a31
  v_pk_mul_f32 v[168:169], v[168:169], v[208:209]
  v_pk_mul_f32 v[170:171], v[170:171], v[208:209]
  v_pk_mul_f32 v[172:173], v[172:173], v[208:209]
  v_pk_mul_f32 v[174:175], v[174:175], v[208:209]
  v_cvt_pk_bf16_f32 v76, v168, v169
  v_cvt_pk_bf16_f32 v77, v170, v171
  v_cvt_pk_bf16_f32 v78, v172, v173
  v_cvt_pk_bf16_f32 v79, v174, v175
  v_accvgpr_read_b32 v144, a56
  v_accvgpr_read_b32 v148, a60
  v_accvgpr_read_b32 v145, a57
  v_accvgpr_read_b32 v149, a61
  v_accvgpr_read_b32 v146, a58
  v_accvgpr_read_b32 v150, a62
  v_accvgpr_read_b32 v147, a59
  v_accvgpr_read_b32 v151, a63
  v_pk_mul_f32 v[144:145], v[144:145], v[210:211]
  v_pk_mul_f32 v[146:147], v[146:147], v[210:211]
  v_pk_mul_f32 v[148:149], v[148:149], v[210:211]
  v_pk_mul_f32 v[150:151], v[150:151], v[210:211]
  v_cvt_pk_bf16_f32 v80, v144, v145
  v_cvt_pk_bf16_f32 v81, v146, v147
  v_cvt_pk_bf16_f32 v82, v148, v149
  v_cvt_pk_bf16_f32 v83, v150, v151
  v_accvgpr_read_b32 v152, a88
  v_accvgpr_read_b32 v156, a92
  v_accvgpr_read_b32 v153, a89
  v_accvgpr_read_b32 v157, a93
  v_accvgpr_read_b32 v154, a90
  v_accvgpr_read_b32 v158, a94
  v_accvgpr_read_b32 v155, a91
  v_accvgpr_read_b32 v159, a95
  v_pk_mul_f32 v[152:153], v[152:153], v[212:213]
  v_pk_mul_f32 v[154:155], v[154:155], v[212:213]
  v_pk_mul_f32 v[156:157], v[156:157], v[212:213]
  v_pk_mul_f32 v[158:159], v[158:159], v[212:213]
  v_cvt_pk_bf16_f32 v84, v152, v153
  v_cvt_pk_bf16_f32 v85, v154, v155
  v_cvt_pk_bf16_f32 v86, v156, v157
  v_cvt_pk_bf16_f32 v87, v158, v159
  v_accvgpr_read_b32 v160, a120
  v_accvgpr_read_b32 v164, a124
  v_accvgpr_read_b32 v161, a121
  v_accvgpr_read_b32 v165, a125
  v_accvgpr_read_b32 v162, a122
  v_accvgpr_read_b32 v166, a126
  v_accvgpr_read_b32 v163, a123
  v_accvgpr_read_b32 v167, a127
  v_pk_mul_f32 v[160:161], v[160:161], v[214:215]
  v_pk_mul_f32 v[162:163], v[162:163], v[214:215]
  v_pk_mul_f32 v[164:165], v[164:165], v[214:215]
  v_pk_mul_f32 v[166:167], v[166:167], v[214:215]
  v_cvt_pk_bf16_f32 v88, v160, v161
  v_cvt_pk_bf16_f32 v89, v162, v163
  v_cvt_pk_bf16_f32 v90, v164, v165
  v_cvt_pk_bf16_f32 v91, v166, v167
  v_accvgpr_read_b32 v168, a152
  v_accvgpr_read_b32 v172, a156
  v_accvgpr_read_b32 v169, a153
  v_accvgpr_read_b32 v173, a157
  v_accvgpr_read_b32 v170, a154
  v_accvgpr_read_b32 v174, a158
  v_accvgpr_read_b32 v171, a155
  v_accvgpr_read_b32 v175, a159
  v_pk_mul_f32 v[168:169], v[168:169], v[216:217]
  v_pk_mul_f32 v[170:171], v[170:171], v[216:217]
  v_pk_mul_f32 v[172:173], v[172:173], v[216:217]
  v_pk_mul_f32 v[174:175], v[174:175], v[216:217]
  v_cvt_pk_bf16_f32 v92, v168, v169
  v_cvt_pk_bf16_f32 v93, v170, v171
  v_cvt_pk_bf16_f32 v94, v172, v173
  v_cvt_pk_bf16_f32 v95, v174, v175
  s_waitcnt vmcnt(0)
  s_barrier
  s_lshl_b32 s79, s98, 7
  s_add_u32 m0, s71, 0
  s_nop 0
  buffer_load_dwordx4 v1, s[48:51], s79 offen offset:0 lds
  buffer_load_dwordx4 v2, s[48:51], s79 offen offset:1024 lds
  buffer_load_dwordx4 v3, s[48:51], s79 offen offset:2048 lds
  buffer_load_dwordx4 v4, s[48:51], s79 offen offset:3072 lds
  s_add_u32 m0, s71, 4096
  s_add_u32 s67, s79, 36864
  buffer_load_dwordx4 v1, s[48:51], s67 offen offset:0 lds
  buffer_load_dwordx4 v2, s[48:51], s67 offen offset:1024 lds
  buffer_load_dwordx4 v3, s[48:51], s67 offen offset:2048 lds
  buffer_load_dwordx4 v4, s[48:51], s67 offen offset:3072 lds
  s_add_u32 m0, s71, 8192
  s_add_u32 s67, s79, 73728
  buffer_load_dwordx4 v1, s[48:51], s67 offen offset:0 lds
  buffer_load_dwordx4 v2, s[48:51], s67 offen offset:1024 lds
  buffer_load_dwordx4 v3, s[48:51], s67 offen offset:2048 lds
  buffer_load_dwordx4 v4, s[48:51], s67 offen offset:3072 lds
  s_add_u32 m0, s71, 12288
  s_add_u32 s67, s79, 110592
  buffer_load_dwordx4 v1, s[48:51], s67 offen offset:0 lds
  buffer_load_dwordx4 v2, s[48:51], s67 offen offset:1024 lds
  buffer_load_dwordx4 v3, s[48:51], s67 offen offset:2048 lds
  buffer_load_dwordx4 v4, s[48:51], s67 offen offset:3072 lds
  v_add_u32 v13, s70, v254
  ds_write_b128 v13, v[16:19] offset:0
  ds_write_b128 v13, v[20:23] offset:1024
  ds_write_b128 v13, v[24:27] offset:2048
  ds_write_b128 v13, v[28:31] offset:3072
  ds_write_b128 v13, v[32:35] offset:4096
  ds_write_b128 v13, v[36:39] offset:5120
  ds_write_b128 v13, v[40:43] offset:6144
  ds_write_b128 v13, v[44:47] offset:7168
  ds_write_b128 v13, v[48:51] offset:8192
  ds_write_b128 v13, v[52:55] offset:9216
  ds_write_b128 v13, v[56:59] offset:10240
  ds_write_b128 v13, v[60:63] offset:11264
  ds_write_b128 v13, v[64:67] offset:12288
  ds_write_b128 v13, v[68:71] offset:13312
  ds_write_b128 v13, v[72:75] offset:14336
  ds_write_b128 v13, v[76:79] offset:15360
  ds_write_b128 v13, v[80:83] offset:16384
  ds_write_b128 v13, v[84:87] offset:17408
  ds_write_b128 v13, v[88:91] offset:18432
  ds_write_b128 v13, v[92:95] offset:19456
  v_lshl_add_u32 v14, v9, 2, v11
  v_lshlrev_b32 v14, 7, v14
  v_lshrrev_b32 v15, 1, v11
  v_lshl_add_u32 v15, v9, 1, v15
  v_and_b32 v15, 3, v15
  v_lshlrev_b32 v15, 1, v15
  v_lshrrev_b32 v13, 1, v12
  s_lshl_b32 s64, s56, 1
  v_add_u32 v13, s64, v13
  v_xor_b32 v13, v13, v15
  v_lshl_add_u32 v14, v13, 4, v14
  v_and_b32 v13, 1, v12
  v_lshl_add_u32 v14, v13, 3, v14
  s_add_u32 s64, s56, 0
  s_and_b32 s64, s64, 3
  s_lshl_b32 s64, s64, 14
  v_add_u32 v236, s64, v14
  v_add_u32 v232, 98304, v236
  s_add_u32 s64, s56, 1
  s_and_b32 s64, s64, 3
  s_lshl_b32 s64, s64, 14
  v_add_u32 v237, s64, v14
  v_add_u32 v233, 98304, v237
  s_add_u32 s64, s56, 2
  s_and_b32 s64, s64, 3
  s_lshl_b32 s64, s64, 14
  v_add_u32 v238, s64, v14
  v_add_u32 v234, 98304, v238
  s_add_u32 s64, s56, 3
  s_and_b32 s64, s64, 3
  s_lshl_b32 s64, s64, 14
  v_add_u32 v239, s64, v14
  v_add_u32 v235, 98304, v239
  s_waitcnt lgkmcnt(0)
  s_barrier
  s_add_u32 s64, s56, 1
  s_and_b32 s64, s64, 3
  s_mul_i32 s64, s64, 20480
  v_add_u32 v13, s64, v254
  ds_read_b128 v[96:99], v13 offset:0
  ds_read_b128 v[100:103], v13 offset:1024
  ds_read_b128 v[104:107], v13 offset:2048
  ds_read_b128 v[108:111], v13 offset:3072
  ds_read_b128 v[112:115], v13 offset:4096
  ds_read_b128 v[116:119], v13 offset:5120
  ds_read_b128 v[120:123], v13 offset:6144
  ds_read_b128 v[124:127], v13 offset:7168
  ds_read_b128 v[128:131], v13 offset:8192
  ds_read_b128 v[132:135], v13 offset:9216
  s_waitcnt lgkmcnt(4)
  ds_read_b128 v[136:139], v13 offset:10240
  ds_read_b128 v[140:143], v13 offset:11264
  ds_read_b128 v[144:147], v13 offset:12288
  ds_read_b128 v[148:151], v13 offset:13312
  ds_read_b128 v[152:155], v13 offset:14336
  ds_read_b128 v[156:159], v13 offset:15360
  ds_read_b128 v[160:163], v13 offset:16384
  ds_read_b128 v[164:167], v13 offset:17408
  ds_read_b128 v[168:171], v13 offset:18432
  ds_read_b128 v[172:175], v13 offset:19456
  s_waitcnt lgkmcnt(4)
  s_add_u32 s64, s56, 2
  s_and_b32 s64, s64, 3
  s_mul_i32 s64, s64, 20480
  v_add_u32 v13, s64, v254
  ds_read_b128 a[96:99], v13 offset:0
  ds_read_b128 a[100:103], v13 offset:1024
  ds_read_b128 a[104:107], v13 offset:2048
  ds_read_b128 a[108:111], v13 offset:3072
  ds_read_b128 a[112:115], v13 offset:4096
  ds_read_b128 a[116:119], v13 offset:5120
  ds_read_b128 a[120:123], v13 offset:6144
  ds_read_b128 a[124:127], v13 offset:7168
  ds_read_b128 a[128:131], v13 offset:8192
  ds_read_b128 a[132:135], v13 offset:9216
  s_waitcnt lgkmcnt(4)
  ds_read_b128 a[136:139], v13 offset:10240
  ds_read_b128 a[140:143], v13 offset:11264
  ds_read_b128 a[144:147], v13 offset:12288
  ds_read_b128 a[148:151], v13 offset:13312
  ds_read_b128 a[152:155], v13 offset:14336
  ds_read_b128 a[156:159], v13 offset:15360
  ds_read_b128 a[160:163], v13 offset:16384
  ds_read_b128 a[164:167], v13 offset:17408
  ds_read_b128 a[168:171], v13 offset:18432
  ds_read_b128 a[172:175], v13 offset:19456
  s_waitcnt lgkmcnt(4)
  s_add_u32 s64, s56, 3
  s_and_b32 s64, s64, 3
  s_mul_i32 s64, s64, 20480
  v_add_u32 v13, s64, v254
  ds_read_b128 a[176:179], v13 offset:0
  ds_read_b128 a[180:183], v13 offset:1024
  ds_read_b128 a[184:187], v13 offset:2048
  ds_read_b128 a[188:191], v13 offset:3072
  ds_read_b128 a[192:195], v13 offset:4096
  ds_read_b128 a[196:199], v13 offset:5120
  ds_read_b128 a[200:203], v13 offset:6144
  ds_read_b128 a[204:207], v13 offset:7168
  ds_read_b128 a[208:211], v13 offset:8192
  ds_read_b128 a[212:215], v13 offset:9216
  s_waitcnt lgkmcnt(4)
  ds_read_b128 a[216:219], v13 offset:10240
  ds_read_b128 a[220:223], v13 offset:11264
  ds_read_b128 a[224:227], v13 offset:12288
  ds_read_b128 a[228:231], v13 offset:13312
  ds_read_b128 a[232:235], v13 offset:14336
  ds_read_b128 a[236:239], v13 offset:15360
  ds_read_b128 a[240:243], v13 offset:16384
  ds_read_b128 a[244:247], v13 offset:17408
  ds_read_b128 a[248:251], v13 offset:18432
  ds_read_b128 a[252:255], v13 offset:19456
  s_waitcnt lgkmcnt(4)
  s_waitcnt vmcnt(0) lgkmcnt(0)
  s_barrier
  s_add_u32 s69, s98, 1
  s_lshl_b32 s69, s69, 7
  s_add_u32 m0, s72, 0
  s_nop 0
  buffer_load_dwordx4 v1, s[48:51], s69 offen offset:0 lds
  buffer_load_dwordx4 v2, s[48:51], s69 offen offset:1024 lds
  buffer_load_dwordx4 v3, s[48:51], s69 offen offset:2048 lds
  buffer_load_dwordx4 v4, s[48:51], s69 offen offset:3072 lds
  s_add_u32 m0, s72, 4096
  s_add_u32 s67, s69, 36864
  buffer_load_dwordx4 v1, s[48:51], s67 offen offset:0 lds
  buffer_load_dwordx4 v2, s[48:51], s67 offen offset:1024 lds
  buffer_load_dwordx4 v3, s[48:51], s67 offen offset:2048 lds
  buffer_load_dwordx4 v4, s[48:51], s67 offen offset:3072 lds
  s_add_u32 m0, s72, 8192
  s_add_u32 s67, s69, 73728
  buffer_load_dwordx4 v1, s[48:51], s67 offen offset:0 lds
  buffer_load_dwordx4 v2, s[48:51], s67 offen offset:1024 lds
  ds_read_b64_tr_b16 v[176:177], v232 offset:0
  ds_read_b64_tr_b16 v[178:179], v232 offset:2048
  ds_read_b64_tr_b16 v[180:181], v232 offset:4096
  ds_read_b64_tr_b16 v[182:183], v232 offset:6144
  ds_read_b64_tr_b16 v[184:185], v232 offset:8192
  ds_read_b64_tr_b16 v[186:187], v232 offset:10240
  ds_read_b64_tr_b16 v[188:189], v232 offset:12288
  ds_read_b64_tr_b16 v[190:191], v232 offset:14336
  s_waitcnt lgkmcnt(0)
  ds_read_b64_tr_b16 v[192:193], v233 offset:0
  ds_read_b64_tr_b16 v[194:195], v233 offset:2048
  ds_read_b64_tr_b16 v[196:197], v233 offset:4096
  ds_read_b64_tr_b16 v[198:199], v233 offset:6144
  ds_read_b64_tr_b16 v[200:201], v233 offset:8192
  ds_read_b64_tr_b16 v[202:203], v233 offset:10240
  ds_read_b64_tr_b16 v[204:205], v233 offset:12288
  ds_read_b64_tr_b16 v[206:207], v233 offset:14336
  s_waitcnt lgkmcnt(0)
  s_mov_b32 s68, 0
K1_P3LOOP:
  s_waitcnt lgkmcnt(8)
  v_mfma_f32_16x16x32_bf16 a[0:3], v[176:179], v[16:19], 0
  v_mfma_f32_16x16x32_bf16 a[0:3], v[180:183], v[36:39], a[0:3]
  v_mfma_f32_16x16x32_bf16 a[4:7], v[176:179], v[20:23], 0
  buffer_load_dwordx4 v3, s[48:51], s67 offen offset:2048 lds
  s_add_u32 s79, s68, 8
  v_mfma_f32_16x16x32_bf16 a[4:7], v[180:183], v[40:43], a[4:7]
  s_add_u32 s79, s79, s98
  s_sub_u32 s65, s79, 9
  v_mfma_f32_16x16x32_bf16 a[8:11], v[176:179], v[24:27], 0
  buffer_load_dwordx4 v4, s[48:51], s67 offen offset:3072 lds
  v_mfma_f32_16x16x32_bf16 a[8:11], v[180:183], v[44:47], a[8:11]
  s_cmp_ge_u32 s79, 9
  s_cselect_b32 s79, s65, s79
  v_mfma_f32_16x16x32_bf16 a[12:15], v[176:179], v[28:31], 0
  s_sub_u32 s65, s79, 9
  v_mfma_f32_16x16x32_bf16 a[12:15], v[180:183], v[48:51], a[12:15]
  s_add_u32 m0, s72, 12288
  v_mfma_f32_16x16x32_bf16 a[16:19], v[176:179], v[32:35], 0
  s_cmp_ge_u32 s79, 9
  s_cselect_b32 s79, s65, s79
  v_mfma_f32_16x16x32_bf16 a[16:19], v[180:183], v[52:55], a[16:19]
  s_waitcnt lgkmcnt(8)
  s_lshl_b32 s79, s79, 2
  v_mfma_f32_16x16x32_bf16 a[0:3], v[184:187], v[56:59], a[0:3]
  ds_read_b64_tr_b16 v[176:177], v234 offset:0
  ds_read_b64_tr_b16 v[178:179], v234 offset:2048
  v_mfma_f32_16x16x32_bf16 a[0:3], v[188:191], v[76:79], a[0:3]
  ds_read_b64_tr_b16 v[180:181], v234 offset:4096
  ds_read_b64_tr_b16 v[182:183], v234 offset:6144
  v_mfma_f32_16x16x32_bf16 a[4:7], v[184:187], v[60:63], a[4:7]
  s_add_u32 s67, s69, 110592
  s_add_u32 s79, s79, s56
  v_mfma_f32_16x16x32_bf16 a[4:7], v[188:191], v[80:83], a[4:7]
  buffer_load_dwordx4 v1, s[48:51], s67 offen offset:0 lds
  s_mulk_i32 s79, 2560
  v_mfma_f32_16x16x32_bf16 a[8:11], v[184:187], v[64:67], a[8:11]
  s_cmp_eq_u32 s68, 0
  s_cselect_b32 s79, 0x40000000, s79
  v_mfma_f32_16x16x32_bf16 a[8:11], v[188:191], v[84:87], a[8:11]
  v_mfma_f32_16x16x32_bf16 a[12:15], v[184:187], v[68:71], a[12:15]
  buffer_load_dwordx4 v2, s[48:51], s67 offen offset:1024 lds
  v_mfma_f32_16x16x32_bf16 a[12:15], v[188:191], v[88:91], a[12:15]
  v_mfma_f32_16x16x32_bf16 a[16:19], v[184:187], v[72:75], a[16:19]
  v_mfma_f32_16x16x32_bf16 a[16:19], v[188:191], v[92:95], a[16:19]
  s_waitcnt lgkmcnt(8)
  buffer_load_dwordx4 v3, s[48:51], s67 offen offset:2048 lds
  v_mfma_f32_16x16x32_bf16 a[0:3], v[192:195], v[96:99], a[0:3]
  ds_read_b64_tr_b16 v[184:185], v234 offset:8192
  ds_read_b64_tr_b16 v[186:187], v234 offset:10240
  v_mfma_f32_16x16x32_bf16 a[0:3], v[196:199], v[116:119], a[0:3]
  ds_read_b64_tr_b16 v[188:189], v234 offset:12288
  ds_read_b64_tr_b16 v[190:191], v234 offset:14336
  v_mfma_f32_16x16x32_bf16 a[4:7], v[192:195], v[100:103], a[4:7]
  buffer_load_dwordx4 v4, s[48:51], s67 offen offset:3072 lds
  v_mfma_f32_16x16x32_bf16 a[4:7], v[196:199], v[120:123], a[4:7]
  v_mfma_f32_16x16x32_bf16 a[8:11], v[192:195], v[104:107], a[8:11]
  v_mfma_f32_16x16x32_bf16 a[8:11], v[196:199], v[124:127], a[8:11]
  v_accvgpr_read_b32 v208, a20
  v_accvgpr_read_b32 v209, a21
  v_mfma_f32_16x16x32_bf16 a[12:15], v[192:195], v[108:111], a[12:15]
  v_accvgpr_read_b32 v210, a22
  v_accvgpr_read_b32 v211, a23
  v_mfma_f32_16x16x32_bf16 a[12:15], v[196:199], v[128:131], a[12:15]
  v_cvt_pk_bf16_f32 v212, v208, v209
  v_mfma_f32_16x16x32_bf16 a[16:19], v[192:195], v[112:115], a[16:19]
  v_cvt_pk_bf16_f32 v213, v210, v211
  s_add_u32 s66, s79, 0
  v_mfma_f32_16x16x32_bf16 a[16:19], v[196:199], v[132:135], a[16:19]
  s_waitcnt lgkmcnt(8)
  buffer_store_dwordx2 v[212:213], v5, s[52:55], s66 offen sc1
  v_mfma_f32_16x16x32_bf16 a[0:3], v[200:203], v[136:139], a[0:3]
  ds_read_b64_tr_b16 v[192:193], v235 offset:0
  ds_read_b64_tr_b16 v[194:195], v235 offset:2048
  v_mfma_f32_16x16x32_bf16 a[0:3], v[204:207], v[156:159], a[0:3]
  ds_read_b64_tr_b16 v[196:197], v235 offset:4096
  ds_read_b64_tr_b16 v[198:199], v235 offset:6144
  v_mfma_f32_16x16x32_bf16 a[4:7], v[200:203], v[140:143], a[4:7]
  v_accvgpr_read_b32 v216, a24
  v_accvgpr_read_b32 v217, a25
  v_mfma_f32_16x16x32_bf16 a[4:7], v[204:207], v[160:163], a[4:7]
  v_accvgpr_read_b32 v218, a26
  v_accvgpr_read_b32 v219, a27
  v_mfma_f32_16x16x32_bf16 a[8:11], v[200:203], v[144:147], a[8:11]
  v_cvt_pk_bf16_f32 v220, v216, v217
  v_cvt_pk_bf16_f32 v221, v218, v219
  v_mfma_f32_16x16x32_bf16 a[8:11], v[204:207], v[164:167], a[8:11]
  s_add_u32 s66, s79, 512
  buffer_store_dwordx2 v[220:221], v5, s[52:55], s66 offen sc1
  v_mfma_f32_16x16x32_bf16 a[12:15], v[200:203], v[148:151], a[12:15]
  v_accvgpr_read_b32 v208, a28
  v_accvgpr_read_b32 v209, a29
  v_mfma_f32_16x16x32_bf16 a[12:15], v[204:207], v[168:171], a[12:15]
  v_accvgpr_read_b32 v210, a30
  v_accvgpr_read_b32 v211, a31
  v_mfma_f32_16x16x32_bf16 a[16:19], v[200:203], v[152:155], a[16:19]
  v_cvt_pk_bf16_f32 v212, v208, v209
  v_cvt_pk_bf16_f32 v213, v210, v211
  v_mfma_f32_16x16x32_bf16 a[16:19], v[204:207], v[172:175], a[16:19]
  s_waitcnt lgkmcnt(8)
  s_add_u32 s66, s79, 1024
  v_mfma_f32_16x16x32_bf16 a[0:3], v[176:179], a[96:99], a[0:3]
  ds_read_b64_tr_b16 v[200:201], v235 offset:8192
  ds_read_b64_tr_b16 v[202:203], v235 offset:10240
  v_mfma_f32_16x16x32_bf16 a[0:3], v[180:183], a[116:119], a[0:3]
  ds_read_b64_tr_b16 v[204:205], v235 offset:12288
  ds_read_b64_tr_b16 v[206:207], v235 offset:14336
  v_mfma_f32_16x16x32_bf16 a[4:7], v[176:179], a[100:103], a[4:7]
  buffer_store_dwordx2 v[212:213], v5, s[52:55], s66 offen sc1
  v_accvgpr_read_b32 v216, a32
  v_mfma_f32_16x16x32_bf16 a[4:7], v[180:183], a[120:123], a[4:7]
  v_accvgpr_read_b32 v217, a33
  v_accvgpr_read_b32 v218, a34
  v_mfma_f32_16x16x32_bf16 a[8:11], v[176:179], a[104:107], a[8:11]
  v_accvgpr_read_b32 v219, a35
  v_cvt_pk_bf16_f32 v220, v216, v217
  v_mfma_f32_16x16x32_bf16 a[8:11], v[180:183], a[124:127], a[8:11]
  v_cvt_pk_bf16_f32 v221, v218, v219
  s_add_u32 s66, s79, 1536
  v_mfma_f32_16x16x32_bf16 a[12:15], v[176:179], a[108:111], a[12:15]
  buffer_store_dwordx2 v[220:221], v5, s[52:55], s66 offen sc1
  v_accvgpr_read_b32 v208, a36
  v_mfma_f32_16x16x32_bf16 a[12:15], v[180:183], a[128:131], a[12:15]
  v_accvgpr_read_b32 v209, a37
  v_accvgpr_read_b32 v210, a38
  v_mfma_f32_16x16x32_bf16 a[16:19], v[176:179], a[112:115], a[16:19]
  v_accvgpr_read_b32 v211, a39
  v_cvt_pk_bf16_f32 v212, v208, v209
  v_cvt_pk_bf16_f32 v213, v210, v211
  s_add_u32 s66, s79, 2048
  buffer_store_dwordx2 v[212:213], v5, s[52:55], s66 offen sc1
  v_mfma_f32_16x16x32_bf16 a[16:19], v[180:183], a[132:135], a[16:19]
  s_waitcnt lgkmcnt(8)
  s_waitcnt vmcnt(5) lgkmcnt(0)
  s_barrier
  v_mfma_f32_16x16x32_bf16 a[0:3], v[184:187], a[136:139], a[0:3]
  ds_read_b64_tr_b16 v[176:177], v236 offset:0
  ds_read_b64_tr_b16 v[178:179], v236 offset:2048
  v_mfma_f32_16x16x32_bf16 a[0:3], v[188:191], a[156:159], a[0:3]
  ds_read_b64_tr_b16 v[180:181], v236 offset:4096
  ds_read_b64_tr_b16 v[182:183], v236 offset:6144
  v_mfma_f32_16x16x32_bf16 a[4:7], v[184:187], a[140:143], a[4:7]
  s_add_u32 s64, s68, 2
  s_mov_b32 s69, s64
  v_mfma_f32_16x16x32_bf16 a[4:7], v[188:191], a[160:163], a[4:7]
  s_add_u32 s69, s69, s98
  s_sub_u32 s65, s69, 9
  v_mfma_f32_16x16x32_bf16 a[8:11], v[184:187], a[144:147], a[8:11]
  s_cmp_ge_u32 s69, 9
  s_cselect_b32 s69, s65, s69
  v_mfma_f32_16x16x32_bf16 a[8:11], v[188:191], a[164:167], a[8:11]
  s_lshl_b32 s69, s69, 7
  v_mfma_f32_16x16x32_bf16 a[12:15], v[184:187], a[148:151], a[12:15]
  s_cmp_lt_u32 s64, 9
  s_cselect_b32 s69, s69, 0x40000000
  v_mfma_f32_16x16x32_bf16 a[12:15], v[188:191], a[168:171], a[12:15]
  v_mfma_f32_16x16x32_bf16 a[16:19], v[184:187], a[152:155], a[16:19]
  v_mfma_f32_16x16x32_bf16 a[16:19], v[188:191], a[172:175], a[16:19]
  s_waitcnt lgkmcnt(8)
  s_add_u32 m0, s71, 0
  v_mfma_f32_16x16x32_bf16 a[0:3], v[192:195], a[176:179], a[0:3]
  ds_read_b64_tr_b16 v[184:185], v236 offset:8192
  ds_read_b64_tr_b16 v[186:187], v236 offset:10240
  v_mfma_f32_16x16x32_bf16 a[0:3], v[196:199], a[196:199], a[0:3]
  ds_read_b64_tr_b16 v[188:189], v236 offset:12288
  ds_read_b64_tr_b16 v[190:191], v236 offset:14336
  v_mfma_f32_16x16x32_bf16 a[4:7], v[192:195], a[180:183], a[4:7]
  s_nop 0
  buffer_load_dwordx4 v1, s[48:51], s69 offen offset:0 lds
  v_mfma_f32_16x16x32_bf16 a[4:7], v[196:199], a[200:203], a[4:7]
  buffer_load_dwordx4 v2, s[48:51], s69 offen offset:1024 lds
  v_mfma_f32_16x16x32_bf16 a[8:11], v[192:195], a[184:187], a[8:11]
  buffer_load_dwordx4 v3, s[48:51], s69 offen offset:2048 lds
  v_mfma_f32_16x16x32_bf16 a[8:11], v[196:199], a[204:207], a[8:11]
  buffer_load_dwordx4 v4, s[48:51], s69 offen offset:3072 lds
  v_mfma_f32_16x16x32_bf16 a[12:15], v[192:195], a[188:191], a[12:15]
  s_add_u32 m0, s71, 4096
  v_mfma_f32_16x16x32_bf16 a[12:15], v[196:199], a[208:211], a[12:15]
  v_mfma_f32_16x16x32_bf16 a[16:19], v[192:195], a[192:195], a[16:19]
  s_add_u32 s67, s69, 36864
  v_mfma_f32_16x16x32_bf16 a[16:19], v[196:199], a[212:215], a[16:19]
  s_waitcnt lgkmcnt(8)
  buffer_load_dwordx4 v1, s[48:51], s67 offen offset:0 lds
  v_mfma_f32_16x16x32_bf16 a[0:3], v[200:203], a[216:219], a[0:3]
  ds_read_b64_tr_b16 v[192:193], v237 offset:0
  ds_read_b64_tr_b16 v[194:195], v237 offset:2048
  v_mfma_f32_16x16x32_bf16 a[0:3], v[204:207], a[236:239], a[0:3]
  ds_read_b64_tr_b16 v[196:197], v237 offset:4096
  ds_read_b64_tr_b16 v[198:199], v237 offset:6144
  v_mfma_f32_16x16x32_bf16 a[4:7], v[200:203], a[220:223], a[4:7]
  buffer_load_dwordx4 v2, s[48:51], s67 offen offset:1024 lds
  buffer_load_dwordx4 v3, s[48:51], s67 offen offset:2048 lds
  v_mfma_f32_16x16x32_bf16 a[4:7], v[204:207], a[240:243], a[4:7]
  buffer_load_dwordx4 v4, s[48:51], s67 offen offset:3072 lds
  v_mfma_f32_16x16x32_bf16 a[8:11], v[200:203], a[224:227], a[8:11]
  s_add_u32 m0, s71, 8192
  v_mfma_f32_16x16x32_bf16 a[8:11], v[204:207], a[244:247], a[8:11]
  v_mfma_f32_16x16x32_bf16 a[12:15], v[200:203], a[228:231], a[12:15]
  s_add_u32 s67, s69, 73728
  v_mfma_f32_16x16x32_bf16 a[12:15], v[204:207], a[248:251], a[12:15]
  buffer_load_dwordx4 v1, s[48:51], s67 offen offset:0 lds
  v_mfma_f32_16x16x32_bf16 a[16:19], v[200:203], a[232:235], a[16:19]
  buffer_load_dwordx4 v2, s[48:51], s67 offen offset:1024 lds
  v_mfma_f32_16x16x32_bf16 a[16:19], v[204:207], a[252:255], a[16:19]
  ds_read_b64_tr_b16 v[200:201], v237 offset:8192
  ds_read_b64_tr_b16 v[202:203], v237 offset:10240
  ds_read_b64_tr_b16 v[204:205], v237 offset:12288
  ds_read_b64_tr_b16 v[206:207], v237 offset:14336
  s_cmp_eq_u32 s68, 8
  s_cbranch_scc1 K1_P3DONE
  s_waitcnt lgkmcnt(8)
  v_mfma_f32_16x16x32_bf16 a[20:23], v[176:179], v[16:19], 0
  v_mfma_f32_16x16x32_bf16 a[20:23], v[180:183], v[36:39], a[20:23]
  v_mfma_f32_16x16x32_bf16 a[24:27], v[176:179], v[20:23], 0
  buffer_load_dwordx4 v3, s[48:51], s67 offen offset:2048 lds
  s_add_u32 s79, s68, 9
  v_mfma_f32_16x16x32_bf16 a[24:27], v[180:183], v[40:43], a[24:27]
  s_add_u32 s79, s79, s98
  s_sub_u32 s65, s79, 9
  v_mfma_f32_16x16x32_bf16 a[28:31], v[176:179], v[24:27], 0
  buffer_load_dwordx4 v4, s[48:51], s67 offen offset:3072 lds
  v_mfma_f32_16x16x32_bf16 a[28:31], v[180:183], v[44:47], a[28:31]
  s_cmp_ge_u32 s79, 9
  s_cselect_b32 s79, s65, s79
  v_mfma_f32_16x16x32_bf16 a[32:35], v[176:179], v[28:31], 0
  s_sub_u32 s65, s79, 9
  v_mfma_f32_16x16x32_bf16 a[32:35], v[180:183], v[48:51], a[32:35]
  s_add_u32 m0, s71, 12288
  v_mfma_f32_16x16x32_bf16 a[36:39], v[176:179], v[32:35], 0
  s_cmp_ge_u32 s79, 9
  s_cselect_b32 s79, s65, s79
  v_mfma_f32_16x16x32_bf16 a[36:39], v[180:183], v[52:55], a[36:39]
  s_waitcnt lgkmcnt(8)
  s_lshl_b32 s79, s79, 2
  v_mfma_f32_16x16x32_bf16 a[20:23], v[184:187], v[56:59], a[20:23]
  ds_read_b64_tr_b16 v[176:177], v238 offset:0
  ds_read_b64_tr_b16 v[178:179], v238 offset:2048
  v_mfma_f32_16x16x32_bf16 a[20:23], v[188:191], v[76:79], a[20:23]
  ds_read_b64_tr_b16 v[180:181], v238 offset:4096
  ds_read_b64_tr_b16 v[182:183], v238 offset:6144
  v_mfma_f32_16x16x32_bf16 a[24:27], v[184:187], v[60:63], a[24:27]
  s_add_u32 s67, s69, 110592
  s_add_u32 s79, s79, s56
  v_mfma_f32_16x16x32_bf16 a[24:27], v[188:191], v[80:83], a[24:27]
  buffer_load_dwordx4 v1, s[48:51], s67 offen offset:0 lds
  s_mulk_i32 s79, 2560
  v_mfma_f32_16x16x32_bf16 a[28:31], v[184:187], v[64:67], a[28:31]
  v_mfma_f32_16x16x32_bf16 a[28:31], v[188:191], v[84:87], a[28:31]
  v_mfma_f32_16x16x32_bf16 a[32:35], v[184:187], v[68:71], a[32:35]
  buffer_load_dwordx4 v2, s[48:51], s67 offen offset:1024 lds
  v_mfma_f32_16x16x32_bf16 a[32:35], v[188:191], v[88:91], a[32:35]
  v_mfma_f32_16x16x32_bf16 a[36:39], v[184:187], v[72:75], a[36:39]
  v_mfma_f32_16x16x32_bf16 a[36:39], v[188:191], v[92:95], a[36:39]
  s_waitcnt lgkmcnt(8)
  buffer_load_dwordx4 v3, s[48:51], s67 offen offset:2048 lds
  v_mfma_f32_16x16x32_bf16 a[20:23], v[192:195], v[96:99], a[20:23]
  ds_read_b64_tr_b16 v[184:185], v238 offset:8192
  ds_read_b64_tr_b16 v[186:187], v238 offset:10240
  v_mfma_f32_16x16x32_bf16 a[20:23], v[196:199], v[116:119], a[20:23]
  ds_read_b64_tr_b16 v[188:189], v238 offset:12288
  ds_read_b64_tr_b16 v[190:191], v238 offset:14336
  v_mfma_f32_16x16x32_bf16 a[24:27], v[192:195], v[100:103], a[24:27]
  buffer_load_dwordx4 v4, s[48:51], s67 offen offset:3072 lds
  v_mfma_f32_16x16x32_bf16 a[24:27], v[196:199], v[120:123], a[24:27]
  v_mfma_f32_16x16x32_bf16 a[28:31], v[192:195], v[104:107], a[28:31]
  v_mfma_f32_16x16x32_bf16 a[28:31], v[196:199], v[124:127], a[28:31]
  v_accvgpr_read_b32 v208, a0
  v_accvgpr_read_b32 v209, a1
  v_mfma_f32_16x16x32_bf16 a[32:35], v[192:195], v[108:111], a[32:35]
  v_accvgpr_read_b32 v210, a2
  v_accvgpr_read_b32 v211, a3
  v_mfma_f32_16x16x32_bf16 a[32:35], v[196:199], v[128:131], a[32:35]
  v_cvt_pk_bf16_f32 v212, v208, v209
  v_mfma_f32_16x16x32_bf16 a[36:39], v[192:195], v[112:115], a[36:39]
  v_cvt_pk_bf16_f32 v213, v210, v211
  s_add_u32 s66, s79, 0
  v_mfma_f32_16x16x32_bf16 a[36:39], v[196:199], v[132:135], a[36:39]
  s_waitcnt lgkmcnt(8)
  buffer_store_dwordx2 v[212:213], v5, s[52:55], s66 offen sc1
  v_mfma_f32_16x16x32_bf16 a[20:23], v[200:203], v[136:139], a[20:23]
  ds_read_b64_tr_b16 v[192:193], v239 offset:0
  ds_read_b64_tr_b16 v[194:195], v239 offset:2048
  v_mfma_f32_16x16x32_bf16 a[20:23], v[204:207], v[156:159], a[20:23]
  ds_read_b64_tr_b16 v[196:197], v239 offset:4096
  ds_read_b64_tr_b16 v[198:199], v239 offset:6144
  v_mfma_f32_16x16x32_bf16 a[24:27], v[200:203], v[140:143], a[24:27]
  v_accvgpr_read_b32 v216, a4
  v_accvgpr_read_b32 v217, a5
  v_mfma_f32_16x16x32_bf16 a[24:27], v[204:207], v[160:163], a[24:27]
  v_accvgpr_read_b32 v218, a6
  v_accvgpr_read_b32 v219, a7
  v_mfma_f32_16x16x32_bf16 a[28:31], v[200:203], v[144:147], a[28:31]
  v_cvt_pk_bf16_f32 v220, v216, v217
  v_cvt_pk_bf16_f32 v221, v218, v219
  v_mfma_f32_16x16x32_bf16 a[28:31], v[204:207], v[164:167], a[28:31]
  s_add_u32 s66, s79, 512
  buffer_store_dwordx2 v[220:221], v5, s[52:55], s66 offen sc1
  v_mfma_f32_16x16x32_bf16 a[32:35], v[200:203], v[148:151], a[32:35]
  v_accvgpr_read_b32 v208, a8
  v_accvgpr_read_b32 v209, a9
  v_mfma_f32_16x16x32_bf16 a[32:35], v[204:207], v[168:171], a[32:35]
  v_accvgpr_read_b32 v210, a10
  v_accvgpr_read_b32 v211, a11
  v_mfma_f32_16x16x32_bf16 a[36:39], v[200:203], v[152:155], a[36:39]
  v_cvt_pk_bf16_f32 v212, v208, v209
  v_cvt_pk_bf16_f32 v213, v210, v211
  v_mfma_f32_16x16x32_bf16 a[36:39], v[204:207], v[172:175], a[36:39]
  s_waitcnt lgkmcnt(8)
  s_add_u32 s66, s79, 1024
  v_mfma_f32_16x16x32_bf16 a[20:23], v[176:179], a[96:99], a[20:23]
  ds_read_b64_tr_b16 v[200:201], v239 offset:8192
  ds_read_b64_tr_b16 v[202:203], v239 offset:10240
  v_mfma_f32_16x16x32_bf16 a[20:23], v[180:183], a[116:119], a[20:23]
  ds_read_b64_tr_b16 v[204:205], v239 offset:12288
  ds_read_b64_tr_b16 v[206:207], v239 offset:14336
  v_mfma_f32_16x16x32_bf16 a[24:27], v[176:179], a[100:103], a[24:27]
  buffer_store_dwordx2 v[212:213], v5, s[52:55], s66 offen sc1
  v_accvgpr_read_b32 v216, a12
  v_mfma_f32_16x16x32_bf16 a[24:27], v[180:183], a[120:123], a[24:27]
  v_accvgpr_read_b32 v217, a13
  v_accvgpr_read_b32 v218, a14
  v_mfma_f32_16x16x32_bf16 a[28:31], v[176:179], a[104:107], a[28:31]
  v_accvgpr_read_b32 v219, a15
  v_cvt_pk_bf16_f32 v220, v216, v217
  v_mfma_f32_16x16x32_bf16 a[28:31], v[180:183], a[124:127], a[28:31]
  v_cvt_pk_bf16_f32 v221, v218, v219
  s_add_u32 s66, s79, 1536
  v_mfma_f32_16x16x32_bf16 a[32:35], v[176:179], a[108:111], a[32:35]
  buffer_store_dwordx2 v[220:221], v5, s[52:55], s66 offen sc1
  v_accvgpr_read_b32 v208, a16
  v_mfma_f32_16x16x32_bf16 a[32:35], v[180:183], a[128:131], a[32:35]
  v_accvgpr_read_b32 v209, a17
  v_accvgpr_read_b32 v210, a18
  v_mfma_f32_16x16x32_bf16 a[36:39], v[176:179], a[112:115], a[36:39]
  v_accvgpr_read_b32 v211, a19
  v_cvt_pk_bf16_f32 v212, v208, v209
  v_cvt_pk_bf16_f32 v213, v210, v211
  s_add_u32 s66, s79, 2048
  buffer_store_dwordx2 v[212:213], v5, s[52:55], s66 offen sc1
  v_mfma_f32_16x16x32_bf16 a[36:39], v[180:183], a[132:135], a[36:39]
  s_waitcnt lgkmcnt(8)
  s_waitcnt vmcnt(5) lgkmcnt(0)
  s_barrier
  v_mfma_f32_16x16x32_bf16 a[20:23], v[184:187], a[136:139], a[20:23]
  ds_read_b64_tr_b16 v[176:177], v232 offset:0
  ds_read_b64_tr_b16 v[178:179], v232 offset:2048
  v_mfma_f32_16x16x32_bf16 a[20:23], v[188:191], a[156:159], a[20:23]
  ds_read_b64_tr_b16 v[180:181], v232 offset:4096
  ds_read_b64_tr_b16 v[182:183], v232 offset:6144
  v_mfma_f32_16x16x32_bf16 a[24:27], v[184:187], a[140:143], a[24:27]
  s_add_u32 s64, s68, 3
  s_mov_b32 s69, s64
  v_mfma_f32_16x16x32_bf16 a[24:27], v[188:191], a[160:163], a[24:27]
  s_add_u32 s69, s69, s98
  s_sub_u32 s65, s69, 9
  v_mfma_f32_16x16x32_bf16 a[28:31], v[184:187], a[144:147], a[28:31]
  s_cmp_ge_u32 s69, 9
  s_cselect_b32 s69, s65, s69
  v_mfma_f32_16x16x32_bf16 a[28:31], v[188:191], a[164:167], a[28:31]
  s_lshl_b32 s69, s69, 7
  v_mfma_f32_16x16x32_bf16 a[32:35], v[184:187], a[148:151], a[32:35]
  s_cmp_lt_u32 s64, 9
  s_cselect_b32 s69, s69, 0x40000000
  v_mfma_f32_16x16x32_bf16 a[32:35], v[188:191], a[168:171], a[32:35]
  v_mfma_f32_16x16x32_bf16 a[36:39], v[184:187], a[152:155], a[36:39]
  v_mfma_f32_16x16x32_bf16 a[36:39], v[188:191], a[172:175], a[36:39]
  s_waitcnt lgkmcnt(8)
  s_add_u32 m0, s72, 0
  v_mfma_f32_16x16x32_bf16 a[20:23], v[192:195], a[176:179], a[20:23]
  ds_read_b64_tr_b16 v[184:185], v232 offset:8192
  ds_read_b64_tr_b16 v[186:187], v232 offset:10240
  v_mfma_f32_16x16x32_bf16 a[20:23], v[196:199], a[196:199], a[20:23]
  ds_read_b64_tr_b16 v[188:189], v232 offset:12288
  ds_read_b64_tr_b16 v[190:191], v232 offset:14336
  v_mfma_f32_16x16x32_bf16 a[24:27], v[192:195], a[180:183], a[24:27]
  s_nop 0
  buffer_load_dwordx4 v1, s[48:51], s69 offen offset:0 lds
  v_mfma_f32_16x16x32_bf16 a[24:27], v[196:199], a[200:203], a[24:27]
  buffer_load_dwordx4 v2, s[48:51], s69 offen offset:1024 lds
  v_mfma_f32_16x16x32_bf16 a[28:31], v[192:195], a[184:187], a[28:31]
  buffer_load_dwordx4 v3, s[48:51], s69 offen offset:2048 lds
  v_mfma_f32_16x16x32_bf16 a[28:31], v[196:199], a[204:207], a[28:31]
  buffer_load_dwordx4 v4, s[48:51], s69 offen offset:3072 lds
  v_mfma_f32_16x16x32_bf16 a[32:35], v[192:195], a[188:191], a[32:35]
  s_add_u32 m0, s72, 4096
  v_mfma_f32_16x16x32_bf16 a[32:35], v[196:199], a[208:211], a[32:35]
  v_mfma_f32_16x16x32_bf16 a[36:39], v[192:195], a[192:195], a[36:39]
  s_add_u32 s67, s69, 36864
  v_mfma_f32_16x16x32_bf16 a[36:39], v[196:199], a[212:215], a[36:39]
  s_waitcnt lgkmcnt(8)
  buffer_load_dwordx4 v1, s[48:51], s67 offen offset:0 lds
  v_mfma_f32_16x16x32_bf16 a[20:23], v[200:203], a[216:219], a[20:23]
  ds_read_b64_tr_b16 v[192:193], v233 offset:0
  ds_read_b64_tr_b16 v[194:195], v233 offset:2048
  v_mfma_f32_16x16x32_bf16 a[20:23], v[204:207], a[236:239], a[20:23]
  ds_read_b64_tr_b16 v[196:197], v233 offset:4096
  ds_read_b64_tr_b16 v[198:199], v233 offset:6144
  v_mfma_f32_16x16x32_bf16 a[24:27], v[200:203], a[220:223], a[24:27]
  buffer_load_dwordx4 v2, s[48:51], s67 offen offset:1024 lds
  buffer_load_dwordx4 v3, s[48:51], s67 offen offset:2048 lds
  v_mfma_f32_16x16x32_bf16 a[24:27], v[204:207], a[240:243], a[24:27]
  buffer_load_dwordx4 v4, s[48:51], s67 offen offset:3072 lds
  v_mfma_f32_16x16x32_bf16 a[28:31], v[200:203], a[224:227], a[28:31]
  s_add_u32 m0, s72, 8192
  v_mfma_f32_16x16x32_bf16 a[28:31], v[204:207], a[244:247], a[28:31]
  v_mfma_f32_16x16x32_bf16 a[32:35], v[200:203], a[228:231], a[32:35]
  s_add_u32 s67, s69, 73728
  v_mfma_f32_16x16x32_bf16 a[32:35], v[204:207], a[248:251], a[32:35]
  buffer_load_dwordx4 v1, s[48:51], s67 offen offset:0 lds
  v_mfma_f32_16x16x32_bf16 a[36:39], v[200:203], a[232:235], a[36:39]
  buffer_load_dwordx4 v2, s[48:51], s67 offen offset:1024 lds
  v_mfma_f32_16x16x32_bf16 a[36:39], v[204:207], a[252:255], a[36:39]
  ds_read_b64_tr_b16 v[200:201], v233 offset:8192
  ds_read_b64_tr_b16 v[202:203], v233 offset:10240
  ds_read_b64_tr_b16 v[204:205], v233 offset:12288
  ds_read_b64_tr_b16 v[206:207], v233 offset:14336
  s_add_u32 s68, s68, 2
  s_branch K1_P3LOOP
K1_P3DONE:
  s_nop 7
  s_nop 1
  s_mov_b32 s79, 8
  s_add_u32 s79, s79, s98
  s_sub_u32 s65, s79, 9
  s_cmp_ge_u32 s79, 9
  s_cselect_b32 s79, s65, s79
  s_lshl_b32 s79, s79, 2
  s_add_u32 s79, s79, s56
  s_mulk_i32 s79, 2560
  v_accvgpr_read_b32 v208, a0
  v_accvgpr_read_b32 v209, a1
  v_accvgpr_read_b32 v210, a2
  v_accvgpr_read_b32 v211, a3
  v_cvt_pk_bf16_f32 v212, v208, v209
  v_cvt_pk_bf16_f32 v213, v210, v211
  s_add_u32 s66, s79, 0
  buffer_store_dwordx2 v[212:213], v5, s[52:55], s66 offen sc1
  v_accvgpr_read_b32 v216, a4
  v_accvgpr_read_b32 v217, a5
  v_accvgpr_read_b32 v218, a6
  v_accvgpr_read_b32 v219, a7
  v_cvt_pk_bf16_f32 v220, v216, v217
  v_cvt_pk_bf16_f32 v221, v218, v219
  s_add_u32 s66, s79, 512
  buffer_store_dwordx2 v[220:221], v5, s[52:55], s66 offen sc1
  v_accvgpr_read_b32 v208, a8
  v_accvgpr_read_b32 v209, a9
  v_accvgpr_read_b32 v210, a10
  v_accvgpr_read_b32 v211, a11
  v_cvt_pk_bf16_f32 v212, v208, v209
  v_cvt_pk_bf16_f32 v213, v210, v211
  s_add_u32 s66, s79, 1024
  buffer_store_dwordx2 v[212:213], v5, s[52:55], s66 offen sc1
  v_accvgpr_read_b32 v216, a12
  v_accvgpr_read_b32 v217, a13
  v_accvgpr_read_b32 v218, a14
  v_accvgpr_read_b32 v219, a15
  v_cvt_pk_bf16_f32 v220, v216, v217
  v_cvt_pk_bf16_f32 v221, v218, v219
  s_add_u32 s66, s79, 1536
  buffer_store_dwordx2 v[220:221], v5, s[52:55], s66 offen sc1
  v_accvgpr_read_b32 v208, a16
  v_accvgpr_read_b32 v209, a17
  v_accvgpr_read_b32 v210, a18
  v_accvgpr_read_b32 v211, a19
  v_cvt_pk_bf16_f32 v212, v208, v209
  v_cvt_pk_bf16_f32 v213, v210, v211
  s_add_u32 s66, s79, 2048
  buffer_store_dwordx2 v[212:213], v5, s[52:55], s66 offen sc1
K1_END:
  s_endpgm
K1_FALLBACK:
  s_waitcnt vmcnt(0) lgkmcnt(0)
  s_cmp_lg_u32 s57, 0
  s_cbranch_scc1 K1_FB_RING
  s_lshr_b32 s64, s56, 1
  s_lshl_b32 s64, s64, 15
  s_mul_i32 s65, s59, 98304
  s_add_u32 s62, s64, s65
K1_FB_RING:
  v_add_u32 v13, 0, v9
  v_xor_b32 v13, v13, v10
  v_lshlrev_b32 v13, 4, v13
  v_lshl_add_u32 v13, v10, 8, v13
  v_add_u32 v228, s62, v13
  v_add_u32 v13, 4, v9
  v_xor_b32 v13, v13, v10
  v_lshlrev_b32 v13, 4, v13
  v_lshl_add_u32 v13, v10, 8, v13
  v_add_u32 v229, s62, v13
  v_add_u32 v13, 8, v9
  v_xor_b32 v13, v13, v10
  v_lshlrev_b32 v13, 4, v13
  v_lshl_add_u32 v13, v10, 8, v13
  v_add_u32 v230, s62, v13
  v_add_u32 v13, 12, v9
  v_xor_b32 v13, v13, v10
  v_lshlrev_b32 v13, 4, v13
  v_lshl_add_u32 v13, v10, 8, v13
  v_add_u32 v231, s62, v13
  v_lshl_add_u32 v14, v9, 2, v11
  v_and_b32 v15, 7, v14
  v_lshlrev_b32 v14, 8, v14
  v_lshl_add_u32 v14, v12, 3, v14
  v_add_u32 v14, s62, v14
  v_xor_b32 v13, 0, v15
  v_lshl_add_u32 v232, v13, 5, v14
  v_xor_b32 v13, 1, v15
  v_lshl_add_u32 v233, v13, 5, v14
  v_xor_b32 v13, 2, v15
  v_lshl_add_u32 v234, v13, 5, v14
  v_xor_b32 v13, 3, v15
  v_lshl_add_u32 v235, v13, 5, v14
  v_xor_b32 v13, 4, v15
  v_lshl_add_u32 v236, v13, 5, v14
  v_xor_b32 v13, 5, v15
  v_lshl_add_u32 v237, v13, 5, v14
  v_xor_b32 v13, 6, v15
  v_lshl_add_u32 v238, v13, 5, v14
  v_xor_b32 v13, 7, v15
  v_lshl_add_u32 v239, v13, 5, v14
  v_mov_b32 v176, 0xff800000
  v_mov_b32 v177, 0xff800000
  v_mov_b32 v178, 0xff800000
  v_mov_b32 v179, 0xff800000
  v_mov_b32 v180, 0xff800000
  s_mov_b32 s74, 0
K1_FB_LOOP:
  s_add_u32 m0, s62, 0
  s_nop 0
  buffer_load_dwordx4 v246, s[32:35], s74 offen offset:0 nt lds
  buffer_load_dwordx4 v247, s[32:35], s74 offen offset:1024 nt lds
  buffer_load_dwordx4 v248, s[32:35], s74 offen offset:2048 nt lds
  buffer_load_dwordx4 v249, s[32:35], s74 offen offset:3072 nt lds
  s_add_u32 m0, s62, 4096
  s_add_u32 s64, s74, 4096
  buffer_load_dwordx4 v246, s[32:35], s64 offen offset:0 nt lds
  buffer_load_dwordx4 v247, s[32:35], s64 offen offset:1024 nt lds
  buffer_load_dwordx4 v248, s[32:35], s64 offen offset:2048 nt lds
  buffer_load_dwordx4 v249, s[32:35], s64 offen offset:3072 nt lds
  s_waitcnt vmcnt(0)
  ds_read_b128 v[144:147], v228 offset:0
  ds_read_b128 v[148:151], v229 offset:0
  ds_read_b128 v[152:155], v230 offset:0
  ds_read_b128 v[156:159], v231 offset:0
  ds_read_b128 v[160:163], v228 offset:4096
  ds_read_b128 v[164:167], v229 offset:4096
  ds_read_b128 v[168:171], v230 offset:4096
  ds_read_b128 v[172:175], v231 offset:4096
  s_waitcnt lgkmcnt(0)
  v_mfma_f32_16x16x32_bf16 v[96:99], v[144:147], v[16:19], 0
  v_mfma_f32_16x16x32_bf16 v[96:99], v[148:151], v[20:23], v[96:99]
  v_mfma_f32_16x16x32_bf16 v[96:99], v[152:155], v[24:27], v[96:99]
  v_mfma_f32_16x16x32_bf16 v[96:99], v[156:159], v[28:31], v[96:99]
  v_mfma_f32_16x16x32_bf16 v[100:103], v[160:163], v[16:19], 0
  v_mfma_f32_16x16x32_bf16 v[100:103], v[164:167], v[20:23], v[100:103]
  v_mfma_f32_16x16x32_bf16 v[100:103], v[168:171], v[24:27], v[100:103]
  v_mfma_f32_16x16x32_bf16 v[100:103], v[172:175], v[28:31], v[100:103]
  v_mfma_f32_16x16x32_bf16 v[104:107], v[144:147], v[32:35], 0
  v_mfma_f32_16x16x32_bf16 v[104:107], v[148:151], v[36:39], v[104:107]
  v_mfma_f32_16x16x32_bf16 v[104:107], v[152:155], v[40:43], v[104:107]
  v_mfma_f32_16x16x32_bf16 v[104:107], v[156:159], v[44:47], v[104:107]
  v_mfma_f32_16x16x32_bf16 v[108:111], v[160:163], v[32:35], 0
  v_mfma_f32_16x16x32_bf16 v[108:111], v[164:167], v[36:39], v[108:111]
  v_mfma_f32_16x16x32_bf16 v[108:111], v[168:171], v[40:43], v[108:111]
  v_mfma_f32_16x16x32_bf16 v[108:111], v[172:175], v[44:47], v[108:111]
  v_mfma_f32_16x16x32_bf16 v[112:115], v[144:147], v[48:51], 0
  v_mfma_f32_16x16x32_bf16 v[112:115], v[148:151], v[52:55], v[112:115]
  v_mfma_f32_16x16x32_bf16 v[112:115], v[152:155], v[56:59], v[112:115]
  v_mfma_f32_16x16x32_bf16 v[112:115], v[156:159], v[60:63], v[112:115]
  v_mfma_f32_16x16x32_bf16 v[116:119], v[160:163], v[48:51], 0
  v_mfma_f32_16x16x32_bf16 v[116:119], v[164:167], v[52:55], v[116:119]
  v_mfma_f32_16x16x32_bf16 v[116:119], v[168:171], v[56:59], v[116:119]
  v_mfma_f32_16x16x32_bf16 v[116:119], v[172:175], v[60:63], v[116:119]
  v_mfma_f32_16x16x32_bf16 v[120:123], v[144:147], v[64:67], 0
  v_mfma_f32_16x16x32_bf16 v[120:123], v[148:151], v[68:71], v[120:123]
  v_mfma_f32_16x16x32_bf16 v[120:123], v[152:155], v[72:75], v[120:123]
  v_mfma_f32_16x16x32_bf16 v[120:123], v[156:159], v[76:79], v[120:123]
  v_mfma_f32_16x16x32_bf16 v[124:127], v[160:163], v[64:67], 0
  v_mfma_f32_16x16x32_bf16 v[124:127], v[164:167], v[68:71], v[124:127]
  v_mfma_f32_16x16x32_bf16 v[124:127], v[168:171], v[72:75], v[124:127]
  v_mfma_f32_16x16x32_bf16 v[124:127], v[172:175], v[76:79], v[124:127]
  v_mfma_f32_16x16x32_bf16 v[128:131], v[144:147], v[80:83], 0
  v_mfma_f32_16x16x32_bf16 v[128:131], v[148:151], v[84:87], v[128:131]
  v_mfma_f32_16x16x32_bf16 v[128:131], v[152:155], v[88:91], v[128:131]
  v_mfma_f32_16x16x32_bf16 v[128:131], v[156:159], v[92:95], v[128:131]
  v_mfma_f32_16x16x32_bf16 v[132:135], v[160:163], v[80:83], 0
  v_mfma_f32_16x16x32_bf16 v[132:135], v[164:167], v[84:87], v[132:135]
  v_mfma_f32_16x16x32_bf16 v[132:135], v[168:171], v[88:91], v[132:135]
  v_mfma_f32_16x16x32_bf16 v[132:135], v[172:175], v[92:95], v[132:135]
  s_nop 7
  s_nop 1
  v_max3_f32 v176, v176, v96, v97
  v_max3_f32 v176, v176, v98, v99
  v_max3_f32 v176, v176, v100, v101
  v_max3_f32 v176, v176, v102, v103
  v_max3_f32 v177, v177, v104, v105
  v_max3_f32 v177, v177, v106, v107
  v_max3_f32 v177, v177, v108, v109
  v_max3_f32 v177, v177, v110, v111
  v_max3_f32 v178, v178, v112, v113
  v_max3_f32 v178, v178, v114, v115
  v_max3_f32 v178, v178, v116, v117
  v_max3_f32 v178, v178, v118, v119
  v_max3_f32 v179, v179, v120, v121
  v_max3_f32 v179, v179, v122, v123
  v_max3_f32 v179, v179, v124, v125
  v_max3_f32 v179, v179, v126, v127
  v_max3_f32 v180, v180, v128, v129
  v_max3_f32 v180, v180, v130, v131
  v_max3_f32 v180, v180, v132, v133
  v_max3_f32 v180, v180, v134, v135
  s_add_u32 s74, s74, 8192
  s_cmp_lt_u32 s74, 131072
  s_cbranch_scc1 K1_FB_LOOP
  v_mov_b32 v13, v176
  v_mov_b32 v14, v13
  s_nop 1
  v_permlane32_swap_b32 v13, v14
  s_nop 1
  v_max_f32 v13, v13, v14
  v_mov_b32 v14, v13
  s_nop 1
  v_permlane16_swap_b32 v13, v14
  s_nop 1
  v_max_f32 v13, v13, v14
  v_sub_f32 v208, 0, v13
  v_sub_f32 v209, 0, v13
  v_sub_f32 v210, 0, v13
  v_sub_f32 v211, 0, v13
  v_mov_b32 v13, v177
  v_mov_b32 v14, v13
  s_nop 1
  v_permlane32_swap_b32 v13, v14
  s_nop 1
  v_max_f32 v13, v13, v14
  v_mov_b32 v14, v13
  s_nop 1
  v_permlane16_swap_b32 v13, v14
  s_nop 1
  v_max_f32 v13, v13, v14
  v_sub_f32 v212, 0, v13
  v_sub_f32 v213, 0, v13
  v_sub_f32 v214, 0, v13
  v_sub_f32 v215, 0, v13
  v_mov_b32 v13, v178
  v_mov_b32 v14, v13
  s_nop 1
  v_permlane32_swap_b32 v13, v14
  s_nop 1
  v_max_f32 v13, v13, v14
  v_mov_b32 v14, v13
  s_nop 1
  v_permlane16_swap_b32 v13, v14
  s_nop 1
  v_max_f32 v13, v13, v14
  v_sub_f32 v216, 0, v13
  v_sub_f32 v217, 0, v13
  v_sub_f32 v218, 0, v13
  v_sub_f32 v219, 0, v13
  v_mov_b32 v13, v179
  v_mov_b32 v14, v13
  s_nop 1
  v_permlane32_swap_b32 v13, v14
  s_nop 1
  v_max_f32 v13, v13, v14
  v_mov_b32 v14, v13
  s_nop 1
  v_permlane16_swap_b32 v13, v14
  s_nop 1
  v_max_f32 v13, v13, v14
  v_sub_f32 v220, 0, v13
  v_sub_f32 v221, 0, v13
  v_sub_f32 v222, 0, v13
  v_sub_f32 v223, 0, v13
  v_mov_b32 v13, v180
  v_mov_b32 v14, v13
  s_nop 1
  v_permlane32_swap_b32 v13, v14
  s_nop 1
  v_max_f32 v13, v13, v14
  v_mov_b32 v14, v13
  s_nop 1
  v_permlane16_swap_b32 v13, v14
  s_nop 1
  v_max_f32 v13, v13, v14
  v_sub_f32 v224, 0, v13
  v_sub_f32 v225, 0, v13
  v_sub_f32 v226, 0, v13
  v_sub_f32 v227, 0, v13
  v_accvgpr_write_b32 a0, 0
  v_accvgpr_write_b32 a1, 0
  v_accvgpr_write_b32 a2, 0
  v_accvgpr_write_b32 a3, 0
  v_accvgpr_write_b32 a4, 0
  v_accvgpr_write_b32 a5, 0
  v_accvgpr_write_b32 a6, 0
  v_accvgpr_write_b32 a7, 0
  v_accvgpr_write_b32 a8, 0
  v_accvgpr_write_b32 a9, 0
  v_accvgpr_write_b32 a10, 0
  v_accvgpr_write_b32 a11, 0
  v_accvgpr_write_b32 a12, 0
  v_accvgpr_write_b32 a13, 0
  v_accvgpr_write_b32 a14, 0
  v_accvgpr_write_b32 a15, 0
  v_accvgpr_write_b32 a16, 0
  v_accvgpr_write_b32 a17, 0
  v_accvgpr_write_b32 a18, 0
  v_accvgpr_write_b32 a19, 0
  v_accvgpr_write_b32 a20, 0
  v_accvgpr_write_b32 a21, 0
  v_accvgpr_write_b32 a22, 0
  v_accvgpr_write_b32 a23, 0
  v_accvgpr_write_b32 a24, 0
  v_accvgpr_write_b32 a25, 0
  v_accvgpr_write_b32 a26, 0
  v_accvgpr_write_b32 a27, 0
  v_accvgpr_write_b32 a28, 0
  v_accvgpr_write_b32 a29, 0
  v_accvgpr_write_b32 a30, 0
  v_accvgpr_write_b32 a31, 0
  v_accvgpr_write_b32 a32, 0
  v_accvgpr_write_b32 a33, 0
  v_accvgpr_write_b32 a34, 0
  v_accvgpr_write_b32 a35, 0
  v_accvgpr_write_b32 a36, 0
  v_accvgpr_write_b32 a37, 0
  v_accvgpr_write_b32 a38, 0
  v_accvgpr_write_b32 a39, 0
  v_accvgpr_write_b32 a40, 0
  v_accvgpr_write_b32 a41, 0
  v_accvgpr_write_b32 a42, 0
  v_accvgpr_write_b32 a43, 0
  v_accvgpr_write_b32 a44, 0
  v_accvgpr_write_b32 a45, 0
  v_accvgpr_write_b32 a46, 0
  v_accvgpr_write_b32 a47, 0
  v_accvgpr_write_b32 a48, 0
  v_accvgpr_write_b32 a49, 0
  v_accvgpr_write_b32 a50, 0
  v_accvgpr_write_b32 a51, 0
  v_accvgpr_write_b32 a52, 0
  v_accvgpr_write_b32 a53, 0
  v_accvgpr_write_b32 a54, 0
  v_accvgpr_write_b32 a55, 0
  v_accvgpr_write_b32 a56, 0
  v_accvgpr_write_b32 a57, 0
  v_accvgpr_write_b32 a58, 0
  v_accvgpr_write_b32 a59, 0
  v_accvgpr_write_b32 a60, 0
  v_accvgpr_write_b32 a61, 0
  v_accvgpr_write_b32 a62, 0
  v_accvgpr_write_b32 a63, 0
  v_accvgpr_write_b32 a64, 0
  v_accvgpr_write_b32 a65, 0
  v_accvgpr_write_b32 a66, 0
  v_accvgpr_write_b32 a67, 0
  v_accvgpr_write_b32 a68, 0
  v_accvgpr_write_b32 a69, 0
  v_accvgpr_write_b32 a70, 0
  v_accvgpr_write_b32 a71, 0
  v_accvgpr_write_b32 a72, 0
  v_accvgpr_write_b32 a73, 0
  v_accvgpr_write_b32 a74, 0
  v_accvgpr_write_b32 a75, 0
  v_accvgpr_write_b32 a76, 0
  v_accvgpr_write_b32 a77, 0
  v_accvgpr_write_b32 a78, 0
  v_accvgpr_write_b32 a79, 0
  v_accvgpr_write_b32 a80, 0
  v_accvgpr_write_b32 a81, 0
  v_accvgpr_write_b32 a82, 0
  v_accvgpr_write_b32 a83, 0
  v_accvgpr_write_b32 a84, 0
  v_accvgpr_write_b32 a85, 0
  v_accvgpr_write_b32 a86, 0
  v_accvgpr_write_b32 a87, 0
  v_accvgpr_write_b32 a88, 0
  v_accvgpr_write_b32 a89, 0
  v_accvgpr_write_b32 a90, 0
  v_accvgpr_write_b32 a91, 0
  v_accvgpr_write_b32 a92, 0
  v_accvgpr_write_b32 a93, 0
  v_accvgpr_write_b32 a94, 0
  v_accvgpr_write_b32 a95, 0
  v_accvgpr_write_b32 a96, 0
  v_accvgpr_write_b32 a97, 0
  v_accvgpr_write_b32 a98, 0
  v_accvgpr_write_b32 a99, 0
  v_accvgpr_write_b32 a100, 0
  v_accvgpr_write_b32 a101, 0
  v_accvgpr_write_b32 a102, 0
  v_accvgpr_write_b32 a103, 0
  v_accvgpr_write_b32 a104, 0
  v_accvgpr_write_b32 a105, 0
  v_accvgpr_write_b32 a106, 0
  v_accvgpr_write_b32 a107, 0
  v_accvgpr_write_b32 a108, 0
  v_accvgpr_write_b32 a109, 0
  v_accvgpr_write_b32 a110, 0
  v_accvgpr_write_b32 a111, 0
  v_accvgpr_write_b32 a112, 0
  v_accvgpr_write_b32 a113, 0
  v_accvgpr_write_b32 a114, 0
  v_accvgpr_write_b32 a115, 0
  v_accvgpr_write_b32 a116, 0
  v_accvgpr_write_b32 a117, 0
  v_accvgpr_write_b32 a118, 0
  v_accvgpr_write_b32 a119, 0
  v_accvgpr_write_b32 a120, 0
  v_accvgpr_write_b32 a121, 0
  v_accvgpr_write_b32 a122, 0
  v_accvgpr_write_b32 a123, 0
  v_accvgpr_write_b32 a124, 0
  v_accvgpr_write_b32 a125, 0
  v_accvgpr_write_b32 a126, 0
  v_accvgpr_write_b32 a127, 0
  v_accvgpr_write_b32 a128, 0
  v_accvgpr_write_b32 a129, 0
  v_accvgpr_write_b32 a130, 0
  v_accvgpr_write_b32 a131, 0
  v_accvgpr_write_b32 a132, 0
  v_accvgpr_write_b32 a133, 0
  v_accvgpr_write_b32 a134, 0
  v_accvgpr_write_b32 a135, 0
  v_accvgpr_write_b32 a136, 0
  v_accvgpr_write_b32 a137, 0
  v_accvgpr_write_b32 a138, 0
  v_accvgpr_write_b32 a139, 0
  v_accvgpr_write_b32 a140, 0
  v_accvgpr_write_b32 a141, 0
  v_accvgpr_write_b32 a142, 0
  v_accvgpr_write_b32 a143, 0
  v_accvgpr_write_b32 a144, 0
  v_accvgpr_write_b32 a145, 0
  v_accvgpr_write_b32 a146, 0
  v_accvgpr_write_b32 a147, 0
  v_accvgpr_write_b32 a148, 0
  v_accvgpr_write_b32 a149, 0
  v_accvgpr_write_b32 a150, 0
  v_accvgpr_write_b32 a151, 0
  v_accvgpr_write_b32 a152, 0
  v_accvgpr_write_b32 a153, 0
  v_accvgpr_write_b32 a154, 0
  v_accvgpr_write_b32 a155, 0
  v_accvgpr_write_b32 a156, 0
  v_accvgpr_write_b32 a157, 0
  v_accvgpr_write_b32 a158, 0
  v_accvgpr_write_b32 a159, 0
  v_accvgpr_write_b32 a160, 0
  v_accvgpr_write_b32 a161, 0
  v_accvgpr_write_b32 a162, 0
  v_accvgpr_write_b32 a163, 0
  v_accvgpr_write_b32 a164, 0
  v_accvgpr_write_b32 a165, 0
  v_accvgpr_write_b32 a166, 0
  v_accvgpr_write_b32 a167, 0
  v_accvgpr_write_b32 a168, 0
  v_accvgpr_write_b32 a169, 0
  v_accvgpr_write_b32 a170, 0
  v_accvgpr_write_b32 a171, 0
  v_accvgpr_write_b32 a172, 0
  v_accvgpr_write_b32 a173, 0
  v_accvgpr_write_b32 a174, 0
  v_accvgpr_write_b32 a175, 0
  v_accvgpr_write_b32 a176, 0
  v_accvgpr_write_b32 a177, 0
  v_accvgpr_write_b32 a178, 0
  v_accvgpr_write_b32 a179, 0
  s_mov_b32 s5, 1
  s_add_u32 s74, s96, 0
  s_and_b32 s74, s74, 15
  s_lshl_b32 s74, s74, 13
  s_add_u32 s73, s96, 0
  s_and_b32 s73, s73, 15
  s_lshl_b32 s73, s73, 13
  s_add_u32 m0, s62, 0
  s_nop 0
  buffer_load_dwordx4 v246, s[32:35], s74 offen offset:0 nt lds
  buffer_load_dwordx4 v247, s[32:35], s74 offen offset:1024 nt lds
  buffer_load_dwordx4 v248, s[32:35], s74 offen offset:2048 nt lds
  buffer_load_dwordx4 v249, s[32:35], s74 offen offset:3072 nt lds
  s_add_u32 m0, s62, 4096
  s_add_u32 s64, s74, 4096
  buffer_load_dwordx4 v246, s[32:35], s64 offen offset:0 nt lds
  buffer_load_dwordx4 v247, s[32:35], s64 offen offset:1024 nt lds
  buffer_load_dwordx4 v248, s[32:35], s64 offen offset:2048 nt lds
  buffer_load_dwordx4 v249, s[32:35], s64 offen offset:3072 nt lds
  s_add_u32 m0, s62, 8192
  s_nop 0
  buffer_load_dwordx4 v250, s[36:39], s73 offen offset:0 nt lds
  buffer_load_dwordx4 v251, s[36:39], s73 offen offset:1024 nt lds
  buffer_load_dwordx4 v250, s[36:39], s73 offen offset:2048 nt lds
  buffer_load_dwordx4 v251, s[36:39], s73 offen offset:3072 nt lds
  s_add_u32 m0, s62, 12288
  s_add_u32 s65, s73, 4096
  buffer_load_dwordx4 v250, s[36:39], s65 offen offset:0 nt lds
  buffer_load_dwordx4 v251, s[36:39], s65 offen offset:1024 nt lds
  buffer_load_dwordx4 v250, s[36:39], s65 offen offset:2048 nt lds
  buffer_load_dwordx4 v251, s[36:39], s65 offen offset:3072 nt lds
  s_add_u32 s74, s96, 1
  s_and_b32 s74, s74, 15
  s_lshl_b32 s74, s74, 13
  s_add_u32 s73, s96, 1
  s_and_b32 s73, s73, 15
  s_lshl_b32 s73, s73, 13
  s_add_u32 m0, s62, 16384
  s_nop 0
  buffer_load_dwordx4 v246, s[32:35], s74 offen offset:0 nt lds
  buffer_load_dwordx4 v247, s[32:35], s74 offen offset:1024 nt lds
  buffer_load_dwordx4 v248, s[32:35], s74 offen offset:2048 nt lds
  buffer_load_dwordx4 v249, s[32:35], s74 offen offset:3072 nt lds
  s_add_u32 m0, s62, 20480
  s_add_u32 s64, s74, 4096
  buffer_load_dwordx4 v246, s[32:35], s64 offen offset:0 nt lds
  buffer_load_dwordx4 v247, s[32:35], s64 offen offset:1024 nt lds
  buffer_load_dwordx4 v248, s[32:35], s64 offen offset:2048 nt lds
  buffer_load_dwordx4 v249, s[32:35], s64 offen offset:3072 nt lds
  s_add_u32 m0, s62, 24576
  s_nop 0
  buffer_load_dwordx4 v250, s[36:39], s73 offen offset:0 nt lds
  buffer_load_dwordx4 v251, s[36:39], s73 offen offset:1024 nt lds
  buffer_load_dwordx4 v250, s[36:39], s73 offen offset:2048 nt lds
  buffer_load_dwordx4 v251, s[36:39], s73 offen offset:3072 nt lds
  s_add_u32 m0, s62, 28672
  s_add_u32 s65, s73, 4096
  buffer_load_dwordx4 v250, s[36:39], s65 offen offset:0 nt lds
  buffer_load_dwordx4 v251, s[36:39], s65 offen offset:1024 nt lds
  buffer_load_dwordx4 v250, s[36:39], s65 offen offset:2048 nt lds
  buffer_load_dwordx4 v251, s[36:39], s65 offen offset:3072 nt lds
  s_waitcnt vmcnt(24)
  ds_read_b128 v[144:147], v228 offset:0
  ds_read_b128 v[148:151], v229 offset:0
  ds_read_b128 v[152:155], v230 offset:0
  ds_read_b128 v[156:159], v231 offset:0
  ds_read_b128 v[160:163], v228 offset:4096
  ds_read_b128 v[164:167], v229 offset:4096
  ds_read_b128 v[168:171], v230 offset:4096
  ds_read_b128 v[172:175], v231 offset:4096
K1_ATT_COMMON_R:
  s_waitcnt lgkmcnt(0)
  s_add_u32 s74, s96, 2
  s_and_b32 s74, s74, 15
  s_lshl_b32 s74, s74, 13
  s_add_u32 m0, s62, 0
  s_nop 0
  buffer_load_dwordx4 v246, s[32:35], s74 offen offset:0 nt lds
  buffer_load_dwordx4 v247, s[32:35], s74 offen offset:1024 nt lds
  buffer_load_dwordx4 v248, s[32:35], s74 offen offset:2048 nt lds
  buffer_load_dwordx4 v249, s[32:35], s74 offen offset:3072 nt lds
  s_add_u32 m0, s62, 4096
  s_add_u32 s64, s74, 4096
  buffer_load_dwordx4 v246, s[32:35], s64 offen offset:0 nt lds
  buffer_load_dwordx4 v247, s[32:35], s64 offen offset:1024 nt lds
  buffer_load_dwordx4 v248, s[32:35], s64 offen offset:2048 nt lds
  buffer_load_dwordx4 v249, s[32:35], s64 offen offset:3072 nt lds
  s_add_u32 s73, s96, 2
  s_and_b32 s73, s73, 15
  s_lshl_b32 s73, s73, 13
  s_add_u32 s74, s96, 3
  s_and_b32 s74, s74, 15
  s_lshl_b32 s74, s74, 13
  s_mov_b32 s97, 0
  v_mfma_f32_16x16x32_bf16 v[96:99], v[144:147], v[16:19], 0
  v_mfma_f32_16x16x32_bf16 v[96:99], v[148:151], v[20:23], v[96:99]
  v_mfma_f32_16x16x32_bf16 v[96:99], v[152:155], v[24:27], v[96:99]
  v_mfma_f32_16x16x32_bf16 v[96:99], v[156:159], v[28:31], v[96:99]
  v_mfma_f32_16x16x32_bf16 v[100:103], v[160:163], v[16:19], 0
  v_mfma_f32_16x16x32_bf16 v[100:103], v[164:167], v[20:23], v[100:103]
  v_mfma_f32_16x16x32_bf16 v[100:103], v[168:171], v[24:27], v[100:103]
  v_mfma_f32_16x16x32_bf16 v[100:103], v[172:175], v[28:31], v[100:103]
  v_mfma_f32_16x16x32_bf16 v[104:107], v[144:147], v[32:35], 0
  v_mfma_f32_16x16x32_bf16 v[104:107], v[148:151], v[36:39], v[104:107]
  v_mfma_f32_16x16x32_bf16 v[104:107], v[152:155], v[40:43], v[104:107]
  v_mfma_f32_16x16x32_bf16 v[104:107], v[156:159], v[44:47], v[104:107]
  v_mfma_f32_16x16x32_bf16 v[108:111], v[160:163], v[32:35], 0
  v_mfma_f32_16x16x32_bf16 v[108:111], v[164:167], v[36:39], v[108:111]
  v_mfma_f32_16x16x32_bf16 v[108:111], v[168:171], v[40:43], v[108:111]
  v_mfma_f32_16x16x32_bf16 v[108:111], v[172:175], v[44:47], v[108:111]
  v_mfma_f32_16x16x32_bf16 v[112:115], v[144:147], v[48:51], 0
  v_mfma_f32_16x16x32_bf16 v[112:115], v[148:151], v[52:55], v[112:115]
  v_mfma_f32_16x16x32_bf16 v[112:115], v[152:155], v[56:59], v[112:115]
  v_mfma_f32_16x16x32_bf16 v[112:115], v[156:159], v[60:63], v[112:115]
  v_mfma_f32_16x16x32_bf16 v[116:119], v[160:163], v[48:51], 0
  v_mfma_f32_16x16x32_bf16 v[116:119], v[164:167], v[52:55], v[116:119]
  v_mfma_f32_16x16x32_bf16 v[116:119], v[168:171], v[56:59], v[116:119]
  v_mfma_f32_16x16x32_bf16 v[116:119], v[172:175], v[60:63], v[116:119]
  v_mfma_f32_16x16x32_bf16 v[120:123], v[144:147], v[64:67], 0
  v_mfma_f32_16x16x32_bf16 v[120:123], v[148:151], v[68:71], v[120:123]
  v_mfma_f32_16x16x32_bf16 v[120:123], v[152:155], v[72:75], v[120:123]
  v_mfma_f32_16x16x32_bf16 v[120:123], v[156:159], v[76:79], v[120:123]
  v_mfma_f32_16x16x32_bf16 v[124:127], v[160:163], v[64:67], 0
  v_mfma_f32_16x16x32_bf16 v[124:127], v[164:167], v[68:71], v[124:127]
  v_mfma_f32_16x16x32_bf16 v[124:127], v[168:171], v[72:75], v[124:127]
  v_mfma_f32_16x16x32_bf16 v[124:127], v[172:175], v[76:79], v[124:127]
  v_mfma_f32_16x16x32_bf16 v[128:131], v[144:147], v[80:83], 0
  v_mfma_f32_16x16x32_bf16 v[128:131], v[148:151], v[84:87], v[128:131]
  v_mfma_f32_16x16x32_bf16 v[128:131], v[152:155], v[88:91], v[128:131]
  v_mfma_f32_16x16x32_bf16 v[128:131], v[156:159], v[92:95], v[128:131]
  v_mfma_f32_16x16x32_bf16 v[132:135], v[160:163], v[80:83], 0
  v_mfma_f32_16x16x32_bf16 v[132:135], v[164:167], v[84:87], v[132:135]
  v_mfma_f32_16x16x32_bf16 v[132:135], v[168:171], v[88:91], v[132:135]
  v_mfma_f32_16x16x32_bf16 v[132:135], v[172:175], v[92:95], v[132:135]
  s_nop 7
  s_nop 1
  v_add_f32 v96, v96, v208
  v_add_f32 v97, v97, v208
  v_add_f32 v98, v98, v208
  v_add_f32 v99, v99, v208
  v_add_f32 v100, v100, v208
  v_add_f32 v101, v101, v208
  v_add_f32 v102, v102, v208
  v_add_f32 v103, v103, v208
  v_add_f32 v104, v104, v212
  v_add_f32 v105, v105, v212
  v_add_f32 v106, v106, v212
  v_add_f32 v107, v107, v212
  v_add_f32 v108, v108, v212
  v_add_f32 v109, v109, v212
  v_add_f32 v110, v110, v212
  v_add_f32 v111, v111, v212
  v_add_f32 v112, v112, v216
  v_add_f32 v113, v113, v216
  v_add_f32 v114, v114, v216
  v_add_f32 v115, v115, v216
  v_add_f32 v116, v116, v216
  v_add_f32 v117, v117, v216
  v_add_f32 v118, v118, v216
  v_add_f32 v119, v119, v216
  v_mov_b32 v136, 0
  v_mov_b32 v137, 0
  v_mov_b32 v138, 0
  v_mov_b32 v139, 0
  v_mov_b32 v176, 0
  v_mov_b32 v177, 0
  v_mov_b32 v178, 0
  v_mov_b32 v179, 0
  v_mov_b32 v180, 0
  v_mov_b32 v181, 0
  v_mov_b32 v182, 0
  v_mov_b32 v183, 0
  v_mov_b32 v184, 0
  v_mov_b32 v185, 0
  v_mov_b32 v186, 0
  v_mov_b32 v187, 0
  v_mov_b32 v188, 0
  v_mov_b32 v189, 0
  v_mov_b32 v190, 0
  v_mov_b32 v191, 0
  v_mov_b32 v192, 0
  v_mov_b32 v193, 0
  v_mov_b32 v194, 0
  v_mov_b32 v195, 0
  v_mov_b32 v196, 0
  v_mov_b32 v197, 0
  v_mov_b32 v198, 0
  v_mov_b32 v199, 0
  v_mov_b32 v200, 0
  v_mov_b32 v201, 0
  v_mov_b32 v202, 0
  v_mov_b32 v203, 0
  v_mov_b32 v204, 0
  v_mov_b32 v205, 0
  v_mov_b32 v206, 0
  v_mov_b32 v207, 0
  s_mov_b32 s68, 0
K1_ALOOP_R:
  s_waitcnt vmcnt(24)
  v_mfma_f32_16x16x32_bf16 a[128:131], v[176:179], v[136:139], a[128:131]
  ds_read_b64_tr_b16 v[176:177], v232 offset:8192
  ds_read_b64_tr_b16 v[178:179], v232 offset:12288
  v_mfma_f32_16x16x32_bf16 a[132:135], v[180:183], v[136:139], a[132:135]
  ds_read_b64_tr_b16 v[180:181], v233 offset:8192
  ds_read_b64_tr_b16 v[182:183], v233 offset:12288
  v_mfma_f32_16x16x32_bf16 a[136:139], v[184:187], v[136:139], a[136:139]
  ds_read_b64_tr_b16 v[184:185], v234 offset:8192
  ds_read_b64_tr_b16 v[186:187], v234 offset:12288
  v_mfma_f32_16x16x32_bf16 a[140:143], v[188:191], v[136:139], a[140:143]
  ds_read_b64_tr_b16 v[188:189], v235 offset:8192
  ds_read_b64_tr_b16 v[190:191], v235 offset:12288
  v_mfma_f32_16x16x32_bf16 a[144:147], v[192:195], v[136:139], a[144:147]
  ds_read_b64_tr_b16 v[192:193], v236 offset:8192
  ds_read_b64_tr_b16 v[194:195], v236 offset:12288
  v_mfma_f32_16x16x32_bf16 a[148:151], v[196:199], v[136:139], a[148:151]
  ds_read_b64_tr_b16 v[196:197], v237 offset:8192
  ds_read_b64_tr_b16 v[198:199], v237 offset:12288
  v_mfma_f32_16x16x32_bf16 a[152:155], v[200:203], v[136:139], a[152:155]
  ds_read_b64_tr_b16 v[200:201], v238 offset:8192
  ds_read_b64_tr_b16 v[202:203], v238 offset:12288
  v_mfma_f32_16x16x32_bf16 a[156:159], v[204:207], v[136:139], a[156:159]
  ds_read_b64_tr_b16 v[204:205], v239 offset:8192
  ds_read_b64_tr_b16 v[206:207], v239 offset:12288
  v_mfma_f32_16x16x32_bf16 a[176:179], a[180:183], v[136:139], a[176:179]
  v_exp_f32 v96, v96
  v_mfma_f32_16x16x32_bf16 v[120:123], v[144:147], v[64:67], v[220:223]
  v_exp_f32 v97, v97
  v_mfma_f32_16x16x32_bf16 v[120:123], v[148:151], v[68:71], v[120:123]
  v_exp_f32 v98, v98
  v_mfma_f32_16x16x32_bf16 v[120:123], v[152:155], v[72:75], v[120:123]
  v_exp_f32 v99, v99
  v_cvt_pk_bf16_f32 v136, v96, v97
  v_mfma_f32_16x16x32_bf16 v[120:123], v[156:159], v[76:79], v[120:123]
  v_exp_f32 v100, v100
  v_mfma_f32_16x16x32_bf16 v[124:127], v[160:163], v[64:67], v[220:223]
  v_exp_f32 v101, v101
  v_cvt_pk_bf16_f32 v137, v98, v99
  v_mfma_f32_16x16x32_bf16 v[124:127], v[164:167], v[68:71], v[124:127]
  v_exp_f32 v102, v102
  v_mfma_f32_16x16x32_bf16 v[124:127], v[168:171], v[72:75], v[124:127]
  v_exp_f32 v103, v103
  v_cvt_pk_bf16_f32 v138, v100, v101
  v_mfma_f32_16x16x32_bf16 v[124:127], v[172:175], v[76:79], v[124:127]
  s_nop 0
  v_cvt_pk_bf16_f32 v139, v102, v103
  s_waitcnt vmcnt(16)
  v_mfma_f32_16x16x32_bf16 v[128:131], v[144:147], v[80:83], v[224:227]
  ds_read_b128 v[144:147], v228 offset:16384
  v_exp_f32 v104, v104
  v_mfma_f32_16x16x32_bf16 v[128:131], v[148:151], v[84:87], v[128:131]
  ds_read_b128 v[148:151], v229 offset:16384
  v_mfma_f32_16x16x32_bf16 v[128:131], v[152:155], v[88:91], v[128:131]
  ds_read_b128 v[152:155], v230 offset:16384
  v_exp_f32 v105, v105
  v_mfma_f32_16x16x32_bf16 v[128:131], v[156:159], v[92:95], v[128:131]
  ds_read_b128 v[156:159], v231 offset:16384
  v_mfma_f32_16x16x32_bf16 v[132:135], v[160:163], v[80:83], v[224:227]
  ds_read_b128 v[160:163], v228 offset:20480
  v_exp_f32 v106, v106
  v_mfma_f32_16x16x32_bf16 v[132:135], v[164:167], v[84:87], v[132:135]
  ds_read_b128 v[164:167], v229 offset:20480
  v_cvt_pk_bf16_f32 v140, v104, v105
  v_mfma_f32_16x16x32_bf16 v[132:135], v[168:171], v[88:91], v[132:135]
  ds_read_b128 v[168:171], v230 offset:20480
  v_exp_f32 v107, v107
  v_mfma_f32_16x16x32_bf16 v[132:135], v[172:175], v[92:95], v[132:135]
  ds_read_b128 v[172:175], v231 offset:20480
  s_waitcnt lgkmcnt(8)
  v_mfma_f32_16x16x32_bf16 a[0:3], v[176:179], v[136:139], a[0:3]
  v_exp_f32 v108, v108
  v_mfma_f32_16x16x32_bf16 a[4:7], v[180:183], v[136:139], a[4:7]
  v_cvt_pk_bf16_f32 v141, v106, v107
  v_mfma_f32_16x16x32_bf16 a[8:11], v[184:187], v[136:139], a[8:11]
  v_exp_f32 v109, v109
  v_mfma_f32_16x16x32_bf16 a[12:15], v[188:191], v[136:139], a[12:15]
  s_add_u32 m0, s62, 8192
  s_nop 0
  buffer_load_dwordx4 v250, s[36:39], s73 offen offset:0 nt lds
  v_mfma_f32_16x16x32_bf16 a[16:19], v[192:195], v[136:139], a[16:19]
  v_exp_f32 v110, v110
  v_mfma_f32_16x16x32_bf16 a[20:23], v[196:199], v[136:139], a[20:23]
  v_cvt_pk_bf16_f32 v142, v108, v109
  buffer_load_dwordx4 v251, s[36:39], s73 offen offset:1024 nt lds
  v_mfma_f32_16x16x32_bf16 a[24:27], v[200:203], v[136:139], a[24:27]
  v_exp_f32 v111, v111
  v_mfma_f32_16x16x32_bf16 a[28:31], v[204:207], v[136:139], a[28:31]
  buffer_load_dwordx4 v250, s[36:39], s73 offen offset:2048 nt lds
  v_mfma_f32_16x16x32_bf16 a[160:163], a[180:183], v[136:139], a[160:163]
  v_cvt_pk_bf16_f32 v143, v110, v111
  s_waitcnt lgkmcnt(0)
  v_mfma_f32_16x16x32_bf16 v[96:99], v[144:147], v[16:19], v[208:211]
  v_exp_f32 v112, v112
  v_mfma_f32_16x16x32_bf16 v[96:99], v[148:151], v[20:23], v[96:99]
  buffer_load_dwordx4 v251, s[36:39], s73 offen offset:3072 nt lds
  v_mfma_f32_16x16x32_bf16 v[96:99], v[152:155], v[24:27], v[96:99]
  v_exp_f32 v113, v113
  v_mfma_f32_16x16x32_bf16 v[96:99], v[156:159], v[28:31], v[96:99]
  v_cvt_pk_bf16_f32 v136, v112, v113
  v_mfma_f32_16x16x32_bf16 v[100:103], v[160:163], v[16:19], v[208:211]
  v_exp_f32 v114, v114
  v_mfma_f32_16x16x32_bf16 v[100:103], v[164:167], v[20:23], v[100:103]
  s_add_u32 m0, s62, 12288
  s_add_u32 s65, s73, 4096
  buffer_load_dwordx4 v250, s[36:39], s65 offen offset:0 nt lds
  v_mfma_f32_16x16x32_bf16 v[100:103], v[168:171], v[24:27], v[100:103]
  v_exp_f32 v115, v115
  v_mfma_f32_16x16x32_bf16 v[100:103], v[172:175], v[28:31], v[100:103]
  v_cvt_pk_bf16_f32 v137, v114, v115
  v_mfma_f32_16x16x32_bf16 a[32:35], v[176:179], v[140:143], a[32:35]
  v_exp_f32 v116, v116
  v_mfma_f32_16x16x32_bf16 a[36:39], v[180:183], v[140:143], a[36:39]
  buffer_load_dwordx4 v251, s[36:39], s65 offen offset:1024 nt lds
  v_mfma_f32_16x16x32_bf16 a[40:43], v[184:187], v[140:143], a[40:43]
  v_exp_f32 v117, v117
  v_mfma_f32_16x16x32_bf16 a[44:47], v[188:191], v[140:143], a[44:47]
  v_cvt_pk_bf16_f32 v138, v116, v117
  v_mfma_f32_16x16x32_bf16 a[48:51], v[192:195], v[140:143], a[48:51]
  v_exp_f32 v118, v118
  v_mfma_f32_16x16x32_bf16 a[52:55], v[196:199], v[140:143], a[52:55]
  buffer_load_dwordx4 v250, s[36:39], s65 offen offset:2048 nt lds
  v_mfma_f32_16x16x32_bf16 a[56:59], v[200:203], v[140:143], a[56:59]
  v_exp_f32 v119, v119
  v_mfma_f32_16x16x32_bf16 a[60:63], v[204:207], v[140:143], a[60:63]
  v_cvt_pk_bf16_f32 v139, v118, v119
  v_mfma_f32_16x16x32_bf16 a[164:167], a[180:183], v[140:143], a[164:167]
  buffer_load_dwordx4 v251, s[36:39], s65 offen offset:3072 nt lds
  v_mfma_f32_16x16x32_bf16 v[104:107], v[144:147], v[32:35], v[212:215]
  v_exp_f32 v120, v120
  v_mfma_f32_16x16x32_bf16 v[104:107], v[148:151], v[36:39], v[104:107]
  s_add_u32 m0, s62, 16384
  s_nop 0
  buffer_load_dwordx4 v246, s[32:35], s74 offen offset:0 nt lds
  v_mfma_f32_16x16x32_bf16 v[104:107], v[152:155], v[40:43], v[104:107]
  v_exp_f32 v121, v121
  v_mfma_f32_16x16x32_bf16 v[104:107], v[156:159], v[44:47], v[104:107]
  v_cvt_pk_bf16_f32 v140, v120, v121
  v_mfma_f32_16x16x32_bf16 v[108:111], v[160:163], v[32:35], v[212:215]
  v_exp_f32 v122, v122
  v_mfma_f32_16x16x32_bf16 v[108:111], v[164:167], v[36:39], v[108:111]
  buffer_load_dwordx4 v247, s[32:35], s74 offen offset:1024 nt lds
  v_mfma_f32_16x16x32_bf16 v[108:111], v[168:171], v[40:43], v[108:111]
  v_exp_f32 v123, v123
  v_mfma_f32_16x16x32_bf16 v[108:111], v[172:175], v[44:47], v[108:111]
  v_cvt_pk_bf16_f32 v141, v122, v123
  v_mfma_f32_16x16x32_bf16 a[64:67], v[176:179], v[136:139], a[64:67]
  v_exp_f32 v124, v124
  v_mfma_f32_16x16x32_bf16 a[68:71], v[180:183], v[136:139], a[68:71]
  buffer_load_dwordx4 v248, s[32:35], s74 offen offset:2048 nt lds
  v_mfma_f32_16x16x32_bf16 a[72:75], v[184:187], v[136:139], a[72:75]
  v_exp_f32 v125, v125
  v_mfma_f32_16x16x32_bf16 a[76:79], v[188:191], v[136:139], a[76:79]
  v_cvt_pk_bf16_f32 v142, v124, v125
  v_mfma_f32_16x16x32_bf16 a[80:83], v[192:195], v[136:139], a[80:83]
  v_exp_f32 v126, v126
  v_mfma_f32_16x16x32_bf16 a[84:87], v[196:199], v[136:139], a[84:87]
  buffer_load_dwordx4 v249, s[32:35], s74 offen offset:3072 nt lds
  v_mfma_f32_16x16x32_bf16 a[88:91], v[200:203], v[136:139], a[88:91]
  v_exp_f32 v127, v127
  v_mfma_f32_16x16x32_bf16 a[92:95], v[204:207], v[136:139], a[92:95]
  v_cvt_pk_bf16_f32 v143, v126, v127
  v_mfma_f32_16x16x32_bf16 a[168:171], a[180:183], v[136:139], a[168:171]
  v_mfma_f32_16x16x32_bf16 v[112:115], v[144:147], v[48:51], v[216:219]
  v_exp_f32 v128, v128
  v_mfma_f32_16x16x32_bf16 v[112:115], v[148:151], v[52:55], v[112:115]
  s_add_u32 m0, s62, 20480
  s_add_u32 s64, s74, 4096
  buffer_load_dwordx4 v246, s[32:35], s64 offen offset:0 nt lds
  v_mfma_f32_16x16x32_bf16 v[112:115], v[152:155], v[56:59], v[112:115]
  v_exp_f32 v129, v129
  v_mfma_f32_16x16x32_bf16 v[112:115], v[156:159], v[60:63], v[112:115]
  v_cvt_pk_bf16_f32 v136, v128, v129
  v_mfma_f32_16x16x32_bf16 v[116:119], v[160:163], v[48:51], v[216:219]
  v_exp_f32 v130, v130
  v_mfma_f32_16x16x32_bf16 v[116:119], v[164:167], v[52:55], v[116:119]
  buffer_load_dwordx4 v247, s[32:35], s64 offen offset:1024 nt lds
  v_mfma_f32_16x16x32_bf16 v[116:119], v[168:171], v[56:59], v[116:119]
  v_exp_f32 v131, v131
  v_mfma_f32_16x16x32_bf16 v[116:119], v[172:175], v[60:63], v[116:119]
  v_cvt_pk_bf16_f32 v137, v130, v131
  v_mfma_f32_16x16x32_bf16 a[96:99], v[176:179], v[140:143], a[96:99]
  v_exp_f32 v132, v132
  v_mfma_f32_16x16x32_bf16 a[100:103], v[180:183], v[140:143], a[100:103]
  buffer_load_dwordx4 v248, s[32:35], s64 offen offset:2048 nt lds
  v_mfma_f32_16x16x32_bf16 a[104:107], v[184:187], v[140:143], a[104:107]
  v_exp_f32 v133, v133
  v_mfma_f32_16x16x32_bf16 a[108:111], v[188:191], v[140:143], a[108:111]
  v_cvt_pk_bf16_f32 v138, v132, v133
  v_mfma_f32_16x16x32_bf16 a[112:115], v[192:195], v[140:143], a[112:115]
  v_exp_f32 v134, v134
  v_mfma_f32_16x16x32_bf16 a[116:119], v[196:199], v[140:143], a[116:119]
  buffer_load_dwordx4 v249, s[32:35], s64 offen offset:3072 nt lds
  v_mfma_f32_16x16x32_bf16 a[120:123], v[200:203], v[140:143], a[120:123]
  v_exp_f32 v135, v135
  v_mfma_f32_16x16x32_bf16 a[124:127], v[204:207], v[140:143], a[124:127]
  v_cvt_pk_bf16_f32 v139, v134, v135
  v_mfma_f32_16x16x32_bf16 a[172:175], a[180:183], v[140:143], a[172:175]
  s_add_u32 s97, s97, 1
  s_add_u32 s66, s97, s96
  s_add_u32 s73, s66, 2
  s_and_b32 s73, s73, 15
  s_lshl_b32 s73, s73, 13
  s_cmp_lt_u32 s97, 14
  s_cselect_b32 s73, s73, 0x40000000
  s_add_u32 s74, s66, 3
  s_and_b32 s74, s74, 15
  s_lshl_b32 s74, s74, 13
  s_cmp_lt_u32 s97, 13
  s_cselect_b32 s74, s74, 0x40000000
  s_waitcnt vmcnt(24)
  v_mfma_f32_16x16x32_bf16 a[128:131], v[176:179], v[136:139], a[128:131]
  ds_read_b64_tr_b16 v[176:177], v232 offset:24576
  ds_read_b64_tr_b16 v[178:179], v232 offset:28672
  v_mfma_f32_16x16x32_bf16 a[132:135], v[180:183], v[136:139], a[132:135]
  ds_read_b64_tr_b16 v[180:181], v233 offset:24576
  ds_read_b64_tr_b16 v[182:183], v233 offset:28672
  v_mfma_f32_16x16x32_bf16 a[136:139], v[184:187], v[136:139], a[136:139]
  ds_read_b64_tr_b16 v[184:185], v234 offset:24576
  ds_read_b64_tr_b16 v[186:187], v234 offset:28672
  v_mfma_f32_16x16x32_bf16 a[140:143], v[188:191], v[136:139], a[140:143]
  ds_read_b64_tr_b16 v[188:189], v235 offset:24576
  ds_read_b64_tr_b16 v[190:191], v235 offset:28672
  v_mfma_f32_16x16x32_bf16 a[144:147], v[192:195], v[136:139], a[144:147]
  ds_read_b64_tr_b16 v[192:193], v236 offset:24576
  ds_read_b64_tr_b16 v[194:195], v236 offset:28672
  v_mfma_f32_16x16x32_bf16 a[148:151], v[196:199], v[136:139], a[148:151]
  ds_read_b64_tr_b16 v[196:197], v237 offset:24576
  ds_read_b64_tr_b16 v[198:199], v237 offset:28672
  v_mfma_f32_16x16x32_bf16 a[152:155], v[200:203], v[136:139], a[152:155]
  ds_read_b64_tr_b16 v[200:201], v238 offset:24576
  ds_read_b64_tr_b16 v[202:203], v238 offset:28672
  v_mfma_f32_16x16x32_bf16 a[156:159], v[204:207], v[136:139], a[156:159]
  ds_read_b64_tr_b16 v[204:205], v239 offset:24576
  ds_read_b64_tr_b16 v[206:207], v239 offset:28672
  v_mfma_f32_16x16x32_bf16 a[176:179], a[180:183], v[136:139], a[176:179]
  v_exp_f32 v96, v96
  v_mfma_f32_16x16x32_bf16 v[120:123], v[144:147], v[64:67], v[220:223]
  v_exp_f32 v97, v97
  v_mfma_f32_16x16x32_bf16 v[120:123], v[148:151], v[68:71], v[120:123]
  v_exp_f32 v98, v98
  v_mfma_f32_16x16x32_bf16 v[120:123], v[152:155], v[72:75], v[120:123]
  v_exp_f32 v99, v99
  v_cvt_pk_bf16_f32 v136, v96, v97
  v_mfma_f32_16x16x32_bf16 v[120:123], v[156:159], v[76:79], v[120:123]
  v_exp_f32 v100, v100
  v_mfma_f32_16x16x32_bf16 v[124:127], v[160:163], v[64:67], v[220:223]
  v_exp_f32 v101, v101
  v_cvt_pk_bf16_f32 v137, v98, v99
  v_mfma_f32_16x16x32_bf16 v[124:127], v[164:167], v[68:71], v[124:127]
  v_exp_f32 v102, v102
  v_mfma_f32_16x16x32_bf16 v[124:127], v[168:171], v[72:75], v[124:127]
  v_exp_f32 v103, v103
  v_cvt_pk_bf16_f32 v138, v100, v101
  v_mfma_f32_16x16x32_bf16 v[124:127], v[172:175], v[76:79], v[124:127]
  s_nop 0
  v_cvt_pk_bf16_f32 v139, v102, v103
  s_waitcnt vmcnt(16)
  v_mfma_f32_16x16x32_bf16 v[128:131], v[144:147], v[80:83], v[224:227]
  ds_read_b128 v[144:147], v228 offset:0
  v_exp_f32 v104, v104
  v_mfma_f32_16x16x32_bf16 v[128:131], v[148:151], v[84:87], v[128:131]
  ds_read_b128 v[148:151], v229 offset:0
  v_mfma_f32_16x16x32_bf16 v[128:131], v[152:155], v[88:91], v[128:131]
  ds_read_b128 v[152:155], v230 offset:0
  v_exp_f32 v105, v105
  v_mfma_f32_16x16x32_bf16 v[128:131], v[156:159], v[92:95], v[128:131]
  ds_read_b128 v[156:159], v231 offset:0
  v_mfma_f32_16x16x32_bf16 v[132:135], v[160:163], v[80:83], v[224:227]
  ds_read_b128 v[160:163], v228 offset:4096
  v_exp_f32 v106, v106
  v_mfma_f32_16x16x32_bf16 v[132:135], v[164:167], v[84:87], v[132:135]
  ds_read_b128 v[164:167], v229 offset:4096
  v_cvt_pk_bf16_f32 v140, v104, v105
  v_mfma_f32_16x16x32_bf16 v[132:135], v[168:171], v[88:91], v[132:135]
  ds_read_b128 v[168:171], v230 offset:4096
  v_exp_f32 v107, v107
  v_mfma_f32_16x16x32_bf16 v[132:135], v[172:175], v[92:95], v[132:135]
  ds_read_b128 v[172:175], v231 offset:4096
  s_waitcnt lgkmcnt(8)
  v_mfma_f32_16x16x32_bf16 a[0:3], v[176:179], v[136:139], a[0:3]
  v_exp_f32 v108, v108
  v_mfma_f32_16x16x32_bf16 a[4:7], v[180:183], v[136:139], a[4:7]
  v_cvt_pk_bf16_f32 v141, v106, v107
  v_mfma_f32_16x16x32_bf16 a[8:11], v[184:187], v[136:139], a[8:11]
  v_exp_f32 v109, v109
  v_mfma_f32_16x16x32_bf16 a[12:15], v[188:191], v[136:139], a[12:15]
  s_add_u32 m0, s62, 24576
  s_nop 0
  buffer_load_dwordx4 v250, s[36:39], s73 offen offset:0 nt lds
  v_mfma_f32_16x16x32_bf16 a[16:19], v[192:195], v[136:139], a[16:19]
  v_exp_f32 v110, v110
  v_mfma_f32_16x16x32_bf16 a[20:23], v[196:199], v[136:139], a[20:23]
  v_cvt_pk_bf16_f32 v142, v108, v109
  buffer_load_dwordx4 v251, s[36:39], s73 offen offset:1024 nt lds
  v_mfma_f32_16x16x32_bf16 a[24:27], v[200:203], v[136:139], a[24:27]
  v_exp_f32 v111, v111
  v_mfma_f32_16x16x32_bf16 a[28:31], v[204:207], v[136:139], a[28:31]
  buffer_load_dwordx4 v250, s[36:39], s73 offen offset:2048 nt lds
  v_mfma_f32_16x16x32_bf16 a[160:163], a[180:183], v[136:139], a[160:163]
  v_cvt_pk_bf16_f32 v143, v110, v111
  s_waitcnt lgkmcnt(0)
  v_mfma_f32_16x16x32_bf16 v[96:99], v[144:147], v[16:19], v[208:211]
  v_exp_f32 v112, v112
  v_mfma_f32_16x16x32_bf16 v[96:99], v[148:151], v[20:23], v[96:99]
  buffer_load_dwordx4 v251, s[36:39], s73 offen offset:3072 nt lds
  v_mfma_f32_16x16x32_bf16 v[96:99], v[152:155], v[24:27], v[96:99]
  v_exp_f32 v113, v113
  v_mfma_f32_16x16x32_bf16 v[96:99], v[156:159], v[28:31], v[96:99]
  v_cvt_pk_bf16_f32 v136, v112, v113
  v_mfma_f32_16x16x32_bf16 v[100:103], v[160:163], v[16:19], v[208:211]
  v_exp_f32 v114, v114
  v_mfma_f32_16x16x32_bf16 v[100:103], v[164:167], v[20:23], v[100:103]
  s_add_u32 m0, s62, 28672
  s_add_u32 s65, s73, 4096
  buffer_load_dwordx4 v250, s[36:39], s65 offen offset:0 nt lds
  v_mfma_f32_16x16x32_bf16 v[100:103], v[168:171], v[24:27], v[100:103]
  v_exp_f32 v115, v115
  v_mfma_f32_16x16x32_bf16 v[100:103], v[172:175], v[28:31], v[100:103]
  v_cvt_pk_bf16_f32 v137, v114, v115
  v_mfma_f32_16x16x32_bf16 a[32:35], v[176:179], v[140:143], a[32:35]
  v_exp_f32 v116, v116
  v_mfma_f32_16x16x32_bf16 a[36:39], v[180:183], v[140:143], a[36:39]
  buffer_load_dwordx4 v251, s[36:39], s65 offen offset:1024 nt lds
  v_mfma_f32_16x16x32_bf16 a[40:43], v[184:187], v[140:143], a[40:43]
  v_exp_f32 v117, v117
  v_mfma_f32_16x16x32_bf16 a[44:47], v[188:191], v[140:143], a[44:47]
  v_cvt_pk_bf16_f32 v138, v116, v117
  v_mfma_f32_16x16x32_bf16 a[48:51], v[192:195], v[140:143], a[48:51]
  v_exp_f32 v118, v118
  v_mfma_f32_16x16x32_bf16 a[52:55], v[196:199], v[140:143], a[52:55]
  buffer_load_dwordx4 v250, s[36:39], s65 offen offset:2048 nt lds
  v_mfma_f32_16x16x32_bf16 a[56:59], v[200:203], v[140:143], a[56:59]
  v_exp_f32 v119, v119
  v_mfma_f32_16x16x32_bf16 a[60:63], v[204:207], v[140:143], a[60:63]
  v_cvt_pk_bf16_f32 v139, v118, v119
  v_mfma_f32_16x16x32_bf16 a[164:167], a[180:183], v[140:143], a[164:167]
  buffer_load_dwordx4 v251, s[36:39], s65 offen offset:3072 nt lds
  v_mfma_f32_16x16x32_bf16 v[104:107], v[144:147], v[32:35], v[212:215]
  v_exp_f32 v120, v120
  v_mfma_f32_16x16x32_bf16 v[104:107], v[148:151], v[36:39], v[104:107]
  s_add_u32 m0, s62, 0
  s_nop 0
  buffer_load_dwordx4 v246, s[32:35], s74 offen offset:0 nt lds
  v_mfma_f32_16x16x32_bf16 v[104:107], v[152:155], v[40:43], v[104:107]
  v_exp_f32 v121, v121
  v_mfma_f32_16x16x32_bf16 v[104:107], v[156:159], v[44:47], v[104:107]
  v_cvt_pk_bf16_f32 v140, v120, v121
  v_mfma_f32_16x16x32_bf16 v[108:111], v[160:163], v[32:35], v[212:215]
  v_exp_f32 v122, v122
  v_mfma_f32_16x16x32_bf16 v[108:111], v[164:167], v[36:39], v[108:111]
  buffer_load_dwordx4 v247, s[32:35], s74 offen offset:1024 nt lds
  v_mfma_f32_16x16x32_bf16 v[108:111], v[168:171], v[40:43], v[108:111]
  v_exp_f32 v123, v123
  v_mfma_f32_16x16x32_bf16 v[108:111], v[172:175], v[44:47], v[108:111]
  v_cvt_pk_bf16_f32 v141, v122, v123
  v_mfma_f32_16x16x32_bf16 a[64:67], v[176:179], v[136:139], a[64:67]
  v_exp_f32 v124, v124
  v_mfma_f32_16x16x32_bf16 a[68:71], v[180:183], v[136:139], a[68:71]
  buffer_load_dwordx4 v248, s[32:35], s74 offen offset:2048 nt lds
  v_mfma_f32_16x16x32_bf16 a[72:75], v[184:187], v[136:139], a[72:75]
  v_exp_f32 v125, v125
  v_mfma_f32_16x16x32_bf16 a[76:79], v[188:191], v[136:139], a[76:79]
  v_cvt_pk_bf16_f32 v142, v124, v125
  v_mfma_f32_16x16x32_bf16 a[80:83], v[192:195], v[136:139], a[80:83]
  v_exp_f32 v126, v126
  v_mfma_f32_16x16x32_bf16 a[84:87], v[196:199], v[136:139], a[84:87]
  buffer_load_dwordx4 v249, s[32:35], s74 offen offset:3072 nt lds
  v_mfma_f32_16x16x32_bf16 a[88:91], v[200:203], v[136:139], a[88:91]
  v_exp_f32 v127, v127
  v_mfma_f32_16x16x32_bf16 a[92:95], v[204:207], v[136:139], a[92:95]
  v_cvt_pk_bf16_f32 v143, v126, v127
  v_mfma_f32_16x16x32_bf16 a[168:171], a[180:183], v[136:139], a[168:171]
  v_mfma_f32_16x16x32_bf16 v[112:115], v[144:147], v[48:51], v[216:219]
  v_exp_f32 v128, v128
  v_mfma_f32_16x16x32_bf16 v[112:115], v[148:151], v[52:55], v[112:115]
  s_add_u32 m0, s62, 4096
  s_add_u32 s64, s74, 4096
  buffer_load_dwordx4 v246, s[32:35], s64 offen offset:0 nt lds
  v_mfma_f32_16x16x32_bf16 v[112:115], v[152:155], v[56:59], v[112:115]
  v_exp_f32 v129, v129
  v_mfma_f32_16x16x32_bf16 v[112:115], v[156:159], v[60:63], v[112:115]
  v_cvt_pk_bf16_f32 v136, v128, v129
  v_mfma_f32_16x16x32_bf16 v[116:119], v[160:163], v[48:51], v[216:219]
  v_exp_f32 v130, v130
  v_mfma_f32_16x16x32_bf16 v[116:119], v[164:167], v[52:55], v[116:119]
  buffer_load_dwordx4 v247, s[32:35], s64 offen offset:1024 nt lds
  v_mfma_f32_16x16x32_bf16 v[116:119], v[168:171], v[56:59], v[116:119]
  v_exp_f32 v131, v131
  v_mfma_f32_16x16x32_bf16 v[116:119], v[172:175], v[60:63], v[116:119]
  v_cvt_pk_bf16_f32 v137, v130, v131
  v_mfma_f32_16x16x32_bf16 a[96:99], v[176:179], v[140:143], a[96:99]
  v_exp_f32 v132, v132
  v_mfma_f32_16x16x32_bf16 a[100:103], v[180:183], v[140:143], a[100:103]
  buffer_load_dwordx4 v248, s[32:35], s64 offen offset:2048 nt lds
  v_mfma_f32_16x16x32_bf16 a[104:107], v[184:187], v[140:143], a[104:107]
  v_exp_f32 v133, v133
  v_mfma_f32_16x16x32_bf16 a[108:111], v[188:191], v[140:143], a[108:111]
  v_cvt_pk_bf16_f32 v138, v132, v133
  v_mfma_f32_16x16x32_bf16 a[112:115], v[192:195], v[140:143], a[112:115]
  v_exp_f32 v134, v134
  v_mfma_f32_16x16x32_bf16 a[116:119], v[196:199], v[140:143], a[116:119]
  buffer_load_dwordx4 v249, s[32:35], s64 offen offset:3072 nt lds
  v_mfma_f32_16x16x32_bf16 a[120:123], v[200:203], v[140:143], a[120:123]
  v_exp_f32 v135, v135
  v_mfma_f32_16x16x32_bf16 a[124:127], v[204:207], v[140:143], a[124:127]
  v_cvt_pk_bf16_f32 v139, v134, v135
  v_mfma_f32_16x16x32_bf16 a[172:175], a[180:183], v[140:143], a[172:175]
  s_add_u32 s97, s97, 1
  s_add_u32 s66, s97, s96
  s_add_u32 s73, s66, 2
  s_and_b32 s73, s73, 15
  s_lshl_b32 s73, s73, 13
  s_cmp_lt_u32 s97, 14
  s_cselect_b32 s73, s73, 0x40000000
  s_add_u32 s74, s66, 3
  s_and_b32 s74, s74, 15
  s_lshl_b32 s74, s74, 13
  s_cmp_lt_u32 s97, 13
  s_cselect_b32 s74, s74, 0x40000000
  s_add_u32 s68, s68, 2
  s_cmp_lt_u32 s68, 16
  s_cbranch_scc1 K1_ALOOP_R
  s_branch K1_POST
.globl reduce_kernel
.p2align 8
.type reduce_kernel,@function
reduce_kernel:
  s_cmp_ge_u32 s2, 360
  s_cbranch_scc1 K2_END
  s_load_dwordx2 s[8:9], s[0:1], 80
  s_load_dwordx2 s[10:11], s[0:1], 96
  v_lshrrev_b32 v1, 6, v0
  v_and_b32 v0, 63, v0
  v_readfirstlane_b32 s12, v1
  s_lshl_b32 s13, s2, 2
  v_lshlrev_b32 v2, 4, v0
  s_add_u32 s13, s13, s12
  s_mov_b32 s78, s13
  s_mul_i32 s13, s13, 2
  s_mul_i32 s14, s13, 46604
  s_lshr_b32 s14, s14, 22
  s_mul_i32 s15, s14, 90
  s_sub_u32 s15, s13, s15
  s_lshr_b32 s16, s14, 4
  s_and_b32 s17, s14, 15
  s_mul_i32 s18, s16, 11796480
  s_mul_i32 s19, s17, 92160
  s_add_u32 s18, s18, s19
  s_lshl_b32 s19, s15, 10
  s_add_u32 s18, s18, s19
  s_waitcnt lgkmcnt(0)
  s_add_u32 s20, s10, s18
  s_addc_u32 s21, s11, 0
  s_and_b32 s21, s21, 0xffff
  s_mov_b32 s22, 10323968
  s_mov_b32 s23, 0x20000
  s_mov_b32 s24, 0
  buffer_load_dwordx4 v[32:35], v2, s[20:23], s24 offen
  s_mov_b32 s24, 1474560
  buffer_load_dwordx4 v[36:39], v2, s[20:23], s24 offen
  s_mov_b32 s24, 2949120
  buffer_load_dwordx4 v[40:43], v2, s[20:23], s24 offen
  s_mov_b32 s24, 4423680
  buffer_load_dwordx4 v[44:47], v2, s[20:23], s24 offen
  s_mov_b32 s24, 5898240
  buffer_load_dwordx4 v[48:51], v2, s[20:23], s24 offen
  s_mov_b32 s24, 7372800
  buffer_load_dwordx4 v[52:55], v2, s[20:23], s24 offen
  s_mov_b32 s24, 8847360
  buffer_load_dwordx4 v[56:59], v2, s[20:23], s24 offen
  s_mov_b32 s24, 10321920
  buffer_load_dwordx4 v[60:63], v2, s[20:23], s24 offen
  s_mov_b32 s24, 1024
  buffer_load_dwordx4 v[64:67], v2, s[20:23], s24 offen
  s_mov_b32 s24, 1475584
  buffer_load_dwordx4 v[68:71], v2, s[20:23], s24 offen
  s_mov_b32 s24, 2950144
  buffer_load_dwordx4 v[72:75], v2, s[20:23], s24 offen
  s_mov_b32 s24, 4424704
  buffer_load_dwordx4 v[76:79], v2, s[20:23], s24 offen
  s_mov_b32 s24, 5899264
  buffer_load_dwordx4 v[80:83], v2, s[20:23], s24 offen
  s_mov_b32 s24, 7373824
  buffer_load_dwordx4 v[84:87], v2, s[20:23], s24 offen
  s_mov_b32 s24, 8848384
  buffer_load_dwordx4 v[88:91], v2, s[20:23], s24 offen
  s_mov_b32 s24, 10322944
  buffer_load_dwordx4 v[92:95], v2, s[20:23], s24 offen
  s_mul_i32 s29, s17, 80
  s_mul_i32 s30, s16, 1152
  s_mov_b32 s32, s8
  s_and_b32 s33, s9, 0xffff
  s_mov_b32 s34, 2949120
  s_mov_b32 s35, 0x20000
  s_mov_b32 s36, 0xffff0000
  v_lshrrev_b32 v3, 5, v0
  s_add_u32 s25, s15, 0
  s_lshl_b32 s25, s25, 1
  v_add_u32 v3, s25, v3
  v_mul_u32_u24 v4, 13108, v3
  v_lshrrev_b32 v4, 16, v4
  v_mul_u32_u24 v5, 5, v4
  v_sub_u32 v5, v3, v5
  v_and_b32 v6, 31, v0
  v_lshlrev_b32 v6, 1, v6
  v_and_b32 v7, 15, v6
  v_lshrrev_b32 v6, 4, v6
  v_lshl_add_u32 v5, v5, 4, v7
  v_add_u32 v5, s29, v5
  v_mul_u32_u24 v5, 2304, v5
  v_lshl_add_u32 v5, v4, 5, v5
  v_lshl_add_u32 v24, v6, 3, v5
  v_lshrrev_b32 v3, 5, v0
  s_add_u32 s25, s15, 1
  s_lshl_b32 s25, s25, 1
  v_add_u32 v3, s25, v3
  v_mul_u32_u24 v4, 13108, v3
  v_lshrrev_b32 v4, 16, v4
  v_mul_u32_u24 v5, 5, v4
  v_sub_u32 v5, v3, v5
  v_and_b32 v6, 31, v0
  v_lshlrev_b32 v6, 1, v6
  v_and_b32 v7, 15, v6
  v_lshrrev_b32 v6, 4, v6
  v_lshl_add_u32 v5, v5, 4, v7
  v_add_u32 v5, s29, v5
  v_mul_u32_u24 v5, 2304, v5
  v_lshl_add_u32 v5, v4, 5, v5
  v_lshl_add_u32 v25, v6, 3, v5
  s_waitcnt vmcnt(15)
  v_lshlrev_b32 v8, 16, v32
  v_and_b32 v9, s36, v32
  v_lshlrev_b32 v10, 16, v33
  v_and_b32 v11, s36, v33
  v_lshlrev_b32 v12, 16, v34
  v_and_b32 v13, s36, v34
  v_lshlrev_b32 v14, 16, v35
  v_and_b32 v15, s36, v35
  s_waitcnt vmcnt(14)
  v_lshlrev_b32 v3, 16, v36
  v_and_b32 v4, s36, v36
  v_add_f32 v8, v8, v3
  v_add_f32 v9, v9, v4
  v_lshlrev_b32 v3, 16, v37
  v_and_b32 v4, s36, v37
  v_add_f32 v10, v10, v3
  v_add_f32 v11, v11, v4
  v_lshlrev_b32 v3, 16, v38
  v_and_b32 v4, s36, v38
  v_add_f32 v12, v12, v3
  v_add_f32 v13, v13, v4
  v_lshlrev_b32 v3, 16, v39
  v_and_b32 v4, s36, v39
  v_add_f32 v14, v14, v3
  v_add_f32 v15, v15, v4
  s_waitcnt vmcnt(13)
  v_lshlrev_b32 v3, 16, v40
  v_and_b32 v4, s36, v40
  v_add_f32 v8, v8, v3
  v_add_f32 v9, v9, v4
  v_lshlrev_b32 v3, 16, v41
  v_and_b32 v4, s36, v41
  v_add_f32 v10, v10, v3
  v_add_f32 v11, v11, v4
  v_lshlrev_b32 v3, 16, v42
  v_and_b32 v4, s36, v42
  v_add_f32 v12, v12, v3
  v_add_f32 v13, v13, v4
  v_lshlrev_b32 v3, 16, v43
  v_and_b32 v4, s36, v43
  v_add_f32 v14, v14, v3
  v_add_f32 v15, v15, v4
  s_waitcnt vmcnt(12)
  v_lshlrev_b32 v3, 16, v44
  v_and_b32 v4, s36, v44
  v_add_f32 v8, v8, v3
  v_add_f32 v9, v9, v4
  v_lshlrev_b32 v3, 16, v45
  v_and_b32 v4, s36, v45
  v_add_f32 v10, v10, v3
  v_add_f32 v11, v11, v4
  v_lshlrev_b32 v3, 16, v46
  v_and_b32 v4, s36, v46
  v_add_f32 v12, v12, v3
  v_add_f32 v13, v13, v4
  v_lshlrev_b32 v3, 16, v47
  v_and_b32 v4, s36, v47
  v_add_f32 v14, v14, v3
  v_add_f32 v15, v15, v4
  s_waitcnt vmcnt(11)
  v_lshlrev_b32 v3, 16, v48
  v_and_b32 v4, s36, v48
  v_add_f32 v8, v8, v3
  v_add_f32 v9, v9, v4
  v_lshlrev_b32 v3, 16, v49
  v_and_b32 v4, s36, v49
  v_add_f32 v10, v10, v3
  v_add_f32 v11, v11, v4
  v_lshlrev_b32 v3, 16, v50
  v_and_b32 v4, s36, v50
  v_add_f32 v12, v12, v3
  v_add_f32 v13, v13, v4
  v_lshlrev_b32 v3, 16, v51
  v_and_b32 v4, s36, v51
  v_add_f32 v14, v14, v3
  v_add_f32 v15, v15, v4
  s_waitcnt vmcnt(10)
  v_lshlrev_b32 v3, 16, v52
  v_and_b32 v4, s36, v52
  v_add_f32 v8, v8, v3
  v_add_f32 v9, v9, v4
  v_lshlrev_b32 v3, 16, v53
  v_and_b32 v4, s36, v53
  v_add_f32 v10, v10, v3
  v_add_f32 v11, v11, v4
  v_lshlrev_b32 v3, 16, v54
  v_and_b32 v4, s36, v54
  v_add_f32 v12, v12, v3
  v_add_f32 v13, v13, v4
  v_lshlrev_b32 v3, 16, v55
  v_and_b32 v4, s36, v55
  v_add_f32 v14, v14, v3
  v_add_f32 v15, v15, v4
  s_waitcnt vmcnt(9)
  v_lshlrev_b32 v3, 16, v56
  v_and_b32 v4, s36, v56
  v_add_f32 v8, v8, v3
  v_add_f32 v9, v9, v4
  v_lshlrev_b32 v3, 16, v57
  v_and_b32 v4, s36, v57
  v_add_f32 v10, v10, v3
  v_add_f32 v11, v11, v4
  v_lshlrev_b32 v3, 16, v58
  v_and_b32 v4, s36, v58
  v_add_f32 v12, v12, v3
  v_add_f32 v13, v13, v4
  v_lshlrev_b32 v3, 16, v59
  v_and_b32 v4, s36, v59
  v_add_f32 v14, v14, v3
  v_add_f32 v15, v15, v4
  s_waitcnt vmcnt(8)
  v_lshlrev_b32 v3, 16, v60
  v_and_b32 v4, s36, v60
  v_add_f32 v8, v8, v3
  v_add_f32 v9, v9, v4
  v_lshlrev_b32 v3, 16, v61
  v_and_b32 v4, s36, v61
  v_add_f32 v10, v10, v3
  v_add_f32 v11, v11, v4
  v_lshlrev_b32 v3, 16, v62
  v_and_b32 v4, s36, v62
  v_add_f32 v12, v12, v3
  v_add_f32 v13, v13, v4
  v_lshlrev_b32 v3, 16, v63
  v_and_b32 v4, s36, v63
  v_add_f32 v14, v14, v3
  v_add_f32 v15, v15, v4
  v_cvt_pk_bf16_f32 v16, v8, v9
  v_cvt_pk_bf16_f32 v17, v10, v11
  v_cvt_pk_bf16_f32 v18, v12, v13
  v_cvt_pk_bf16_f32 v19, v14, v15
  buffer_store_dwordx2 v[16:17], v24, s[32:35], s30 offen
  buffer_store_dwordx2 v[18:19], v24, s[32:35], s30 offen offset:2304
  s_waitcnt vmcnt(9)
  v_lshlrev_b32 v8, 16, v64
  v_and_b32 v9, s36, v64
  v_lshlrev_b32 v10, 16, v65
  v_and_b32 v11, s36, v65
  v_lshlrev_b32 v12, 16, v66
  v_and_b32 v13, s36, v66
  v_lshlrev_b32 v14, 16, v67
  v_and_b32 v15, s36, v67
  s_waitcnt vmcnt(8)
  v_lshlrev_b32 v3, 16, v68
  v_and_b32 v4, s36, v68
  v_add_f32 v8, v8, v3
  v_add_f32 v9, v9, v4
  v_lshlrev_b32 v3, 16, v69
  v_and_b32 v4, s36, v69
  v_add_f32 v10, v10, v3
  v_add_f32 v11, v11, v4
  v_lshlrev_b32 v3, 16, v70
  v_and_b32 v4, s36, v70
  v_add_f32 v12, v12, v3
  v_add_f32 v13, v13, v4
  v_lshlrev_b32 v3, 16, v71
  v_and_b32 v4, s36, v71
  v_add_f32 v14, v14, v3
  v_add_f32 v15, v15, v4
  s_waitcnt vmcnt(7)
  v_lshlrev_b32 v3, 16, v72
  v_and_b32 v4, s36, v72
  v_add_f32 v8, v8, v3
  v_add_f32 v9, v9, v4
  v_lshlrev_b32 v3, 16, v73
  v_and_b32 v4, s36, v73
  v_add_f32 v10, v10, v3
  v_add_f32 v11, v11, v4
  v_lshlrev_b32 v3, 16, v74
  v_and_b32 v4, s36, v74
  v_add_f32 v12, v12, v3
  v_add_f32 v13, v13, v4
  v_lshlrev_b32 v3, 16, v75
  v_and_b32 v4, s36, v75
  v_add_f32 v14, v14, v3
  v_add_f32 v15, v15, v4
  s_waitcnt vmcnt(6)
  v_lshlrev_b32 v3, 16, v76
  v_and_b32 v4, s36, v76
  v_add_f32 v8, v8, v3
  v_add_f32 v9, v9, v4
  v_lshlrev_b32 v3, 16, v77
  v_and_b32 v4, s36, v77
  v_add_f32 v10, v10, v3
  v_add_f32 v11, v11, v4
  v_lshlrev_b32 v3, 16, v78
  v_and_b32 v4, s36, v78
  v_add_f32 v12, v12, v3
  v_add_f32 v13, v13, v4
  v_lshlrev_b32 v3, 16, v79
  v_and_b32 v4, s36, v79
  v_add_f32 v14, v14, v3
  v_add_f32 v15, v15, v4
  s_waitcnt vmcnt(5)
  v_lshlrev_b32 v3, 16, v80
  v_and_b32 v4, s36, v80
  v_add_f32 v8, v8, v3
  v_add_f32 v9, v9, v4
  v_lshlrev_b32 v3, 16, v81
  v_and_b32 v4, s36, v81
  v_add_f32 v10, v10, v3
  v_add_f32 v11, v11, v4
  v_lshlrev_b32 v3, 16, v82
  v_and_b32 v4, s36, v82
  v_add_f32 v12, v12, v3
  v_add_f32 v13, v13, v4
  v_lshlrev_b32 v3, 16, v83
  v_and_b32 v4, s36, v83
  v_add_f32 v14, v14, v3
  v_add_f32 v15, v15, v4
  s_waitcnt vmcnt(4)
  v_lshlrev_b32 v3, 16, v84
  v_and_b32 v4, s36, v84
  v_add_f32 v8, v8, v3
  v_add_f32 v9, v9, v4
  v_lshlrev_b32 v3, 16, v85
  v_and_b32 v4, s36, v85
  v_add_f32 v10, v10, v3
  v_add_f32 v11, v11, v4
  v_lshlrev_b32 v3, 16, v86
  v_and_b32 v4, s36, v86
  v_add_f32 v12, v12, v3
  v_add_f32 v13, v13, v4
  v_lshlrev_b32 v3, 16, v87
  v_and_b32 v4, s36, v87
  v_add_f32 v14, v14, v3
  v_add_f32 v15, v15, v4
  s_waitcnt vmcnt(3)
  v_lshlrev_b32 v3, 16, v88
  v_and_b32 v4, s36, v88
  v_add_f32 v8, v8, v3
  v_add_f32 v9, v9, v4
  v_lshlrev_b32 v3, 16, v89
  v_and_b32 v4, s36, v89
  v_add_f32 v10, v10, v3
  v_add_f32 v11, v11, v4
  v_lshlrev_b32 v3, 16, v90
  v_and_b32 v4, s36, v90
  v_add_f32 v12, v12, v3
  v_add_f32 v13, v13, v4
  v_lshlrev_b32 v3, 16, v91
  v_and_b32 v4, s36, v91
  v_add_f32 v14, v14, v3
  v_add_f32 v15, v15, v4
  s_waitcnt vmcnt(2)
  v_lshlrev_b32 v3, 16, v92
  v_and_b32 v4, s36, v92
  v_add_f32 v8, v8, v3
  v_add_f32 v9, v9, v4
  v_lshlrev_b32 v3, 16, v93
  v_and_b32 v4, s36, v93
  v_add_f32 v10, v10, v3
  v_add_f32 v11, v11, v4
  v_lshlrev_b32 v3, 16, v94
  v_and_b32 v4, s36, v94
  v_add_f32 v12, v12, v3
  v_add_f32 v13, v13, v4
  v_lshlrev_b32 v3, 16, v95
  v_and_b32 v4, s36, v95
  v_add_f32 v14, v14, v3
  v_add_f32 v15, v15, v4
  v_cvt_pk_bf16_f32 v20, v8, v9
  v_cvt_pk_bf16_f32 v21, v10, v11
  v_cvt_pk_bf16_f32 v22, v12, v13
  v_cvt_pk_bf16_f32 v23, v14, v15
  buffer_store_dwordx2 v[20:21], v25, s[32:35], s30 offen
  buffer_store_dwordx2 v[22:23], v25, s[32:35], s30 offen offset:2304
K2_END:
  s_endpgm
.section .rodata,"a"
.p2align 6
.amdhsa_kernel attn_kernel
  .amdhsa_next_free_vgpr 512
  .amdhsa_next_free_sgpr 102
  .amdhsa_accum_offset 256
  .amdhsa_group_segment_fixed_size 0
  .amdhsa_kernarg_size 104
  .amdhsa_user_sgpr_count 2
  .amdhsa_user_sgpr_kernarg_segment_ptr 1
  .amdhsa_system_sgpr_workgroup_id_x 1
.end_amdhsa_kernel
.p2align 6
.amdhsa_kernel reduce_kernel
  .amdhsa_next_free_vgpr 96
  .amdhsa_next_free_sgpr 102
  .amdhsa_accum_offset 96
  .amdhsa_group_segment_fixed_size 0
  .amdhsa_kernarg_size 104
  .amdhsa_user_sgpr_count 2
  .amdhsa_user_sgpr_kernarg_segment_ptr 1
  .amdhsa_system_sgpr_workgroup_id_x 1
.end_amdhsa_kernel
```
